```python
import torch

def _softmax(x, axis=-1):
    return torch.softmax(x, dim=axis)
def _gelu(x):
    return torch.nn.functional.gelu(x, approximate="tanh")
def _silu(x):
    return torch.nn.functional.silu(x)
def _sigmoid(x):
    return torch.sigmoid(x)
def _layernorm(x, axis=-1, eps=1e-5):
    m = x.mean(dim=axis, keepdim=True)
    v = x.var(dim=axis, keepdim=True, unbiased=False)
    return (x - m) / torch.sqrt(v + eps)
def _scatter_add(tgt, idx, src, axis=0):
    return tgt.clone().index_add_(axis, idx, src)
def _segment_sum(src, seg, n):
    out = torch.zeros((n,) + src.shape[1:], dtype=src.dtype)
    return out.index_add_(0, seg, src)
def _pad(x, pw):
    flat = tuple(v for pair in reversed(pw) for v in pair)
    return torch.nn.functional.pad(x, flat)

kernel_name = 'interleave_layers__spectral_gfnet__linear_attn_block__prompt'

def setup_inputs():

    _w = (lambda a: (lambda t: t.to(torch.bfloat16) if t.is_floating_point() else t)(torch.as_tensor(a)))
    def _A_setup():
        B, S, D = 1, 2048, 640
        Df = D // 2 + 1
        return {
            "x": _w((lambda *s: torch.randn(*s, dtype=torch.bfloat16) * 0.05)(B, S, D)),
            "w_r": _w((lambda *s: torch.randn(*s, dtype=torch.bfloat16) * 0.4)(S, Df) * 0.02),
            "w_i": _w((lambda *s: torch.randn(*s, dtype=torch.bfloat16) * 0.4)(S, Df) * 0.02),
        }
    _A_in = _A_setup()

    def _B_setup():
        B, S, D = 1, 2048, 640
        return {
            "x": _w((lambda *s: torch.randn(*s, dtype=torch.bfloat16) * 0.05)(B, S, D)),
            "wqkv": _w((lambda *s: torch.randn(*s, dtype=torch.bfloat16) * 0.05)(D, 3 * D)),
            "wo": _w((lambda *s: torch.randn(*s, dtype=torch.bfloat16) * 0.05)(D, D)),
        }
    _B_in = _B_setup()

    return {
        "A_x": _A_in["x"],
        "A_w_r": _A_in["w_r"],
        "A_w_i": _A_in["w_i"],
        "B_x": _B_in["x"],
        "B_wqkv": _B_in["wqkv"],
        "B_wo": _B_in["wo"],
    }

def reference(A_x, A_w_r, A_w_i, B_x, B_wqkv, B_wo):
    def _A_ref(x, w_r, w_i):
        B, S, D = x.shape
        X = (lambda x, axes=(-2,-1): torch.fft.rfft2(x.float(), dim=axes))(x, axes=(-2, -1))
        W = w_r + 1j * w_i
        X = X * W
        y = (lambda x, s, axes=(-2,-1): torch.fft.irfft2(x, s=s, dim=axes).to(torch.bfloat16))(X, (S, D), axes=(-2, -1))
        return y

    def _B_ref(x, wqkv, wo):
        B, S, D = x.shape
        H = 32; Dh = D // H
        qkv = (lambda x, *d: x.permute(*d))((x @ wqkv).reshape(B, S, 3, H, Dh), 2, 0, 3, 1, 4)
        q, k, v = qkv[0], qkv[1], qkv[2]
        phi = lambda t: torch.where(t > 0, t + 1, torch.exp(t)) + 1e-6
        pq, pk = phi(q), phi(k)
        kv = torch.einsum("bhsd,bhse->bhde", pk, v)
        z = torch.einsum("bhsd->bhd", pk)
        num = torch.einsum("bhqd,bhde->bhqe", pq, kv)
        den = torch.einsum("bhqd,bhd->bhq", pq, z)[..., None] + 1e-6
        o = num / den
        return (lambda x, *d: x.permute(*d))(o, 0, 2, 1, 3).reshape(B, S, D) @ wo

    x = A_x
    x = x + _A_ref(_layernorm(x, axis=-1), A_w_r, A_w_i)
    x = x + _B_ref(_layernorm(x, axis=-1), B_wqkv, B_wo)
    x = x + _A_ref(_layernorm(x, axis=-1), A_w_r, A_w_i)
    x = x + _B_ref(_layernorm(x, axis=-1), B_wqkv, B_wo)
    return x
```

```asm
; @launch grid=(256,1,1) block=(512,1,1) lds=163840
.amdgcn_target "amdgcn-amd-amdhsa--gfx950"
.text
.globl interleave_layers__spectral_gfnet__linear_attn_block__prompt_kernel
.p2align 8
.type interleave_layers__spectral_gfnet__linear_attn_block__prompt_kernel,@function
interleave_layers__spectral_gfnet__linear_attn_block__prompt_kernel:
    s_cmp_ge_u32 s2, 256
    s_cbranch_scc1 kexit
    s_load_dwordx16 s[40:55], s[0:1], 0
    s_load_dwordx2 s[56:57], s[0:1], 64
    v_and_b32 v1, 63, v0
    v_lshrrev_b32 v5, 6, v0
    v_and_b32 v2, 15, v0
    v_bfe_u32 v3, v0, 4, 2
    v_readfirstlane_b32 s3, v5
    v_lshlrev_b32 v4, 4, v1
    s_and_b32 s4, s2, 7
    s_bfe_u32 s5, s2, 0x20003
    s_lshr_b32 s6, s2, 5
    s_lshl_b32 s7, s4, 2
    s_add_u32 s7, s7, s5
    s_mov_b32 s83, 0
    s_mov_b32 s79, 0
    s_mov_b32 s69, 0
    s_mov_b32 s70, 0
    v_mov_b32 v252, 0
    v_mov_b32 v244, 0
    s_and_b32 s60, s3, 3
    s_lshr_b32 s61, s3, 2
    s_and_b32 s62, s3, 1
    s_lshl_b32 s62, s62, 2
    s_bfe_u32 s63, s3, 0x10001
    s_and_b32 s72, s6, 1
    s_lshl_b32 s72, s72, 2
    s_add_u32 s72, s72, s4
    s_and_b32 s72, s72, 7
    s_lshl_b32 s73, s5, 3
    s_add_u32 s72, s72, s73
    s_mul_i32 s73, s6, 20
    s_add_u32 s73, s73, s72
    s_cmp_lg_u32 s3, 1
    s_cbranch_scc1 ct_1
    s_getpc_b64 s[64:65]
ctbase:
    s_lshr_b32 s66, s2, 3
    s_mul_i32 s66, s66, 12
    v_min_u32 v8, 11, v1
    v_add_u32 v8, s66, v8
    v_lshlrev_b32 v8, 7, v8
    v_min_u32 v8, kend-ctbase-4, v8
    v_mov_b32 v9, s65
    v_add_co_u32 v8, vcc, s64, v8
    s_nop 1
    v_addc_co_u32 v9, vcc, 0, v9, vcc
    global_load_dword v254, v[8:9], off
ct_1:
    s_waitcnt lgkmcnt(0)
    s_mov_b32 s8, s40
    s_and_b32 s9, s41, 0xffff
    s_mov_b32 s10, 2621440
    s_mov_b32 s11, 0x20000
    s_mov_b32 s32, s56
    s_and_b32 s33, s57, 0xffff
    s_mov_b32 s34, 39321600
    s_mov_b32 s35, 0x20000
    s_mov_b32 s20, s48
    s_and_b32 s21, s49, 0xffff
    s_mov_b32 s22, 2457600
    s_mov_b32 s23, 0x20000
    s_mov_b32 s12, s42
    s_and_b32 s13, s43, 0xffff
    s_mov_b32 s14, 1314816
    s_mov_b32 s15, 0x20000
    s_mov_b32 s16, s44
    s_and_b32 s17, s45, 0xffff
    s_mov_b32 s18, 1314816
    s_mov_b32 s19, 0x20000
    s_mov_b32 s24, s50
    s_and_b32 s25, s51, 0xffff
    s_mov_b32 s26, 819200
    s_mov_b32 s27, 0x20000
    s_mov_b32 s28, s52
    s_and_b32 s29, s53, 0xffff
    s_mov_b32 s30, 2621440
    s_mov_b32 s31, 0x20000
    s_mov_b32 s36, s54
    s_and_b32 s37, s55, 0xffff
    s_mov_b32 s38, 256
    s_mov_b32 s39, 0x20000
    s_cmp_ge_u32 s3, 4
    s_cbranch_scc1 tc3_4
    v_lshlrev_b32 v8, 7, v1
    s_cmp_eq_u32 s3, 3
    s_cbranch_scc1 tc4_5
    s_cmp_eq_u32 s3, 2
    s_cbranch_scc0 tc2_3
    s_mul_i32 s40, s2, 5248
    v_min_u32 v9, 5120, v8
    buffer_load_dword v254, v9, s[12:15], s40 offen
    buffer_load_dword v254, v9, s[16:19], s40 offen
    s_branch tc2_3
tc4_5:
    s_mul_i32 s40, s2, 3200
    v_min_u32 v9, 3072, v8
    buffer_load_dword v254, v9, s[24:27], s40 offen
    s_branch tc2_3
tc3_4:
    s_and_b32 s40, s3, 1
    s_lshl_b32 s40, s40, 6
    v_add_u32 v8, s40, v1
    v_min_u32 v8, 79, v8
    s_cmp_ge_u32 s3, 6
    s_cbranch_scc1 tc1_2
    v_mul_u32_u24 v9, 205, v8
    v_lshrrev_b32 v9, 11, v9
    v_mul_u32_u24 v10, 10, v9
    v_sub_u32 v10, v8, v10
    v_and_b32 v11, 3, v9
    v_lshrrev_b32 v9, 2, v9
    s_lshl_b32 s40, s5, 4
    s_lshl_b32 s41, s6, 1
    s_add_u32 s40, s40, s41
    v_add_u32 v9, s40, v9
    v_lshl_add_u32 v9, v9, 5, v11
    s_lshl_b32 s40, s4, 2
    v_add_u32 v9, s40, v9
    v_mul_u32_u24 v9, 1280, v9
    v_lshl_add_u32 v9, v10, 7, v9
    buffer_load_dword v254, v9, s[8:11], 0 offen
    s_branch tc2_3
tc1_2:
    s_mul_i32 s40, s6, 80
    v_add_u32 v8, s40, v8
    v_mul_u32_u24 v8, 3840, v8
    s_lshl_b32 s40, s7, 7
    s_cmp_ge_u32 s7, 30
    s_cselect_b32 s40, 2146435072, s40
    buffer_load_dword v254, v8, s[20:23], s40 offen
tc2_3:
    s_cmp_lg_u32 s2, 0
    s_cbranch_scc1 zi_6
    s_cmp_lg_u32 s3, 6
    s_cbranch_scc1 zi_6
    v_mov_b32 v8, 0
    v_mov_b32 v9, 0
    v_mov_b32 v10, 0
    v_mov_b32 v11, 0
    s_mov_b32 s42, 26214400
    v_lshlrev_b32 v12, 8, v1
    buffer_store_dword v8, v12, s[32:35], s42 offen sc1
    s_mov_b32 s42, 26230784
    buffer_store_dword v8, v12, s[32:35], s42 offen sc1
zi_6:
    s_mov_b32 s40, s3
    v_and_b32 v8, 1, v2
    v_cvt_f32_u32 v8, v8
    v_mul_f32 v8, 0.25, v8
    v_lshrrev_b32 v9, 1, v2
    s_mul_i32 s44, s6, 40
    s_add_u32 s44, s44, 1
    v_add_u32 v9, s44, v9
    v_lshlrev_b32 v10, 3, v3
    s_mov_b32 s45, 0x3acccccd
    v_mov_b32 v28, 0.125
    v_sub_f32 v29, 0.5, v8
    v_sub_f32 v29, v29, v8
ft_7:
    s_mul_i32 s41, s40, 52
    s_lshr_b32 s41, s41, 8
    s_mul_i32 s42, s41, 5
    s_sub_u32 s42, s40, s42
    s_lshl_b32 s43, s40, 10
    v_add_u32 v30, s43, v4
    s_lshl_b32 s42, s42, 3
    s_lshl_b32 s41, s41, 5
    v_add_u32 v11, s42, v9
    v_add_u32 v12, s41, v10
    v_cmp_eq_u32 vcc, 0x140, v11
    v_cvt_f32_u32 v13, v11
    v_cvt_f32_u32 v12, v12
    v_mul_f32 v13, s45, v13
    v_cndmask_b32 v14, v8, v28, vcc
    v_cndmask_b32 v13, v13, v29, vcc
    v_fma_f32 v16, v12, v13, v14
    v_cos_f32 v15, v13
    v_add_f32 v17, v16, v13
    v_cos_f32 v16, v16
    v_cos_f32 v17, v17
    v_add_f32 v15, v15, v15
    v_fma_f32 v18, v15, v17, -v16
    v_fma_f32 v19, v15, v18, -v17
    v_fma_f32 v20, v15, v19, -v18
    v_fma_f32 v21, v15, v20, -v19
    v_fma_f32 v22, v15, v21, -v20
    v_fma_f32 v23, v15, v22, -v21
    v_cvt_pk_bf16_f32 v24, v16, v17
    v_cvt_pk_bf16_f32 v25, v18, v19
    v_cvt_pk_bf16_f32 v26, v20, v21
    v_cvt_pk_bf16_f32 v27, v22, v23
    ds_write_b128 v30, v[24:27] offset:0
    s_add_u32 s40, s40, 8
    s_cmp_lt_u32 s40, 50
    s_cbranch_scc1 ft_7
    s_cmp_lg_u32 s2, 0
    s_cbranch_scc1 zs_8
    s_cmp_lg_u32 s3, 6
    s_cbranch_scc1 zs_8
    s_waitcnt vmcnt(0)
    v_mov_b32 v254, 1
    v_mov_b32 v255, 0
    s_mov_b64 exec, 1
    buffer_store_dword v254, v255, s[36:39], 0 offen sc1
    s_mov_b64 exec, -1
zs_8:
    v_lshrrev_b32 v8, 3, v1
    v_add_u32 v9, 8, v8
    s_lshl_b32 s42, s5, 1
    s_add_u32 s42, s42, s63
    s_lshl_b32 s42, s42, 3
    s_add_u32 s42, s42, s62
    s_lshl_b32 s42, s42, 5
    s_lshl_b32 s43, s4, 2
    s_add_u32 s42, s42, s43
    v_and_b32 v6, 3, v8
    v_lshlrev_b32 v6, 5, v6
    v_lshrrev_b32 v11, 2, v8
    v_add3_u32 v6, v6, v11, s42
    s_lshl_b32 s42, s5, 1
    s_add_u32 s42, s42, s63
    s_lshl_b32 s42, s42, 3
    s_add_u32 s42, s42, s62
    s_lshl_b32 s42, s42, 5
    s_lshl_b32 s43, s4, 2
    s_add_u32 s42, s42, s43
    v_and_b32 v7, 3, v9
    v_lshlrev_b32 v7, 5, v7
    v_lshrrev_b32 v11, 2, v9
    v_add3_u32 v7, v7, v11, s42
    s_movk_i32 s41, 1280
    v_mul_lo_u32 v6, v6, s41
    v_mul_lo_u32 v7, v7, s41
    v_and_b32 v9, 6, v8
    v_and_b32 v10, 7, v1
    v_xor_b32 v9, v9, v10
    v_lshl_add_u32 v6, v9, 4, v6
    v_lshl_add_u32 v7, v9, 4, v7
    s_mul_i32 s52, s61, 640
    s_mul_i32 s53, s3, 10240
    s_add_u32 s53, s53, 51200
    s_add_u32 m0, s53, 0
    s_nop 0
    buffer_load_dwordx4 v6, s[8:11], s52 offen offset:0 lds
    s_add_u32 m0, s53, 1024
    s_nop 0
    buffer_load_dwordx4 v7, s[8:11], s52 offen offset:0 lds
    s_add_u32 m0, s53, 1920
    s_nop 0
    buffer_load_dwordx4 v6, s[8:11], s52 offen offset:128 lds
    s_add_u32 m0, s53, 2944
    s_nop 0
    buffer_load_dwordx4 v7, s[8:11], s52 offen offset:128 lds
    s_add_u32 m0, s53, 3840
    s_nop 0
    buffer_load_dwordx4 v6, s[8:11], s52 offen offset:256 lds
    s_add_u32 m0, s53, 4864
    s_nop 0
    buffer_load_dwordx4 v7, s[8:11], s52 offen offset:256 lds
    s_add_u32 m0, s53, 5760
    s_nop 0
    buffer_load_dwordx4 v6, s[8:11], s52 offen offset:384 lds
    s_add_u32 m0, s53, 6784
    s_nop 0
    buffer_load_dwordx4 v7, s[8:11], s52 offen offset:384 lds
    s_add_u32 m0, s53, 7680
    s_nop 0
    buffer_load_dwordx4 v6, s[8:11], s52 offen offset:512 lds
    s_add_u32 m0, s53, 8704
    s_nop 0
    buffer_load_dwordx4 v7, s[8:11], s52 offen offset:512 lds
    s_cmp_ge_u32 s3, 3
    s_cbranch_scc1 wtl_9
    s_mul_i32 s79, s2, 3
    s_add_u32 s79, s79, s3
    s_mul_i32 s69, s79, 5462
    s_lshr_b32 s69, s69, 16
    s_mul_i32 s40, s69, 12
    s_sub_u32 s70, s79, s40
    v_bfe_u32 v6, v1, 3, 1
    v_lshrrev_b32 v7, 4, v1
    v_lshl_add_u32 v5, v6, 2, v7
    s_mov_b32 s41, 41088
    v_mul_lo_u32 v6, v5, s41
    v_and_b32 v7, 7, v1
    v_lshl_add_u32 v6, v7, 4, v6
    s_mul_i32 s40, s69, 642
    s_andn2_b32 s40, s40, 127
    s_lshr_b32 s41, s70, 1
    s_lshl_b32 s41, s41, 7
    s_add_u32 s40, s40, s41
    s_and_b32 s41, s70, 1
    s_mul_i32 s41, s41, 657408
    s_add_u32 s40, s40, s41
    s_add_u32 s41, s40, 328704
    buffer_load_dwordx4 v[84:87], v6, s[12:15], s40 offen
    buffer_load_dwordx4 v[88:91], v6, s[16:19], s40 offen
    buffer_load_dwordx4 v[92:95], v6, s[12:15], s41 offen
    buffer_load_dwordx4 v[96:99], v6, s[16:19], s41 offen
wtl_9:
    s_mul_i32 s64, s7, 81920
    s_mul_i32 s40, s6, 5120
    s_add_u32 s64, s64, s40
    s_cmp_ge_u32 s72, 20
    s_cbranch_scc1 nc_10
    s_mov_b32 s40, 0
    v_lshrrev_b32 v7, 2, v2
    v_and_b32 v6, 3, v2
    v_lshl_add_u32 v6, v7, 3, v6
    v_add_u32 v6, s40, v6
    v_cvt_f32_u32 v6, v6
    v_lshlrev_b32 v7, 3, v3
    v_cvt_f32_u32 v7, v7
    s_lshl_b32 s40, s63, 5
    v_cvt_f32_u32 v8, s40
    s_xor_b32 s40, s40, 32
    v_cvt_f32_u32 v9, s40
    v_cvt_f32_u32 v10, s62
    v_add_f32 v11, v8, v6
    v_mul_f32 v12, 0x3c800000, v11
    v_add_f32 v13, v8, v7
    v_mul_f32 v13, v13, v12
    v_cos_f32 v14, v12
    v_add_f32 v17, v13, v12
    v_sin_f32 v24, v13
    v_cos_f32 v16, v13
    v_sin_f32 v25, v17
    v_cos_f32 v17, v17
    v_add_f32 v14, v14, v14
    v_fma_f32 v26, v14, v25, -v24
    v_fma_f32 v18, v14, v17, -v16
    v_fma_f32 v27, v14, v26, -v25
    v_fma_f32 v19, v14, v18, -v17
    v_fma_f32 v28, v14, v27, -v26
    v_fma_f32 v20, v14, v19, -v18
    v_fma_f32 v29, v14, v28, -v27
    v_fma_f32 v21, v14, v20, -v19
    v_fma_f32 v30, v14, v29, -v28
    v_fma_f32 v22, v14, v21, -v20
    v_fma_f32 v31, v14, v30, -v29
    v_fma_f32 v23, v14, v22, -v21
    v_cvt_pk_bf16_f32 v180, v24, v25
    v_cvt_pk_bf16_f32 v181, v26, v27
    v_cvt_pk_bf16_f32 v182, v28, v29
    v_cvt_pk_bf16_f32 v183, v30, v31
    v_cvt_pk_bf16_f32 v164, v16, v17
    v_cvt_pk_bf16_f32 v165, v18, v19
    v_cvt_pk_bf16_f32 v166, v20, v21
    v_cvt_pk_bf16_f32 v167, v22, v23
    v_add_f32 v13, v9, v7
    v_mul_f32 v13, v13, v12
    v_cos_f32 v14, v12
    v_add_f32 v17, v13, v12
    v_sin_f32 v24, v13
    v_cos_f32 v16, v13
    v_sin_f32 v25, v17
    v_cos_f32 v17, v17
    v_add_f32 v14, v14, v14
    v_fma_f32 v26, v14, v25, -v24
    v_fma_f32 v18, v14, v17, -v16
    v_fma_f32 v27, v14, v26, -v25
    v_fma_f32 v19, v14, v18, -v17
    v_fma_f32 v28, v14, v27, -v26
    v_fma_f32 v20, v14, v19, -v18
    v_fma_f32 v29, v14, v28, -v27
    v_fma_f32 v21, v14, v20, -v19
    v_fma_f32 v30, v14, v29, -v28
    v_fma_f32 v22, v14, v21, -v20
    v_fma_f32 v31, v14, v30, -v29
    v_fma_f32 v23, v14, v22, -v21
    v_cvt_pk_bf16_f32 v184, v24, v25
    v_cvt_pk_bf16_f32 v185, v26, v27
    v_cvt_pk_bf16_f32 v186, v28, v29
    v_cvt_pk_bf16_f32 v187, v30, v31
    v_cvt_pk_bf16_f32 v168, v16, v17
    v_cvt_pk_bf16_f32 v169, v18, v19
    v_cvt_pk_bf16_f32 v170, v20, v21
    v_cvt_pk_bf16_f32 v171, v22, v23
    v_mov_b32 v11, v6
    v_mul_f32 v12, 0x3d000000, v11
    v_mul_f32 v13, v7, v12
    v_cos_f32 v14, v12
    v_add_f32 v17, v13, v12
    v_sin_f32 v24, v13
    v_cos_f32 v16, v13
    v_sin_f32 v25, v17
    v_cos_f32 v17, v17
    v_add_f32 v14, v14, v14
    v_fma_f32 v26, v14, v25, -v24
    v_fma_f32 v18, v14, v17, -v16
    v_fma_f32 v27, v14, v26, -v25
    v_fma_f32 v19, v14, v18, -v17
    v_fma_f32 v28, v14, v27, -v26
    v_fma_f32 v20, v14, v19, -v18
    v_fma_f32 v29, v14, v28, -v27
    v_fma_f32 v21, v14, v20, -v19
    v_fma_f32 v30, v14, v29, -v28
    v_fma_f32 v22, v14, v21, -v20
    v_fma_f32 v31, v14, v30, -v29
    v_fma_f32 v23, v14, v22, -v21
    v_cvt_pk_bf16_f32 v204, v24, v25
    v_cvt_pk_bf16_f32 v205, v26, v27
    v_cvt_pk_bf16_f32 v206, v28, v29
    v_cvt_pk_bf16_f32 v207, v30, v31
    v_cvt_pk_bf16_f32 v196, v16, v17
    v_cvt_pk_bf16_f32 v197, v18, v19
    v_cvt_pk_bf16_f32 v198, v20, v21
    v_cvt_pk_bf16_f32 v199, v22, v23
    v_mul_f32 v12, 0x3a000000, v11
    v_add_f32 v13, v7, v10
    v_add_f32 v13, v13, v8
    v_mul_f32 v16, v13, v12
    v_add_f32 v17, v16, v12
    v_fma_f32 v18, 2.0, v12, v16
    v_add_f32 v19, v18, v12
    v_sin_f32 v236, v16
    v_sin_f32 v237, v17
    v_sin_f32 v238, v18
    v_sin_f32 v239, v19
    v_cos_f32 v228, v16
    v_cos_f32 v229, v17
    v_cos_f32 v230, v18
    v_cos_f32 v231, v19
    v_add_f32 v11, v8, v6
    v_add_f32 v11, 4.0, v11
    v_mul_f32 v12, 0x3c800000, v11
    v_add_f32 v13, v8, v7
    v_mul_f32 v13, v13, v12
    v_cos_f32 v14, v12
    v_add_f32 v17, v13, v12
    v_sin_f32 v24, v13
    v_cos_f32 v16, v13
    v_sin_f32 v25, v17
    v_cos_f32 v17, v17
    v_add_f32 v14, v14, v14
    v_fma_f32 v26, v14, v25, -v24
    v_fma_f32 v18, v14, v17, -v16
    v_fma_f32 v27, v14, v26, -v25
    v_fma_f32 v19, v14, v18, -v17
    v_fma_f32 v28, v14, v27, -v26
    v_fma_f32 v20, v14, v19, -v18
    v_fma_f32 v29, v14, v28, -v27
    v_fma_f32 v21, v14, v20, -v19
    v_fma_f32 v30, v14, v29, -v28
    v_fma_f32 v22, v14, v21, -v20
    v_fma_f32 v31, v14, v30, -v29
    v_fma_f32 v23, v14, v22, -v21
    v_cvt_pk_bf16_f32 v188, v24, v25
    v_cvt_pk_bf16_f32 v189, v26, v27
    v_cvt_pk_bf16_f32 v190, v28, v29
    v_cvt_pk_bf16_f32 v191, v30, v31
    v_cvt_pk_bf16_f32 v172, v16, v17
    v_cvt_pk_bf16_f32 v173, v18, v19
    v_cvt_pk_bf16_f32 v174, v20, v21
    v_cvt_pk_bf16_f32 v175, v22, v23
    v_add_f32 v13, v9, v7
    v_mul_f32 v13, v13, v12
    v_cos_f32 v14, v12
    v_add_f32 v17, v13, v12
    v_sin_f32 v24, v13
    v_cos_f32 v16, v13
    v_sin_f32 v25, v17
    v_cos_f32 v17, v17
    v_add_f32 v14, v14, v14
    v_fma_f32 v26, v14, v25, -v24
    v_fma_f32 v18, v14, v17, -v16
    v_fma_f32 v27, v14, v26, -v25
    v_fma_f32 v19, v14, v18, -v17
    v_fma_f32 v28, v14, v27, -v26
    v_fma_f32 v20, v14, v19, -v18
    v_fma_f32 v29, v14, v28, -v27
    v_fma_f32 v21, v14, v20, -v19
    v_fma_f32 v30, v14, v29, -v28
    v_fma_f32 v22, v14, v21, -v20
    v_fma_f32 v31, v14, v30, -v29
    v_fma_f32 v23, v14, v22, -v21
    v_cvt_pk_bf16_f32 v192, v24, v25
    v_cvt_pk_bf16_f32 v193, v26, v27
    v_cvt_pk_bf16_f32 v194, v28, v29
    v_cvt_pk_bf16_f32 v195, v30, v31
    v_cvt_pk_bf16_f32 v176, v16, v17
    v_cvt_pk_bf16_f32 v177, v18, v19
    v_cvt_pk_bf16_f32 v178, v20, v21
    v_cvt_pk_bf16_f32 v179, v22, v23
    v_mov_b32 v11, v6
    v_add_f32 v11, 4.0, v11
    v_mul_f32 v12, 0x3d000000, v11
    v_mul_f32 v13, v7, v12
    v_cos_f32 v14, v12
    v_add_f32 v17, v13, v12
    v_sin_f32 v24, v13
    v_cos_f32 v16, v13
    v_sin_f32 v25, v17
    v_cos_f32 v17, v17
    v_add_f32 v14, v14, v14
    v_fma_f32 v26, v14, v25, -v24
    v_fma_f32 v18, v14, v17, -v16
    v_fma_f32 v27, v14, v26, -v25
    v_fma_f32 v19, v14, v18, -v17
    v_fma_f32 v28, v14, v27, -v26
    v_fma_f32 v20, v14, v19, -v18
    v_fma_f32 v29, v14, v28, -v27
    v_fma_f32 v21, v14, v20, -v19
    v_fma_f32 v30, v14, v29, -v28
    v_fma_f32 v22, v14, v21, -v20
    v_fma_f32 v31, v14, v30, -v29
    v_fma_f32 v23, v14, v22, -v21
    v_cvt_pk_bf16_f32 v208, v24, v25
    v_cvt_pk_bf16_f32 v209, v26, v27
    v_cvt_pk_bf16_f32 v210, v28, v29
    v_cvt_pk_bf16_f32 v211, v30, v31
    v_cvt_pk_bf16_f32 v200, v16, v17
    v_cvt_pk_bf16_f32 v201, v18, v19
    v_cvt_pk_bf16_f32 v202, v20, v21
    v_cvt_pk_bf16_f32 v203, v22, v23
    v_mul_f32 v12, 0x3a000000, v11
    v_add_f32 v13, v7, v10
    v_add_f32 v13, v13, v8
    v_mul_f32 v16, v13, v12
    v_add_f32 v17, v16, v12
    v_fma_f32 v18, 2.0, v12, v16
    v_add_f32 v19, v18, v12
    v_sin_f32 v240, v16
    v_sin_f32 v241, v17
    v_sin_f32 v242, v18
    v_sin_f32 v243, v19
    v_cos_f32 v232, v16
    v_cos_f32 v233, v17
    v_cos_f32 v234, v18
    v_cos_f32 v235, v19
    v_mul_f32 v228, 0x3a000000, v228
    v_mul_f32 v229, 0x3a000000, v229
    v_mul_f32 v230, 0x3a000000, v230
    v_mul_f32 v231, 0x3a000000, v231
    v_mul_f32 v232, 0x3a000000, v232
    v_mul_f32 v233, 0x3a000000, v233
    v_mul_f32 v234, 0x3a000000, v234
    v_mul_f32 v235, 0x3a000000, v235
    v_mul_f32 v236, 0x3a000000, v236
    v_mul_f32 v237, 0x3a000000, v237
    v_mul_f32 v238, 0x3a000000, v238
    v_mul_f32 v239, 0x3a000000, v239
    v_mul_f32 v240, 0x3a000000, v240
    v_mul_f32 v241, 0x3a000000, v241
    v_mul_f32 v242, 0x3a000000, v242
    v_mul_f32 v243, 0x3a000000, v243
    v_add_f32 v11, v8, v6
    v_add_f32 v11, v11, v10
    v_mul_f32 v12, 0x3a000000, v11
    v_mul_f32 v13, v7, v12
    v_mov_b32 v16, v13
    v_add_f32 v17, v13, v12
    v_fma_f32 v18, 2.0, v12, v13
    v_fma_f32 v20, 4.0, v12, v13
    v_add_f32 v19, v18, v12
    v_add_f32 v21, v20, v12
    v_fma_f32 v22, 2.0, v12, v20
    v_add_f32 v23, v22, v12
    v_sin_f32 v220, v16
    v_sin_f32 v221, v17
    v_sin_f32 v222, v18
    v_sin_f32 v223, v19
    v_sin_f32 v224, v20
    v_sin_f32 v225, v21
    v_sin_f32 v226, v22
    v_sin_f32 v227, v23
    v_cos_f32 v212, v16
    v_cos_f32 v213, v17
    v_cos_f32 v214, v18
    v_cos_f32 v215, v19
    v_cos_f32 v216, v20
    v_cos_f32 v217, v21
    v_cos_f32 v218, v22
    v_cos_f32 v219, v23
    v_lshrrev_b32 v9, 2, v2
    v_and_b32 v8, 3, v2
    v_lshl_add_u32 v8, v9, 3, v8
    v_add_u32 v8, s62, v8
    s_lshl_b32 s40, s63, 5
    v_add_u32 v8, s40, v8
    s_lshl_b32 s40, s61, 1
    v_lshl_add_u32 v9, v3, 2, s40
    v_and_b32 v10, 15, v8
    v_xor_b32 v9, v9, v10
    v_lshlrev_b32 v9, 4, v9
    v_lshl_add_u32 v244, v8, 8, v9
    v_add_u32 v244, 81920, v244
    v_xor_b32 v248, 16, v244
nc_10:
    s_cmp_ge_u32 s3, 3
    s_cbranch_scc1 wtskip_11
    v_and_b32 v6, 3, v2
    v_cmp_eq_u32 vcc, v6, v3
    v_lshrrev_b32 v6, 2, v2
    s_nop 0
    v_cndmask_b32 v6, 7, v6, vcc
    v_mov_b32 v28, 0x3f80
    v_mov_b32 v29, 0x3f800000
    v_cmp_eq_u32 vcc, 0, v6
    s_nop 1
    v_cndmask_b32 v8, 0, v28, vcc
    v_cmp_eq_u32 vcc, 1, v6
    s_nop 1
    v_cndmask_b32 v8, v8, v29, vcc
    v_cmp_eq_u32 vcc, 2, v6
    s_nop 1
    v_cndmask_b32 v9, 0, v28, vcc
    v_cmp_eq_u32 vcc, 3, v6
    s_nop 1
    v_cndmask_b32 v9, v9, v29, vcc
    v_mov_b32 v10, 0
    v_mov_b32 v11, 0
    v_mov_b32 v12, 0
    v_mov_b32 v13, 0
    v_mov_b32 v14, v8
    v_mov_b32 v15, v9
    v_and_b32 v7, 7, v2
    v_lshrrev_b32 v17, 3, v2
    s_lshr_b32 s40, s70, 1
    s_lshl_b32 s40, s40, 6
    s_sub_u32 s40, s40, s69
    s_sub_u32 s40, s40, 1
    v_lshl_add_u32 v18, v7, 3, v3
    v_add_u32 v18, s40, v18
    v_add_u32 v19, 4, v18
    v_and_b32 v20, 1, v18
    v_lshlrev_b32 v20, 5, v20
    v_lshl_add_u32 v20, v17, 4, v20
    v_mov_b32 v21, 2146435072
    v_lshrrev_b32 v16, 1, v18
    v_lshl_add_u32 v16, v16, 14, v20
    v_cmp_gt_u32 vcc, 0x140, v18
    s_nop 1
    v_cndmask_b32 v16, v21, v16, vcc
    v_lshrrev_b32 v22, 1, v19
    v_lshl_add_u32 v22, v22, 14, v20
    v_cmp_gt_u32 vcc, 0x140, v19
    s_nop 1
    v_cndmask_b32 v22, v21, v22, vcc
    s_lshl_b32 s40, s69, 8
    s_and_b32 s41, s70, 1
    s_lshl_b32 s41, s41, 7
    s_add_u32 s40, s40, s41
    s_add_u32 s40, s40, 28835840
    s_waitcnt vmcnt(0)
    v_mfma_f32_16x16x32_bf16 v[32:35], v[8:11], v[84:87], 0
    v_mfma_f32_16x16x32_bf16 v[36:39], v[8:11], v[88:91], 0
    v_mfma_f32_16x16x32_bf16 v[40:43], v[12:15], v[84:87], 0
    v_mfma_f32_16x16x32_bf16 v[44:47], v[12:15], v[88:91], 0
    v_mfma_f32_16x16x32_bf16 v[48:51], v[8:11], v[92:95], 0
    v_mfma_f32_16x16x32_bf16 v[52:55], v[8:11], v[96:99], 0
    v_mfma_f32_16x16x32_bf16 v[56:59], v[12:15], v[92:95], 0
    v_mfma_f32_16x16x32_bf16 v[60:63], v[12:15], v[96:99], 0
    s_nop 1
    v_cvt_pk_bf16_f32 v64, v32, v36
    v_cvt_pk_bf16_f32 v65, v33, v37
    v_cvt_pk_bf16_f32 v66, v34, v38
    v_cvt_pk_bf16_f32 v67, v35, v39
    buffer_store_dwordx4 v[64:67], v16, s[32:35], s40 offen offset:0 sc1
    v_cvt_pk_bf16_f32 v68, v40, v44
    v_cvt_pk_bf16_f32 v69, v41, v45
    v_cvt_pk_bf16_f32 v70, v42, v46
    v_cvt_pk_bf16_f32 v71, v43, v47
    buffer_store_dwordx4 v[68:71], v22, s[32:35], s40 offen offset:0 sc1
    v_cvt_pk_bf16_f32 v72, v48, v52
    v_cvt_pk_bf16_f32 v73, v49, v53
    v_cvt_pk_bf16_f32 v74, v50, v54
    v_cvt_pk_bf16_f32 v75, v51, v55
    buffer_store_dwordx4 v[72:75], v16, s[32:35], s40 offen offset:64 sc1
    v_cvt_pk_bf16_f32 v76, v56, v60
    v_cvt_pk_bf16_f32 v77, v57, v61
    v_cvt_pk_bf16_f32 v78, v58, v62
    v_cvt_pk_bf16_f32 v79, v59, v63
    buffer_store_dwordx4 v[76:79], v22, s[32:35], s40 offen offset:64 sc1
wtskip_11:
    v_lshrrev_b32 v22, 3, v1
    v_and_b32 v23, 2, v22
    v_and_b32 v21, 7, v1
    v_xor_b32 v23, v23, v21
    s_movk_i32 s41, 3840
    v_mul_lo_u32 v22, v22, s41
    v_lshl_add_u32 v22, v23, 4, v22
    v_xor_b32 v23, 64, v22
    s_mul_i32 s54, s3, 307200
    s_lshl_b32 s41, s7, 7
    s_add_u32 s54, s54, s41
    s_cmp_ge_u32 s7, 30
    s_cselect_b32 s54, 2146435072, s54
    v_lshrrev_b32 v10, 3, v1
    v_and_b32 v11, 7, v1
    s_lshl_b32 s42, s60, 3
    v_and_b32 v5, 2, v10
    v_cvt_f32_u32 v5, v5
    v_subrev_f32 v5, 1.0, v5
    s_mul_i32 s43, s61, 40960
    s_lshl_b32 s44, s60, 9
    s_add_u32 s43, s43, s44
    v_lshlrev_b32 v9, 3, v1
    v_add_u32 v9, s43, v9
    v_xor_b32 v11, v11, v10
    v_lshlrev_b32 v11, 4, v11
    v_lshl_add_u32 v10, v10, 7, v11
    s_mul_i32 s43, s61, 10240
    s_lshl_b32 s44, s60, 10
    s_add_u32 s43, s43, s44
    s_add_u32 s43, s43, 102400
    v_add_u32 v10, s43, v10
    v_lshlrev_b32 v8, 1, v3
    s_lshr_b32 s44, s62, 2
    v_add_u32 v8, s44, v8
    v_and_b32 v11, 7, v2
    v_xor_b32 v8, v8, v11
    v_lshlrev_b32 v8, 4, v8
    v_lshl_add_u32 v8, v2, 7, v8
    s_mul_i32 s43, s61, 20480
    s_mul_i32 s44, s63, 10240
    s_add_u32 s43, s43, s44
    s_add_u32 s43, s43, 102400
    v_add_u32 v8, s43, v8
    s_cmp_lt_u32 s3, 3
    s_cbranch_scc1 w6_13
    s_waitcnt vmcnt(0)
w6_13:
    v_and_b32 v6, 6, v2
    v_xor_b32 v6, v6, v3
    v_lshlrev_b32 v6, 4, v6
    v_lshl_add_u32 v6, v2, 7, v6
    s_mul_i32 s41, s3, 10240
    s_add_u32 s41, s41, 51200
    v_add_u32 v6, s41, v6
    v_xor_b32 v7, 64, v6
    s_waitcnt vmcnt(4)
    ds_read_b128 v[84:87], v6 offset:0
    ds_read_b128 v[88:91], v7 offset:0
    ds_read_b128 v[92:95], v6 offset:2048
    ds_read_b128 v[96:99], v7 offset:2048
    ds_read_b128 v[100:103], v6 offset:4096
    ds_read_b128 v[104:107], v7 offset:4096
    ds_read_b128 v[108:111], v6 offset:6144
    ds_read_b128 v[112:115], v7 offset:6144
    ds_read_b128 v[116:119], v6 offset:8192
    ds_read_b128 v[120:123], v7 offset:8192
    buffer_load_dwordx4 v[124:127], v22, s[20:23], s54 offen
    s_add_u32 s54, s54, 30720
    buffer_load_dwordx4 v[128:131], v23, s[20:23], s54 offen
    s_add_u32 s54, s54, 30720
    s_waitcnt lgkmcnt(0)
    s_barrier
    ds_read_b128 v[44:47], v4 offset:0
    ds_read_b128 v[48:51], v4 offset:1024
    ds_read_b128 v[52:55], v4 offset:2048
    ds_read_b128 v[56:59], v4 offset:3072
    ds_read_b128 v[60:63], v4 offset:4096
    ds_read_b128 v[64:67], v4 offset:5120
    ds_read_b128 v[68:71], v4 offset:6144
    ds_read_b128 v[72:75], v4 offset:7168
    ds_read_b128 v[76:79], v4 offset:8192
    ds_read_b128 v[80:83], v4 offset:9216
    buffer_load_dwordx4 v[132:135], v22, s[20:23], s54 offen
    s_add_u32 s54, s54, 30720
    s_waitcnt lgkmcnt(5)
    v_mfma_f32_16x16x32_bf16 v[24:27], v[84:87], v[44:47], 0
    v_mfma_f32_16x16x32_bf16 v[28:31], v[84:87], v[48:51], 0
    v_mfma_f32_16x16x32_bf16 v[32:35], v[84:87], v[52:55], 0
    v_mfma_f32_16x16x32_bf16 v[36:39], v[84:87], v[56:59], 0
    v_mfma_f32_16x16x32_bf16 v[40:43], v[84:87], v[60:63], 0
    ds_read_b128 v[44:47], v4 offset:10240
    ds_read_b128 v[48:51], v4 offset:11264
    ds_read_b128 v[52:55], v4 offset:12288
    ds_read_b128 v[56:59], v4 offset:13312
    ds_read_b128 v[60:63], v4 offset:14336
    buffer_load_dwordx4 v[136:139], v23, s[20:23], s54 offen
    s_add_u32 s54, s54, 30720
    s_waitcnt lgkmcnt(5)
    v_mfma_f32_16x16x32_bf16 v[24:27], v[88:91], v[64:67], v[24:27]
    v_mfma_f32_16x16x32_bf16 v[28:31], v[88:91], v[68:71], v[28:31]
    v_mfma_f32_16x16x32_bf16 v[32:35], v[88:91], v[72:75], v[32:35]
    v_mfma_f32_16x16x32_bf16 v[36:39], v[88:91], v[76:79], v[36:39]
    v_mfma_f32_16x16x32_bf16 v[40:43], v[88:91], v[80:83], v[40:43]
    ds_read_b128 v[64:67], v4 offset:15360
    ds_read_b128 v[68:71], v4 offset:16384
    ds_read_b128 v[72:75], v4 offset:17408
    ds_read_b128 v[76:79], v4 offset:18432
    ds_read_b128 v[80:83], v4 offset:19456
    buffer_load_dwordx4 v[140:143], v22, s[20:23], s54 offen
    s_add_u32 s54, s54, 30720
    s_waitcnt lgkmcnt(5)
    v_mfma_f32_16x16x32_bf16 v[24:27], v[92:95], v[44:47], v[24:27]
    v_mfma_f32_16x16x32_bf16 v[28:31], v[92:95], v[48:51], v[28:31]
    v_mfma_f32_16x16x32_bf16 v[32:35], v[92:95], v[52:55], v[32:35]
    v_mfma_f32_16x16x32_bf16 v[36:39], v[92:95], v[56:59], v[36:39]
    v_mfma_f32_16x16x32_bf16 v[40:43], v[92:95], v[60:63], v[40:43]
    ds_read_b128 v[44:47], v4 offset:20480
    ds_read_b128 v[48:51], v4 offset:21504
    ds_read_b128 v[52:55], v4 offset:22528
    ds_read_b128 v[56:59], v4 offset:23552
    ds_read_b128 v[60:63], v4 offset:24576
    buffer_load_dwordx4 v[144:147], v23, s[20:23], s54 offen
    s_add_u32 s54, s54, 30720
    s_waitcnt lgkmcnt(5)
    v_mfma_f32_16x16x32_bf16 v[24:27], v[96:99], v[64:67], v[24:27]
    v_mfma_f32_16x16x32_bf16 v[28:31], v[96:99], v[68:71], v[28:31]
    v_mfma_f32_16x16x32_bf16 v[32:35], v[96:99], v[72:75], v[32:35]
    v_mfma_f32_16x16x32_bf16 v[36:39], v[96:99], v[76:79], v[36:39]
    v_mfma_f32_16x16x32_bf16 v[40:43], v[96:99], v[80:83], v[40:43]
    ds_read_b128 v[64:67], v4 offset:25600
    ds_read_b128 v[68:71], v4 offset:26624
    ds_read_b128 v[72:75], v4 offset:27648
    ds_read_b128 v[76:79], v4 offset:28672
    ds_read_b128 v[80:83], v4 offset:29696
    buffer_load_dwordx4 v[148:151], v22, s[20:23], s54 offen
    s_add_u32 s54, s54, 30720
    s_waitcnt lgkmcnt(5)
    v_mfma_f32_16x16x32_bf16 v[24:27], v[100:103], v[44:47], v[24:27]
    v_mfma_f32_16x16x32_bf16 v[28:31], v[100:103], v[48:51], v[28:31]
    v_mfma_f32_16x16x32_bf16 v[32:35], v[100:103], v[52:55], v[32:35]
    v_mfma_f32_16x16x32_bf16 v[36:39], v[100:103], v[56:59], v[36:39]
    v_mfma_f32_16x16x32_bf16 v[40:43], v[100:103], v[60:63], v[40:43]
    ds_read_b128 v[44:47], v4 offset:30720
    ds_read_b128 v[48:51], v4 offset:31744
    ds_read_b128 v[52:55], v4 offset:32768
    ds_read_b128 v[56:59], v4 offset:33792
    ds_read_b128 v[60:63], v4 offset:34816
    buffer_load_dwordx4 v[152:155], v23, s[20:23], s54 offen
    s_add_u32 s54, s54, 30720
    s_waitcnt lgkmcnt(5)
    v_mfma_f32_16x16x32_bf16 v[24:27], v[104:107], v[64:67], v[24:27]
    v_mfma_f32_16x16x32_bf16 v[28:31], v[104:107], v[68:71], v[28:31]
    v_mfma_f32_16x16x32_bf16 v[32:35], v[104:107], v[72:75], v[32:35]
    v_mfma_f32_16x16x32_bf16 v[36:39], v[104:107], v[76:79], v[36:39]
    v_mfma_f32_16x16x32_bf16 v[40:43], v[104:107], v[80:83], v[40:43]
    ds_read_b128 v[64:67], v4 offset:35840
    ds_read_b128 v[68:71], v4 offset:36864
    ds_read_b128 v[72:75], v4 offset:37888
    ds_read_b128 v[76:79], v4 offset:38912
    ds_read_b128 v[80:83], v4 offset:39936
    buffer_load_dwordx4 v[156:159], v22, s[20:23], s54 offen
    s_add_u32 s54, s54, 30720
    s_waitcnt lgkmcnt(5)
    v_mfma_f32_16x16x32_bf16 v[24:27], v[108:111], v[44:47], v[24:27]
    v_mfma_f32_16x16x32_bf16 v[28:31], v[108:111], v[48:51], v[28:31]
    v_mfma_f32_16x16x32_bf16 v[32:35], v[108:111], v[52:55], v[32:35]
    v_mfma_f32_16x16x32_bf16 v[36:39], v[108:111], v[56:59], v[36:39]
    v_mfma_f32_16x16x32_bf16 v[40:43], v[108:111], v[60:63], v[40:43]
    ds_read_b128 v[44:47], v4 offset:40960
    ds_read_b128 v[48:51], v4 offset:41984
    ds_read_b128 v[52:55], v4 offset:43008
    ds_read_b128 v[56:59], v4 offset:44032
    ds_read_b128 v[60:63], v4 offset:45056
    buffer_load_dwordx4 v[160:163], v23, s[20:23], s54 offen
    s_waitcnt lgkmcnt(5)
    v_mfma_f32_16x16x32_bf16 v[24:27], v[112:115], v[64:67], v[24:27]
    v_mfma_f32_16x16x32_bf16 v[28:31], v[112:115], v[68:71], v[28:31]
    v_mfma_f32_16x16x32_bf16 v[32:35], v[112:115], v[72:75], v[32:35]
    v_mfma_f32_16x16x32_bf16 v[36:39], v[112:115], v[76:79], v[36:39]
    v_mfma_f32_16x16x32_bf16 v[40:43], v[112:115], v[80:83], v[40:43]
    ds_read_b128 v[64:67], v4 offset:46080
    ds_read_b128 v[68:71], v4 offset:47104
    ds_read_b128 v[72:75], v4 offset:48128
    ds_read_b128 v[76:79], v4 offset:49152
    ds_read_b128 v[80:83], v4 offset:50176
    s_waitcnt lgkmcnt(5)
    v_mfma_f32_16x16x32_bf16 v[24:27], v[116:119], v[44:47], v[24:27]
    v_mfma_f32_16x16x32_bf16 v[28:31], v[116:119], v[48:51], v[28:31]
    v_mfma_f32_16x16x32_bf16 v[32:35], v[116:119], v[52:55], v[32:35]
    v_mfma_f32_16x16x32_bf16 v[36:39], v[116:119], v[56:59], v[36:39]
    v_mfma_f32_16x16x32_bf16 v[40:43], v[116:119], v[60:63], v[40:43]
    s_waitcnt lgkmcnt(0)
    v_mfma_f32_16x16x32_bf16 v[24:27], v[120:123], v[64:67], v[24:27]
    v_mfma_f32_16x16x32_bf16 v[28:31], v[120:123], v[68:71], v[28:31]
    v_mfma_f32_16x16x32_bf16 v[32:35], v[120:123], v[72:75], v[32:35]
    v_mfma_f32_16x16x32_bf16 v[36:39], v[120:123], v[76:79], v[36:39]
    v_mfma_f32_16x16x32_bf16 v[40:43], v[120:123], v[80:83], v[40:43]
    s_cmp_lg_u32 s3, 6
    s_nop 0
    s_cbranch_scc1 ip_14
    v_mov_b32 v255, 0
    buffer_load_dword v253, v255, s[36:39], 0 offen sc1
ip_14:
    s_mov_b32 s65, 26279936
    ds_write_b128 v8, v[24:27] offset:0
    ds_write_b128 v8, v[28:31] offset:2048
    ds_write_b128 v8, v[32:35] offset:4096
    ds_write_b128 v8, v[36:39] offset:6144
    ds_write_b128 v8, v[40:43] offset:8192
    s_add_u32 s46, s64, 4096
    s_cmp_ge_u32 s60, 2
    s_cselect_b32 s46, 2146435072, s46
    s_cselect_b32 s47, 0, 1.0
    v_mov_b32 v18, s47
    s_cmp_eq_u32 s6, 7
    s_cselect_b32 s47, 1, 99
    s_cmp_eq_u32 s60, s47
    s_cselect_b32 s47, 7, 99
    v_lshrrev_b32 v19, 3, v1
    v_cmp_ne_u32 vcc, s47, v19
    s_nop 1
    v_cndmask_b32 v18, 0, v18, vcc
    v_and_b32 v20, 7, v1
    v_lshlrev_b32 v20, 4, v20
    v_lshl_add_u32 v20, v3, 2, v20
    s_lshl_b32 s47, s61, 7
    s_lshl_b32 s45, s60, 8
    s_add_u32 s47, s47, s45
    s_add_u32 s47, s47, 147456
    v_add_u32 v20, s47, v20
    s_waitcnt lgkmcnt(0)
    s_barrier
    ds_read_b128 v[44:47], v10 offset:0
    ds_read_b128 v[56:59], v10 offset:20480
    ds_read_b128 v[48:51], v10 offset:4096
    ds_read_b128 v[60:63], v10 offset:24576
    ds_read_b128 v[52:55], v10 offset:8192
    ds_read_b128 v[64:67], v10 offset:28672
    s_waitcnt lgkmcnt(4)
    v_fma_f32 v44, v5, v56, v44
    v_fma_f32 v45, v5, v57, v45
    v_fma_f32 v46, v5, v58, v46
    v_fma_f32 v47, v5, v59, v47
    v_cvt_pk_bf16_f32 v12, v44, v45
    v_cvt_pk_bf16_f32 v13, v46, v47
    v_max_u32 v12, 1, v12
    v_max_u32 v13, 1, v13
    buffer_store_dwordx2 v[12:13], v9, s[32:35], s64 offen offset:0 sc1
    s_waitcnt lgkmcnt(2)
    v_fma_f32 v48, v5, v60, v48
    v_fma_f32 v49, v5, v61, v49
    v_fma_f32 v50, v5, v62, v50
    v_fma_f32 v51, v5, v63, v51
    v_cvt_pk_bf16_f32 v14, v48, v49
    v_cvt_pk_bf16_f32 v15, v50, v51
    v_max_u32 v14, 1, v14
    v_max_u32 v15, 1, v15
    buffer_store_dwordx2 v[14:15], v9, s[32:35], s64 offen offset:2048 sc1
    s_waitcnt lgkmcnt(0)
    v_fma_f32 v52, v5, v64, v52
    v_fma_f32 v53, v5, v65, v53
    v_fma_f32 v54, v5, v66, v54
    v_fma_f32 v55, v5, v67, v55
    v_cvt_pk_bf16_f32 v16, v52, v53
    v_cvt_pk_bf16_f32 v17, v54, v55
    v_max_u32 v16, 1, v16
    v_max_u32 v17, 1, v17
    buffer_store_dwordx2 v[16:17], v9, s[32:35], s46 offen sc1
    v_cmp_lt_f32 vcc, 0, v18
    v_mul_f32 v44, v44, v44
    v_mul_f32 v45, v45, v45
    v_mul_f32 v46, v46, v46
    v_mul_f32 v47, v47, v47
    v_cndmask_b32 v52, 0, v52, vcc
    v_cndmask_b32 v53, 0, v53, vcc
    v_cndmask_b32 v54, 0, v54, vcc
    v_cndmask_b32 v55, 0, v55, vcc
    v_fmac_f32 v44, v48, v48
    v_fmac_f32 v45, v49, v49
    v_fmac_f32 v46, v50, v50
    v_fmac_f32 v47, v51, v51
    v_fmac_f32 v44, v52, v52
    v_fmac_f32 v45, v53, v53
    v_fmac_f32 v46, v54, v54
    v_fmac_f32 v47, v55, v55
    s_nop 0
    v_permlane32_swap_b32 v44, v46
    v_permlane32_swap_b32 v45, v47
    v_add_f32 v44, v44, v46
    v_add_f32 v45, v45, v47
    s_nop 1
    v_permlane16_swap_b32 v44, v45
    v_add_f32 v44, v44, v45
    s_nop 1
    v_add_f32_dpp v44, v44, v44 row_ror:8 row_mask:0xf bank_mask:0xf
    ds_write_b32 v20, v44
    v_lshlrev_b32 v18, 3, v1
    v_add_u32 v18, 147456, v18
    v_lshlrev_b32 v11, 2, v1
    s_lshl_b32 s47, s6, 12
    s_lshl_b32 s46, s7, 7
    s_add_u32 s47, s47, s46
    s_add_u32 s47, s47, s65
    s_waitcnt lgkmcnt(0)
    s_barrier
    s_cmp_lg_u32 s3, 6
    s_cbranch_scc1 xv_15
    ds_read_b64 v[44:45], v18
    ds_read_b64 v[46:47], v18 offset:256
    ds_read_b64 v[48:49], v18 offset:512
    ds_read_b64 v[50:51], v18 offset:768
    s_waitcnt lgkmcnt(0)
    v_add_f32 v44, v44, v46
    v_add_f32 v45, v45, v47
    v_add_f32 v48, v48, v50
    v_add_f32 v49, v49, v51
    v_add_f32 v44, v44, v48
    v_add_f32 v45, v45, v49
    v_cvt_pk_bf16_f32 v10, v44, v45
    v_max_u32 v10, 1, v10
    s_mov_b32 exec_hi, 0
    buffer_store_dword v10, v11, s[32:35], s47 offen sc1
    s_mov_b32 exec_hi, -1
xv_15:
    s_waitcnt vmcnt(3)
    s_mul_i32 s41, s3, 10240
    s_add_u32 s41, s41, 51200
    v_add_u32 v6, s41, v4
    ds_write_b128 v6, v[124:127] offset:0
    ds_write_b128 v6, v[128:131] offset:1024
    ds_write_b128 v6, v[132:135] offset:2048
    ds_write_b128 v6, v[136:139] offset:3072
    ds_write_b128 v6, v[140:143] offset:4096
    ds_write_b128 v6, v[144:147] offset:5120
    ds_write_b128 v6, v[148:151] offset:6144
    ds_write_b128 v6, v[152:155] offset:7168
    ds_write_b128 v6, v[156:159] offset:8192
    ds_write_b128 v6, v[160:163] offset:9216
    v_lshrrev_b32 v7, 2, v2
    v_lshl_add_u32 v6, v3, 3, v7
    v_lshlrev_b32 v6, 7, v6
    v_lshrrev_b32 v7, 1, v7
    v_and_b32 v11, 1, v3
    v_lshl_add_u32 v7, v11, 1, v7
    v_xor_b32 v7, s60, v7
    v_lshl_add_u32 v6, v7, 5, v6
    v_and_b32 v7, 3, v2
    v_lshl_add_u32 v7, v7, 3, v6
    s_mul_i32 s40, s61, 40960
    s_add_u32 s40, s40, 51200
    v_add_u32 v7, s40, v7
    s_cmp_lg_u32 s3, 6
    s_cbranch_scc1 bz_16
    v_cmp_gt_u32 vcc, 1, v253
    s_nop 0
    s_cmp_eq_u64 vcc, 0
    s_cbranch_scc1 iw_17
    v_mov_b32 v255, 0
    s_mov_b32 s58, 40000
    s_cmp_lg_u32 s83, 0
    s_cbranch_scc1 polld_19
poll_18:
    buffer_load_dword v254, v255, s[36:39], 0 offen sc1
    s_waitcnt vmcnt(0)
    v_cmp_gt_u32 vcc, 1, v254
    s_nop 0
    s_cmp_eq_u64 vcc, 0
    s_cbranch_scc1 polld_19
    s_sub_u32 s58, s58, 1
    s_cmp_lg_u32 s58, 0
    s_cbranch_scc1 poll_18
    s_mov_b32 s83, 100
    v_mov_b32 v254, 100
    v_mov_b32 v255, 16
    buffer_store_dword v254, v255, s[36:39], 0 offen
polld_19:
iw_17:
bz_16:
    s_waitcnt vmcnt(0) lgkmcnt(0)
    s_barrier
    s_cmp_lg_u32 s3, 6
    s_cbranch_scc1 arr_20
    s_and_b32 s59, s2, 15
    s_lshl_b32 s59, s59, 8
    s_add_u32 s59, s59, 26214400
    v_lshlrev_b32 v255, 12, v1
    v_mov_b32 v254, 1
    s_mov_b64 exec, 15
    buffer_atomic_add v254, v255, s[32:35], s59 offen sc1
    s_mov_b64 exec, -1
arr_20:
    ds_read_b64_tr_b16 v[84:85], v7 offset:0
    ds_read_b64_tr_b16 v[86:87], v7 offset:512
    ds_read_b64_tr_b16 v[88:89], v7 offset:4096
    ds_read_b64_tr_b16 v[90:91], v7 offset:4608
    ds_read_b64_tr_b16 v[92:93], v7 offset:8192
    ds_read_b64_tr_b16 v[94:95], v7 offset:8704
    ds_read_b64_tr_b16 v[96:97], v7 offset:12288
    ds_read_b64_tr_b16 v[98:99], v7 offset:12800
    s_waitcnt lgkmcnt(4)
    ds_read_b64_tr_b16 v[100:101], v7 offset:16384
    ds_read_b64_tr_b16 v[102:103], v7 offset:16896
    ds_read_b64_tr_b16 v[104:105], v7 offset:20480
    ds_read_b64_tr_b16 v[106:107], v7 offset:20992
    ds_read_b64_tr_b16 v[108:109], v7 offset:24576
    ds_read_b64_tr_b16 v[110:111], v7 offset:25088
    ds_read_b64_tr_b16 v[112:113], v7 offset:28672
    ds_read_b64_tr_b16 v[114:115], v7 offset:29184
    s_waitcnt lgkmcnt(4)
    ds_read_b64_tr_b16 v[116:117], v7 offset:32768
    ds_read_b64_tr_b16 v[118:119], v7 offset:33280
    ds_read_b64_tr_b16 v[120:121], v7 offset:36864
    ds_read_b64_tr_b16 v[122:123], v7 offset:37376
    v_mov_b32 v12, 0
    v_mov_b32 v13, 0
    v_mov_b32 v14, 0
    v_mov_b32 v15, 0
    s_lshl_b32 s40, s3, 8
    s_add_u32 s40, s40, s2
    s_lshl_b32 s41, s40, 10
    s_add_u32 s41, s41, 36700160
    s_cmp_ge_u32 s40, 1056
    s_cbranch_scc1 zf_21
    buffer_store_dwordx4 v[12:15], v4, s[32:35], s41 offen sc1
zf_21:
    ds_read_b128 v[44:47], v4 offset:0
    ds_read_b128 v[48:51], v4 offset:1024
    ds_read_b128 v[52:55], v4 offset:2048
    ds_read_b128 v[56:59], v4 offset:3072
    ds_read_b128 v[60:63], v4 offset:4096
    ds_read_b128 v[64:67], v4 offset:5120
    ds_read_b128 v[68:71], v4 offset:6144
    ds_read_b128 v[72:75], v4 offset:7168
    ds_read_b128 v[76:79], v4 offset:8192
    ds_read_b128 v[80:83], v4 offset:9216
    s_waitcnt lgkmcnt(5)
    v_mfma_f32_16x16x32_bf16 v[24:27], v[44:47], v[84:87], 0
    v_mfma_f32_16x16x32_bf16 v[28:31], v[48:51], v[84:87], 0
    v_mfma_f32_16x16x32_bf16 v[32:35], v[52:55], v[84:87], 0
    v_mfma_f32_16x16x32_bf16 v[36:39], v[56:59], v[84:87], 0
    v_mfma_f32_16x16x32_bf16 v[40:43], v[60:63], v[84:87], 0
    ds_read_b128 v[44:47], v4 offset:10240
    ds_read_b128 v[48:51], v4 offset:11264
    ds_read_b128 v[52:55], v4 offset:12288
    ds_read_b128 v[56:59], v4 offset:13312
    ds_read_b128 v[60:63], v4 offset:14336
    s_waitcnt lgkmcnt(5)
    v_mfma_f32_16x16x32_bf16 v[24:27], v[64:67], v[88:91], v[24:27]
    v_mfma_f32_16x16x32_bf16 v[28:31], v[68:71], v[88:91], v[28:31]
    v_mfma_f32_16x16x32_bf16 v[32:35], v[72:75], v[88:91], v[32:35]
    v_mfma_f32_16x16x32_bf16 v[36:39], v[76:79], v[88:91], v[36:39]
    v_mfma_f32_16x16x32_bf16 v[40:43], v[80:83], v[88:91], v[40:43]
    ds_read_b128 v[64:67], v4 offset:15360
    ds_read_b128 v[68:71], v4 offset:16384
    ds_read_b128 v[72:75], v4 offset:17408
    ds_read_b128 v[76:79], v4 offset:18432
    ds_read_b128 v[80:83], v4 offset:19456
    s_waitcnt lgkmcnt(5)
    v_mfma_f32_16x16x32_bf16 v[24:27], v[44:47], v[92:95], v[24:27]
    v_mfma_f32_16x16x32_bf16 v[28:31], v[48:51], v[92:95], v[28:31]
    v_mfma_f32_16x16x32_bf16 v[32:35], v[52:55], v[92:95], v[32:35]
    v_mfma_f32_16x16x32_bf16 v[36:39], v[56:59], v[92:95], v[36:39]
    v_mfma_f32_16x16x32_bf16 v[40:43], v[60:63], v[92:95], v[40:43]
    ds_read_b128 v[44:47], v4 offset:20480
    ds_read_b128 v[48:51], v4 offset:21504
    ds_read_b128 v[52:55], v4 offset:22528
    ds_read_b128 v[56:59], v4 offset:23552
    ds_read_b128 v[60:63], v4 offset:24576
    s_waitcnt lgkmcnt(5)
    v_mfma_f32_16x16x32_bf16 v[24:27], v[64:67], v[96:99], v[24:27]
    v_mfma_f32_16x16x32_bf16 v[28:31], v[68:71], v[96:99], v[28:31]
    v_mfma_f32_16x16x32_bf16 v[32:35], v[72:75], v[96:99], v[32:35]
    v_mfma_f32_16x16x32_bf16 v[36:39], v[76:79], v[96:99], v[36:39]
    v_mfma_f32_16x16x32_bf16 v[40:43], v[80:83], v[96:99], v[40:43]
    ds_read_b128 v[64:67], v4 offset:25600
    ds_read_b128 v[68:71], v4 offset:26624
    ds_read_b128 v[72:75], v4 offset:27648
    ds_read_b128 v[76:79], v4 offset:28672
    ds_read_b128 v[80:83], v4 offset:29696
    s_waitcnt lgkmcnt(5)
    v_mfma_f32_16x16x32_bf16 v[24:27], v[44:47], v[100:103], v[24:27]
    v_mfma_f32_16x16x32_bf16 v[28:31], v[48:51], v[100:103], v[28:31]
    v_mfma_f32_16x16x32_bf16 v[32:35], v[52:55], v[100:103], v[32:35]
    v_mfma_f32_16x16x32_bf16 v[36:39], v[56:59], v[100:103], v[36:39]
    v_mfma_f32_16x16x32_bf16 v[40:43], v[60:63], v[100:103], v[40:43]
    ds_read_b128 v[44:47], v4 offset:30720
    ds_read_b128 v[48:51], v4 offset:31744
    ds_read_b128 v[52:55], v4 offset:32768
    ds_read_b128 v[56:59], v4 offset:33792
    ds_read_b128 v[60:63], v4 offset:34816
    s_waitcnt lgkmcnt(5)
    v_mfma_f32_16x16x32_bf16 v[24:27], v[64:67], v[104:107], v[24:27]
    v_mfma_f32_16x16x32_bf16 v[28:31], v[68:71], v[104:107], v[28:31]
    v_mfma_f32_16x16x32_bf16 v[32:35], v[72:75], v[104:107], v[32:35]
    v_mfma_f32_16x16x32_bf16 v[36:39], v[76:79], v[104:107], v[36:39]
    v_mfma_f32_16x16x32_bf16 v[40:43], v[80:83], v[104:107], v[40:43]
    ds_read_b128 v[64:67], v4 offset:35840
    ds_read_b128 v[68:71], v4 offset:36864
    ds_read_b128 v[72:75], v4 offset:37888
    ds_read_b128 v[76:79], v4 offset:38912
    ds_read_b128 v[80:83], v4 offset:39936
    s_waitcnt lgkmcnt(5)
    v_mfma_f32_16x16x32_bf16 v[24:27], v[44:47], v[108:111], v[24:27]
    v_mfma_f32_16x16x32_bf16 v[28:31], v[48:51], v[108:111], v[28:31]
    v_mfma_f32_16x16x32_bf16 v[32:35], v[52:55], v[108:111], v[32:35]
    v_mfma_f32_16x16x32_bf16 v[36:39], v[56:59], v[108:111], v[36:39]
    v_mfma_f32_16x16x32_bf16 v[40:43], v[60:63], v[108:111], v[40:43]
    ds_read_b128 v[44:47], v4 offset:40960
    ds_read_b128 v[48:51], v4 offset:41984
    ds_read_b128 v[52:55], v4 offset:43008
    ds_read_b128 v[56:59], v4 offset:44032
    ds_read_b128 v[60:63], v4 offset:45056
    s_waitcnt lgkmcnt(5)
    v_mfma_f32_16x16x32_bf16 v[24:27], v[64:67], v[112:115], v[24:27]
    v_mfma_f32_16x16x32_bf16 v[28:31], v[68:71], v[112:115], v[28:31]
    v_mfma_f32_16x16x32_bf16 v[32:35], v[72:75], v[112:115], v[32:35]
    v_mfma_f32_16x16x32_bf16 v[36:39], v[76:79], v[112:115], v[36:39]
    v_mfma_f32_16x16x32_bf16 v[40:43], v[80:83], v[112:115], v[40:43]
    ds_read_b128 v[64:67], v4 offset:46080
    ds_read_b128 v[68:71], v4 offset:47104
    ds_read_b128 v[72:75], v4 offset:48128
    ds_read_b128 v[76:79], v4 offset:49152
    ds_read_b128 v[80:83], v4 offset:50176
    s_waitcnt lgkmcnt(5)
    v_mfma_f32_16x16x32_bf16 v[24:27], v[44:47], v[116:119], v[24:27]
    v_mfma_f32_16x16x32_bf16 v[28:31], v[48:51], v[116:119], v[28:31]
    v_mfma_f32_16x16x32_bf16 v[32:35], v[52:55], v[116:119], v[32:35]
    v_mfma_f32_16x16x32_bf16 v[36:39], v[56:59], v[116:119], v[36:39]
    v_mfma_f32_16x16x32_bf16 v[40:43], v[60:63], v[116:119], v[40:43]
    s_waitcnt lgkmcnt(0)
    v_mfma_f32_16x16x32_bf16 v[24:27], v[64:67], v[120:123], v[24:27]
    v_mfma_f32_16x16x32_bf16 v[28:31], v[68:71], v[120:123], v[28:31]
    v_mfma_f32_16x16x32_bf16 v[32:35], v[72:75], v[120:123], v[32:35]
    v_mfma_f32_16x16x32_bf16 v[36:39], v[76:79], v[120:123], v[36:39]
    v_mfma_f32_16x16x32_bf16 v[40:43], v[80:83], v[120:123], v[40:43]
    s_cmp_lg_u32 s3, 7
    s_cbranch_scc1 pb_22
    s_and_b32 s59, s2, 3
    s_lshl_b32 s59, s59, 12
    s_add_u32 s59, s59, 26214400
    v_lshlrev_b32 v255, 8, v2
    buffer_load_dword v252, v255, s[32:35], s59 offen sc1
pb_22:
    s_mul_i32 s40, s60, 5120
    s_add_u32 s40, s40, 133120
    v_add_u32 v7, s40, v4
    s_cmp_eq_u32 s61, 0
    s_cbranch_scc1 wq1_23
    ds_write_b128 v7, v[24:27] offset:0
    ds_write_b128 v7, v[28:31] offset:1024
    ds_write_b128 v7, v[32:35] offset:2048
    ds_write_b128 v7, v[36:39] offset:3072
    ds_write_b128 v7, v[40:43] offset:4096
wq1_23:
    s_cmp_lg_u32 s3, 7
    s_cbranch_scc1 pc_24
    s_waitcnt vmcnt(0)
    v_cmp_gt_u32 vcc, 16, v252
    s_nop 0
    s_cmp_eq_u64 vcc, 0
    s_cbranch_scc1 pc_24
    s_cmp_lg_u32 s3, 7
    s_cbranch_scc1 wt_25
    s_and_b32 s59, s2, 3
    s_lshl_b32 s59, s59, 12
    s_add_u32 s59, s59, 26214400
    v_lshlrev_b32 v255, 8, v2
    s_mov_b32 s58, 40000
    s_cmp_lg_u32 s83, 0
    s_cbranch_scc1 polld_27
poll_26:
    buffer_load_dword v254, v255, s[32:35], s59 offen sc1
    s_waitcnt vmcnt(0)
    v_cmp_gt_u32 vcc, 16, v254
    s_nop 0
    s_cmp_eq_u64 vcc, 0
    s_cbranch_scc1 polld_27
    s_sub_u32 s58, s58, 1
    s_cmp_lg_u32 s58, 0
    s_cbranch_scc1 poll_26
    s_mov_b32 s83, 1
    v_mov_b32 v254, 1
    v_mov_b32 v255, 16
    buffer_store_dword v254, v255, s[36:39], 0 offen
polld_27:
wt_25:
pc_24:
    s_waitcnt lgkmcnt(0)
    s_barrier
    s_lshr_b32 s81, s2, 3
    s_and_b32 s80, s4, 3
    s_mul_i32 s80, s80, 2
    s_and_b32 s82, s81, 1
    s_add_u32 s80, s80, s82
    s_lshr_b32 s71, s4, 2
    s_mul_i32 s71, s71, 16
    s_lshr_b32 s81, s81, 1
    s_add_u32 s71, s71, s81
    s_and_b32 s68, s71, 3
    s_mul_i32 s68, s68, 5
    s_lshr_b32 s81, s71, 2
    s_add_u32 s68, s68, s81
    s_cmp_ge_u32 s68, 20
    s_cselect_b32 s81, 20, 0
    s_sub_u32 s68, s68, s81
    s_cmp_ge_u32 s72, 20
    s_cbranch_scc1 side_28
    s_cmp_ge_u32 s7, 30
    s_cbranch_scc1 wq2_31
    s_cmp_lg_u32 s61, 0
    s_cbranch_scc1 wq2_31
    ds_read_b128 v[44:47], v7 offset:0
    ds_read_b128 v[48:51], v7 offset:1024
    ds_read_b128 v[52:55], v7 offset:2048
    ds_read_b128 v[56:59], v7 offset:3072
    ds_read_b128 v[60:63], v7 offset:4096
    s_mul_i32 s41, s7, 205
    s_lshr_b32 s41, s41, 11
    s_mul_i32 s42, s41, 10
    s_sub_u32 s42, s7, s42
    s_lshl_b32 s42, s42, 6
    s_lshl_b32 s43, s60, 4
    s_add_u32 s42, s42, s43
    v_add_u32 v10, s42, v2
    v_mul_u32_u24 v11, 3277, v10
    v_lshrrev_b32 v11, 16, v11
    v_mul_u32_u24 v12, 20, v11
    v_sub_u32 v10, v10, v12
    s_cmp_eq_u32 s41, 0
    s_cselect_b32 s42, 48, 0
    s_cselect_b32 s43, 24, 16
    s_cmp_eq_u32 s41, 2
    s_cselect_b32 s42, 16, s42
    s_cselect_b32 s43, 20, s43
    v_add_u32 v12, s42, v10
    v_add_u32 v13, s43, v10
    v_cmp_gt_u32 vcc, 16, v10
    s_nop 1
    v_cndmask_b32 v10, v13, v12, vcc
    v_mul_u32_u24 v11, 80, v11
    v_add_u32 v10, v10, v11
    v_lshrrev_b32 v12, 1, v3
    v_mul_u32_u24 v12, 2560, v12
    v_add_u32 v10, v10, v12
    v_lshlrev_b32 v10, 4, v10
    v_and_b32 v12, 1, v3
    v_lshl_add_u32 v10, v12, 3, v10
    s_mul_i32 s40, s6, 409600
    s_add_u32 s40, s40, 20971520
    s_mov_b32 s42, 0x3b4ccccd
    v_mov_b32 v12, s42
    s_cmp_eq_u32 s6, 7
    s_cselect_b32 s43, 3, 99
    v_cmp_ne_u32 vcc, s43, v3
    s_nop 1
    v_cndmask_b32 v12, 0, v12, vcc
    s_mul_i32 s44, s6, 5
    s_waitcnt lgkmcnt(0)
    v_sub_f32 v16, v24, v44
    v_mul_f32 v16, s42, v16
    v_sub_f32 v17, v25, v45
    v_mul_f32 v17, s42, v17
    v_add_f32 v18, v26, v46
    v_mul_f32 v18, s42, v18
    v_add_f32 v19, v27, v47
    v_mul_f32 v19, s42, v19
    v_cvt_pk_bf16_f32 v20, v16, v17
    v_cvt_pk_bf16_f32 v21, v18, v19
    buffer_store_dwordx2 v[20:21], v10, s[32:35], s40 offen sc1
    s_add_u32 s40, s40, 81920
    v_sub_f32 v16, v28, v48
    v_mul_f32 v16, s42, v16
    v_sub_f32 v17, v29, v49
    v_mul_f32 v17, s42, v17
    v_add_f32 v18, v30, v50
    v_mul_f32 v18, s42, v18
    v_add_f32 v19, v31, v51
    v_mul_f32 v19, s42, v19
    v_cvt_pk_bf16_f32 v22, v16, v17
    v_cvt_pk_bf16_f32 v23, v18, v19
    buffer_store_dwordx2 v[22:23], v10, s[32:35], s40 offen sc1
    s_add_u32 s40, s40, 81920
    v_sub_f32 v16, v32, v52
    v_mul_f32 v16, s42, v16
    v_sub_f32 v17, v33, v53
    v_mul_f32 v17, s42, v17
    v_add_f32 v18, v34, v54
    v_mul_f32 v18, s42, v18
    v_add_f32 v19, v35, v55
    v_mul_f32 v19, s42, v19
    v_cvt_pk_bf16_f32 v20, v16, v17
    v_cvt_pk_bf16_f32 v21, v18, v19
    buffer_store_dwordx2 v[20:21], v10, s[32:35], s40 offen sc1
    s_add_u32 s40, s40, 81920
    v_sub_f32 v16, v36, v56
    v_mul_f32 v16, s42, v16
    v_sub_f32 v17, v37, v57
    v_mul_f32 v17, s42, v17
    v_add_f32 v18, v38, v58
    v_mul_f32 v18, s42, v18
    v_add_f32 v19, v39, v59
    v_mul_f32 v19, s42, v19
    v_cvt_pk_bf16_f32 v22, v16, v17
    v_cvt_pk_bf16_f32 v23, v18, v19
    buffer_store_dwordx2 v[22:23], v10, s[32:35], s40 offen sc1
    s_add_u32 s40, s40, 81920
    v_sub_f32 v16, v40, v60
    v_mul_f32 v16, s42, v16
    v_sub_f32 v17, v41, v61
    v_mul_f32 v17, s42, v17
    v_add_f32 v18, v42, v62
    v_mul_f32 v18, s42, v18
    v_add_f32 v19, v43, v63
    v_mul_f32 v19, v12, v19
    v_cvt_pk_bf16_f32 v20, v16, v17
    v_cvt_pk_bf16_f32 v21, v18, v19
    buffer_store_dwordx2 v[20:21], v10, s[32:35], s40 offen sc1
wq2_31:
    s_lshl_b32 s40, s62, 1
    v_add_u32 v8, s40, v3
    v_xor_b32 v9, v8, v2
    v_lshlrev_b32 v9, 4, v9
    v_lshl_add_u32 v9, v3, 8, v9
    v_xor_b32 v10, 64, v9
    s_lshl_b32 s40, s73, 14
    s_lshl_b32 s41, s3, 11
    s_add_u32 s40, s40, s41
    s_add_u32 s40, s40, 28835840
    s_add_u32 m0, s41, 81920
    s_nop 0
    buffer_load_dwordx4 v9, s[32:35], s40 offen sc1 lds
    buffer_load_dwordx4 v10, s[32:35], s40 offen offset:1024 sc1 lds
    v_lshrrev_b32 v140, 2, v2
    v_and_b32 v141, 3, v2
    v_lshl_add_u32 v141, v140, 3, v141
    v_add_u32 v141, s62, v141
    v_lshrrev_b32 v136, 3, v0
    s_mov_b32 s41, 40960
    v_mul_lo_u32 v136, v136, s41
    v_bfe_u32 v138, v0, 2, 1
    v_mul_u32_u24 v139, 3, v138
    v_xor_b32 v139, v139, v1
    v_and_b32 v137, 7, v139
    v_lshl_add_u32 v136, v137, 4, v136
    v_and_b32 v137, 3, v139
    v_lshlrev_b32 v137, 4, v137
    v_lshl_add_u32 v137, v138, 14, v137
    v_lshrrev_b32 v138, 3, v0
    v_lshl_add_u32 v137, v138, 6, v137
    s_lshl_b32 s40, s3, 10
    s_lshr_b32 s42, s3, 1
    s_lshr_b32 s43, s3, 2
    s_xor_b32 s42, s42, s43
    s_lshl_b32 s42, s42, 6
    v_lshlrev_b32 v138, 4, v139
    v_xor_b32 v138, s42, v138
    s_add_u32 s40, s40, 102400
    v_add_u32 v138, s40, v138
    v_lshrrev_b32 v141, 2, v141
    s_lshl_b32 s40, s63, 2
    v_add_u32 v140, s40, v3
    v_lshl_add_u32 v141, v141, 3, v140
    v_and_b32 v143, 3, v2
    v_lshl_add_u32 v139, v141, 3, v143
    v_lshrrev_b32 v144, 2, v2
    v_lshrrev_b32 v145, 3, v2
    v_xor_b32 v144, v144, v145
    v_lshlrev_b32 v144, 2, v144
    v_xor_b32 v139, v139, v144
    s_lshl_b32 s40, s61, 13
    s_add_u32 s42, s40, 102400
    v_lshl_add_u32 v139, v139, 4, s42
    v_xor_b32 v140, 512, v139
    v_mul_lo_u32 v141, v141, s41
    v_lshl_add_u32 v141, v143, 4, v141
    s_lshl_b32 s43, s63, 12
    s_add_u32 s43, s43, s40
    s_add_u32 s43, s43, 135168
    s_lshl_b32 s44, s62, 1
    s_add_u32 s45, s44, s43
    v_add_u32 v143, s45, v4
    s_lshl_b32 s45, s62, 9
    s_add_u32 s45, s45, s43
    v_add_u32 v144, s45, v4
    s_lshl_b32 s43, s63, 11
    s_add_u32 s43, s43, s40
    s_add_u32 s43, s43, 135168
    s_add_u32 s45, s44, s43
    v_add_u32 v145, s45, v4
    s_lshl_b32 s45, s62, 10
    s_add_u32 s45, s45, s43
    v_add_u32 v146, s45, v4
    v_xor_b32 v147, 2048, v146
    s_cmp_eq_u32 s73, 159
    s_cselect_b32 s40, 4, 99
    v_and_b32 v148, 4, v0
    v_cmp_ne_u32 vcc, s40, v148
    s_nop 1
    v_cndmask_b32 v148, 0, -1, vcc
    s_lshl_b32 s46, s73, 8
    s_add_u32 s47, s46, 34078720
    s_add_u32 s46, s46, 0
    s_mov_b32 s42, 26279936
    s_mov_b32 s43, 26284032
    s_mov_b32 s44, 26288128
    s_mov_b32 s45, 26292224
    s_mov_b32 s58, 40000
    s_mov_b32 s41, 0x80008000
    v_xor_b32 v64, s41, v180
    v_xor_b32 v65, s41, v181
    v_xor_b32 v66, s41, v182
    v_xor_b32 v67, s41, v183
    v_xor_b32 v68, s41, v184
    v_xor_b32 v69, s41, v185
    v_xor_b32 v70, s41, v186
    v_xor_b32 v71, s41, v187
    v_xor_b32 v72, s41, v188
    v_xor_b32 v73, s41, v189
    v_xor_b32 v74, s41, v190
    v_xor_b32 v75, s41, v191
    v_xor_b32 v76, s41, v192
    v_xor_b32 v77, s41, v193
    v_xor_b32 v78, s41, v194
    v_xor_b32 v79, s41, v195
    v_xor_b32 v80, s41, v204
    v_xor_b32 v81, s41, v205
    v_xor_b32 v82, s41, v206
    v_xor_b32 v83, s41, v207
    v_xor_b32 v84, s41, v208
    v_xor_b32 v85, s41, v209
    v_xor_b32 v86, s41, v210
    v_xor_b32 v87, s41, v211
    v_mul_u32_u24 v150, 2560, v3
    s_mul_i32 s48, s71, 80
    v_add3_u32 v150, v150, v2, s48
    v_lshlrev_b32 v150, 4, v150
    s_lshl_b32 s48, s60, 8
    v_add_u32 v149, s48, v150
    v_add_u32 v150, 1024, v150
    s_mov_b32 s51, 24248320
    s_add_u32 s50, s68, s61
    s_mul_i32 s50, s50, 163840
    s_add_u32 s50, s50, 20971520
    s_add_u32 s76, s68, s3
    s_mul_i32 s76, s76, 163840
    s_add_u32 s76, s76, 20971520
    s_mul_i32 s49, s61, 4096
    s_lshl_b32 s48, s60, 10
    s_add_u32 s49, s49, s48
    s_mul_i32 s77, s3, 4096
    s_barrier
    buffer_load_dwordx4 v[16:19], v137, s[32:35], s42 offen sc1
    buffer_load_dwordx4 v[20:23], v137, s[32:35], s43 offen sc1
    buffer_load_dwordx4 v[24:27], v137, s[32:35], s44 offen sc1
    buffer_load_dwordx4 v[28:31], v137, s[32:35], s45 offen sc1
    buffer_load_dwordx4 v[48:51], v136, s[32:35], s46 offen sc1
    buffer_load_dwordx4 v[52:55], v136, s[32:35], s46 offen offset:128 sc1
    s_lshl_b32 s41, s61, 7
    s_add_u32 s47, s47, s41
    s_mov_b32 s40, 0x36a3d70a
    v_mov_b32 v8, 0x3727c5ac
    s_waitcnt vmcnt(2)
    v_min3_u32 v9, v16, v17, v18
    v_min3_u32 v9, v9, v19, v20
    v_min3_u32 v9, v9, v21, v22
    v_min3_u32 v9, v9, v23, v24
    v_min3_u32 v9, v9, v25, v26
    v_min3_u32 v9, v9, v27, v28
    v_min3_u32 v9, v9, v29, v30
    v_min_u32 v9, v9, v31
    v_cmp_eq_u32 vcc, 0, v9
    s_nop 0
    s_cmp_lg_u64 vcc, 0
    s_cbranch_scc1 fvr_33
fvb_34:
    v_lshlrev_b32 v40, 16, v16
    v_and_b32 v41, 0xffff0000, v16
    v_lshlrev_b32 v42, 16, v17
    v_and_b32 v43, 0xffff0000, v17
    v_lshlrev_b32 v44, 16, v18
    v_and_b32 v45, 0xffff0000, v18
    v_lshlrev_b32 v46, 16, v19
    v_and_b32 v47, 0xffff0000, v19
    v_lshlrev_b32 v32, 16, v20
    v_and_b32 v33, 0xffff0000, v20
    v_lshlrev_b32 v34, 16, v21
    v_and_b32 v35, 0xffff0000, v21
    v_lshlrev_b32 v36, 16, v22
    v_and_b32 v37, 0xffff0000, v22
    v_lshlrev_b32 v38, 16, v23
    v_and_b32 v39, 0xffff0000, v23
    v_add_f32 v40, v40, v32
    v_add_f32 v41, v41, v33
    v_add_f32 v42, v42, v34
    v_add_f32 v43, v43, v35
    v_add_f32 v44, v44, v36
    v_add_f32 v45, v45, v37
    v_add_f32 v46, v46, v38
    v_add_f32 v47, v47, v39
    v_lshlrev_b32 v32, 16, v24
    v_and_b32 v33, 0xffff0000, v24
    v_lshlrev_b32 v34, 16, v25
    v_and_b32 v35, 0xffff0000, v25
    v_lshlrev_b32 v36, 16, v26
    v_and_b32 v37, 0xffff0000, v26
    v_lshlrev_b32 v38, 16, v27
    v_and_b32 v39, 0xffff0000, v27
    v_add_f32 v40, v40, v32
    v_add_f32 v41, v41, v33
    v_add_f32 v42, v42, v34
    v_add_f32 v43, v43, v35
    v_add_f32 v44, v44, v36
    v_add_f32 v45, v45, v37
    v_add_f32 v46, v46, v38
    v_add_f32 v47, v47, v39
    v_lshlrev_b32 v32, 16, v28
    v_and_b32 v33, 0xffff0000, v28
    v_lshlrev_b32 v34, 16, v29
    v_and_b32 v35, 0xffff0000, v29
    v_lshlrev_b32 v36, 16, v30
    v_and_b32 v37, 0xffff0000, v30
    v_lshlrev_b32 v38, 16, v31
    v_and_b32 v39, 0xffff0000, v31
    v_add_f32 v40, v40, v32
    v_add_f32 v41, v41, v33
    v_add_f32 v42, v42, v34
    v_add_f32 v43, v43, v35
    v_add_f32 v44, v44, v36
    v_add_f32 v45, v45, v37
    v_add_f32 v46, v46, v38
    v_add_f32 v47, v47, v39
    v_add_f32_dpp v40, v40, v40 row_half_mirror row_mask:0xf bank_mask:0xf
    v_add_f32_dpp v41, v41, v41 row_half_mirror row_mask:0xf bank_mask:0xf
    v_add_f32_dpp v42, v42, v42 row_half_mirror row_mask:0xf bank_mask:0xf
    v_add_f32_dpp v43, v43, v43 row_half_mirror row_mask:0xf bank_mask:0xf
    v_add_f32_dpp v44, v44, v44 row_half_mirror row_mask:0xf bank_mask:0xf
    v_add_f32_dpp v45, v45, v45 row_half_mirror row_mask:0xf bank_mask:0xf
    v_add_f32_dpp v46, v46, v46 row_half_mirror row_mask:0xf bank_mask:0xf
    v_add_f32_dpp v47, v47, v47 row_half_mirror row_mask:0xf bank_mask:0xf
    v_fma_f32 v40, v40, s40, v8
    v_fma_f32 v41, v41, s40, v8
    v_fma_f32 v42, v42, s40, v8
    v_fma_f32 v43, v43, s40, v8
    v_fma_f32 v44, v44, s40, v8
    v_fma_f32 v45, v45, s40, v8
    v_fma_f32 v46, v46, s40, v8
    v_fma_f32 v47, v47, s40, v8
    v_rsq_f32 v40, v40
    v_rsq_f32 v41, v41
    v_rsq_f32 v42, v42
    v_rsq_f32 v43, v43
    v_rsq_f32 v44, v44
    v_rsq_f32 v45, v45
    v_rsq_f32 v46, v46
    v_rsq_f32 v47, v47
    s_waitcnt vmcnt(0)
    v_min3_u32 v9, v48, v49, v50
    v_min3_u32 v9, v9, v51, v52
    v_min3_u32 v9, v9, v53, v54
    v_min_u32 v9, v9, v55
    v_cmp_eq_u32 vcc, 0, v9
    s_nop 0
    s_cmp_lg_u64 vcc, 0
    s_cbranch_scc1 fdr_35
fdb_36:
    ds_write_b128 v138, v[48:51] offset:16384
    v_lshlrev_b32 v16, 16, v48
    v_and_b32 v17, 0xffff0000, v48
    v_lshlrev_b32 v18, 16, v49
    v_and_b32 v19, 0xffff0000, v49
    v_lshlrev_b32 v20, 16, v50
    v_and_b32 v21, 0xffff0000, v50
    v_lshlrev_b32 v22, 16, v51
    v_and_b32 v23, 0xffff0000, v51
    v_mul_f32 v16, v16, v40
    v_mul_f32 v17, v17, v41
    v_mul_f32 v18, v18, v42
    v_mul_f32 v19, v19, v43
    v_mul_f32 v20, v20, v44
    v_mul_f32 v21, v21, v45
    v_mul_f32 v22, v22, v46
    v_mul_f32 v23, v23, v47
    v_cvt_pk_bf16_f32 v56, v16, v17
    v_cvt_pk_bf16_f32 v57, v18, v19
    v_cvt_pk_bf16_f32 v58, v20, v21
    v_cvt_pk_bf16_f32 v59, v22, v23
    ds_write_b128 v138, v[56:59] offset:0
    ds_write_b128 v138, v[52:55] offset:24576
    v_lshlrev_b32 v16, 16, v52
    v_and_b32 v17, 0xffff0000, v52
    v_lshlrev_b32 v18, 16, v53
    v_and_b32 v19, 0xffff0000, v53
    v_lshlrev_b32 v20, 16, v54
    v_and_b32 v21, 0xffff0000, v54
    v_lshlrev_b32 v22, 16, v55
    v_and_b32 v23, 0xffff0000, v55
    v_mul_f32 v16, v16, v40
    v_mul_f32 v17, v17, v41
    v_mul_f32 v18, v18, v42
    v_mul_f32 v19, v19, v43
    v_mul_f32 v20, v20, v44
    v_mul_f32 v21, v21, v45
    v_mul_f32 v22, v22, v46
    v_mul_f32 v23, v23, v47
    v_cvt_pk_bf16_f32 v60, v16, v17
    v_cvt_pk_bf16_f32 v61, v18, v19
    v_cvt_pk_bf16_f32 v62, v20, v21
    v_cvt_pk_bf16_f32 v63, v22, v23
    v_and_b32 v60, v60, v148
    v_and_b32 v61, v61, v148
    v_and_b32 v62, v62, v148
    v_and_b32 v63, v63, v148
    ds_write_b128 v138, v[60:63] offset:8192
    v_xor_b32 v8, 64, v139
    v_and_b32 v10, 0xfffffbff, v139
    v_xor_b32 v11, 64, v10
    v_xor_b32 v12, 512, v10
    v_xor_b32 v13, 512, v11
    s_waitcnt lgkmcnt(0)
    s_barrier
    ds_read_b128 v[104:107], v10
    ds_read_b128 v[108:111], v11
    ds_read_b128 v[16:19], v10 offset:1024
    ds_read_b128 v[20:23], v11 offset:1024
    ds_read_b128 v[112:115], v12
    ds_read_b128 v[116:119], v13
    ds_read_b128 v[24:27], v12 offset:1024
    ds_read_b128 v[28:31], v13 offset:1024
    ds_read_b128 v[48:51], v139 offset:16384
    ds_read_b128 v[52:55], v8 offset:16384
    ds_read_b128 v[244:247], v244
    ds_read_b128 v[248:251], v248
    s_cmp_lg_u32 s3, 6
    s_cbranch_scc1 arr_37
    s_and_b32 s59, s2, 15
    s_lshl_b32 s59, s59, 8
    s_add_u32 s59, s59, 26230784
    v_lshlrev_b32 v255, 12, v1
    v_mov_b32 v254, 1
    s_mov_b64 exec, 15
    buffer_atomic_add v254, v255, s[32:35], s59 offen sc1
    s_mov_b64 exec, -1
arr_37:
    s_cmp_lg_u32 s62, 0
    s_cbranch_scc1 s1t_38
    s_waitcnt lgkmcnt(10)
    v_mfma_f32_16x16x32_bf16 v[120:123], v[104:107], v[164:167], 0
    v_mfma_f32_16x16x32_bf16 v[128:131], v[108:111], v[164:167], 0
    v_mfma_f32_16x16x32_bf16 v[120:123], v[108:111], v[180:183], v[120:123]
    v_mfma_f32_16x16x32_bf16 v[128:131], v[104:107], v[64:67], v[128:131]
    s_waitcnt lgkmcnt(8)
    v_mfma_f32_16x16x32_bf16 v[124:127], v[16:19], v[164:167], 0
    v_mfma_f32_16x16x32_bf16 v[132:135], v[20:23], v[164:167], 0
    v_mfma_f32_16x16x32_bf16 v[124:127], v[20:23], v[180:183], v[124:127]
    v_mfma_f32_16x16x32_bf16 v[132:135], v[16:19], v[64:67], v[132:135]
    s_waitcnt lgkmcnt(6)
    v_mfma_f32_16x16x32_bf16 v[120:123], v[112:115], v[168:171], v[120:123]
    v_mfma_f32_16x16x32_bf16 v[128:131], v[116:119], v[168:171], v[128:131]
    v_mfma_f32_16x16x32_bf16 v[120:123], v[116:119], v[184:187], v[120:123]
    v_mfma_f32_16x16x32_bf16 v[128:131], v[112:115], v[68:71], v[128:131]
    s_waitcnt lgkmcnt(4)
    v_mfma_f32_16x16x32_bf16 v[124:127], v[24:27], v[168:171], v[124:127]
    v_mfma_f32_16x16x32_bf16 v[132:135], v[28:31], v[168:171], v[132:135]
    v_mfma_f32_16x16x32_bf16 v[124:127], v[28:31], v[184:187], v[124:127]
    v_mfma_f32_16x16x32_bf16 v[132:135], v[24:27], v[68:71], v[132:135]
    s_nop 0
    s_branch s1u_39
s1t_38:
    s_waitcnt lgkmcnt(10)
    v_mfma_f32_16x16x32_bf16 v[120:123], v[104:107], v[172:175], 0
    v_mfma_f32_16x16x32_bf16 v[128:131], v[108:111], v[172:175], 0
    v_mfma_f32_16x16x32_bf16 v[120:123], v[108:111], v[188:191], v[120:123]
    v_mfma_f32_16x16x32_bf16 v[128:131], v[104:107], v[72:75], v[128:131]
    s_waitcnt lgkmcnt(8)
    v_mfma_f32_16x16x32_bf16 v[124:127], v[16:19], v[172:175], 0
    v_mfma_f32_16x16x32_bf16 v[132:135], v[20:23], v[172:175], 0
    v_mfma_f32_16x16x32_bf16 v[124:127], v[20:23], v[188:191], v[124:127]
    v_mfma_f32_16x16x32_bf16 v[132:135], v[16:19], v[72:75], v[132:135]
    s_waitcnt lgkmcnt(6)
    v_mfma_f32_16x16x32_bf16 v[120:123], v[112:115], v[176:179], v[120:123]
    v_mfma_f32_16x16x32_bf16 v[128:131], v[116:119], v[176:179], v[128:131]
    v_mfma_f32_16x16x32_bf16 v[120:123], v[116:119], v[192:195], v[120:123]
    v_mfma_f32_16x16x32_bf16 v[128:131], v[112:115], v[76:79], v[128:131]
    s_waitcnt lgkmcnt(4)
    v_mfma_f32_16x16x32_bf16 v[124:127], v[24:27], v[176:179], v[124:127]
    v_mfma_f32_16x16x32_bf16 v[132:135], v[28:31], v[176:179], v[132:135]
    v_mfma_f32_16x16x32_bf16 v[124:127], v[28:31], v[192:195], v[124:127]
    v_mfma_f32_16x16x32_bf16 v[132:135], v[24:27], v[76:79], v[132:135]
s1u_39:
    s_nop 1
    v_mul_f32 v16, v120, v212
    v_mul_f32 v24, v128, v212
    v_mul_f32 v17, v121, v213
    v_mul_f32 v25, v129, v213
    v_mul_f32 v18, v122, v214
    v_mul_f32 v26, v130, v214
    v_mul_f32 v19, v123, v215
    v_mul_f32 v27, v131, v215
    v_mul_f32 v20, v124, v216
    v_mul_f32 v28, v132, v216
    v_mul_f32 v21, v125, v217
    v_mul_f32 v29, v133, v217
    v_mul_f32 v22, v126, v218
    v_mul_f32 v30, v134, v218
    v_mul_f32 v23, v127, v219
    v_mul_f32 v31, v135, v219
    v_fma_f32 v16, v128, v220, v16
    v_fma_f32 v24, -v120, v220, v24
    v_fma_f32 v17, v129, v221, v17
    v_fma_f32 v25, -v121, v221, v25
    v_fma_f32 v18, v130, v222, v18
    v_fma_f32 v26, -v122, v222, v26
    v_fma_f32 v19, v131, v223, v19
    v_fma_f32 v27, -v123, v223, v27
    v_fma_f32 v20, v132, v224, v20
    v_fma_f32 v28, -v124, v224, v28
    v_fma_f32 v21, v133, v225, v21
    v_fma_f32 v29, -v125, v225, v29
    v_fma_f32 v22, v134, v226, v22
    v_fma_f32 v30, -v126, v226, v30
    v_fma_f32 v23, v135, v227, v23
    v_fma_f32 v31, -v127, v227, v31
    v_cvt_pk_bf16_f32 v104, v16, v17
    v_cvt_pk_bf16_f32 v105, v18, v19
    v_cvt_pk_bf16_f32 v106, v20, v21
    v_cvt_pk_bf16_f32 v107, v22, v23
    v_cvt_pk_bf16_f32 v108, v24, v25
    v_cvt_pk_bf16_f32 v109, v26, v27
    v_cvt_pk_bf16_f32 v110, v28, v29
    v_cvt_pk_bf16_f32 v111, v30, v31
    s_waitcnt lgkmcnt(0)
    v_mfma_f32_16x16x32_bf16 v[120:123], v[196:199], v[104:107], 0
    v_mfma_f32_16x16x32_bf16 v[128:131], v[196:199], v[108:111], 0
    v_mfma_f32_16x16x32_bf16 v[120:123], v[204:207], v[108:111], v[120:123]
    v_mfma_f32_16x16x32_bf16 v[128:131], v[80:83], v[104:107], v[128:131]
    v_mfma_f32_16x16x32_bf16 v[124:127], v[200:203], v[104:107], 0
    v_mfma_f32_16x16x32_bf16 v[132:135], v[200:203], v[108:111], 0
    v_mfma_f32_16x16x32_bf16 v[124:127], v[208:211], v[108:111], v[124:127]
    v_mfma_f32_16x16x32_bf16 v[132:135], v[84:87], v[104:107], v[132:135]
    v_lshlrev_b32 v88, 16, v244
    v_and_b32 v96, 0xffff0000, v244
    v_lshlrev_b32 v89, 16, v245
    v_and_b32 v97, 0xffff0000, v245
    v_lshlrev_b32 v90, 16, v246
    v_and_b32 v98, 0xffff0000, v246
    v_lshlrev_b32 v91, 16, v247
    v_and_b32 v99, 0xffff0000, v247
    v_lshlrev_b32 v92, 16, v248
    v_and_b32 v100, 0xffff0000, v248
    v_lshlrev_b32 v93, 16, v249
    v_and_b32 v101, 0xffff0000, v249
    v_lshlrev_b32 v94, 16, v250
    v_and_b32 v102, 0xffff0000, v250
    v_lshlrev_b32 v95, 16, v251
    v_and_b32 v103, 0xffff0000, v251
    v_mov_b32 v32, 0
    v_mov_b32 v33, 0
    v_mov_b32 v34, 0
    v_mov_b32 v35, 0
    s_lshl_b32 s40, s73, 3
    s_add_u32 s40, s40, s3
    s_lshl_b32 s40, s40, 11
    s_add_u32 s40, s40, 5242880
    buffer_store_dwordx4 v[32:35], v4, s[32:35], s40 offen sc1
    buffer_store_dwordx4 v[32:35], v4, s[32:35], s40 offen offset:1024 sc1
    s_cmp_lg_u32 s3, 7
    s_cbranch_scc1 p1_40
    s_and_b32 s59, s2, 3
    s_lshl_b32 s59, s59, 12
    s_add_u32 s59, s59, 26230784
    v_lshlrev_b32 v255, 8, v2
    buffer_load_dword v252, v255, s[32:35], s59 offen sc1
p1_40:
    v_mul_f32 v16, v120, v88
    v_mul_f32 v24, v128, v88
    v_mul_f32 v17, v121, v89
    v_mul_f32 v25, v129, v89
    v_mul_f32 v18, v122, v90
    v_mul_f32 v26, v130, v90
    v_mul_f32 v19, v123, v91
    v_mul_f32 v27, v131, v91
    v_mul_f32 v20, v124, v92
    v_mul_f32 v28, v132, v92
    v_mul_f32 v21, v125, v93
    v_mul_f32 v29, v133, v93
    v_mul_f32 v22, v126, v94
    v_mul_f32 v30, v134, v94
    v_mul_f32 v23, v127, v95
    v_mul_f32 v31, v135, v95
    v_fma_f32 v16, -v128, v96, v16
    v_fma_f32 v24, v120, v96, v24
    v_fma_f32 v17, -v129, v97, v17
    v_fma_f32 v25, v121, v97, v25
    v_fma_f32 v18, -v130, v98, v18
    v_fma_f32 v26, v122, v98, v26
    v_fma_f32 v19, -v131, v99, v19
    v_fma_f32 v27, v123, v99, v27
    v_fma_f32 v20, -v132, v100, v20
    v_fma_f32 v28, v124, v100, v28
    v_fma_f32 v21, -v133, v101, v21
    v_fma_f32 v29, v125, v101, v29
    v_fma_f32 v22, -v134, v102, v22
    v_fma_f32 v30, v126, v102, v30
    v_fma_f32 v23, -v135, v103, v23
    v_fma_f32 v31, v127, v103, v31
    v_cvt_pk_bf16_f32 v112, v16, v17
    v_cvt_pk_bf16_f32 v113, v18, v19
    v_cvt_pk_bf16_f32 v114, v20, v21
    v_cvt_pk_bf16_f32 v115, v22, v23
    v_cvt_pk_bf16_f32 v116, v24, v25
    v_cvt_pk_bf16_f32 v117, v26, v27
    v_cvt_pk_bf16_f32 v118, v28, v29
    v_cvt_pk_bf16_f32 v119, v30, v31
    v_mfma_f32_16x16x32_bf16 v[120:123], v[112:115], v[196:199], 0
    s_nop 0
    v_mfma_f32_16x16x32_bf16 v[128:131], v[116:119], v[196:199], 0
    v_mfma_f32_16x16x32_bf16 v[120:123], v[116:119], v[80:83], v[120:123]
    v_mfma_f32_16x16x32_bf16 v[128:131], v[112:115], v[204:207], v[128:131]
    v_mfma_f32_16x16x32_bf16 v[124:127], v[112:115], v[200:203], 0
    v_mfma_f32_16x16x32_bf16 v[132:135], v[116:119], v[200:203], 0
    v_mfma_f32_16x16x32_bf16 v[124:127], v[116:119], v[84:87], v[124:127]
    v_mfma_f32_16x16x32_bf16 v[132:135], v[112:115], v[208:211], v[132:135]
    s_nop 2
    v_mul_f32 v16, v120, v228
    v_mul_f32 v24, v128, v228
    v_mul_f32 v17, v121, v229
    v_mul_f32 v25, v129, v229
    v_mul_f32 v18, v122, v230
    v_mul_f32 v26, v130, v230
    v_mul_f32 v19, v123, v231
    v_mul_f32 v27, v131, v231
    v_mul_f32 v20, v124, v232
    v_mul_f32 v28, v132, v232
    v_mul_f32 v21, v125, v233
    v_mul_f32 v29, v133, v233
    v_mul_f32 v22, v126, v234
    v_mul_f32 v30, v134, v234
    v_mul_f32 v23, v127, v235
    v_mul_f32 v31, v135, v235
    v_fma_f32 v16, -v128, v236, v16
    v_fma_f32 v24, v120, v236, v24
    v_fma_f32 v17, -v129, v237, v17
    v_fma_f32 v25, v121, v237, v25
    v_fma_f32 v18, -v130, v238, v18
    v_fma_f32 v26, v122, v238, v26
    v_fma_f32 v19, -v131, v239, v19
    v_fma_f32 v27, v123, v239, v27
    v_fma_f32 v20, -v132, v240, v20
    v_fma_f32 v28, v124, v240, v28
    v_fma_f32 v21, -v133, v241, v21
    v_fma_f32 v29, v125, v241, v29
    v_fma_f32 v22, -v134, v242, v22
    v_fma_f32 v30, v126, v242, v30
    v_fma_f32 v23, -v135, v243, v23
    v_fma_f32 v31, v127, v243, v31
    v_cvt_pk_bf16_f32 v32, v16, v17
    v_cvt_pk_bf16_f32 v33, v18, v19
    ds_write_b64 v145, v[32:33] offset:0
    v_cvt_pk_bf16_f32 v34, v24, v25
    v_cvt_pk_bf16_f32 v35, v26, v27
    ds_write_b64 v145, v[34:35] offset:1024
    v_cvt_pk_bf16_f32 v36, v20, v21
    v_cvt_pk_bf16_f32 v37, v22, v23
    ds_write_b64 v145, v[36:37] offset:4096
    v_cvt_pk_bf16_f32 v38, v28, v29
    v_cvt_pk_bf16_f32 v39, v30, v31
    ds_write_b64 v145, v[38:39] offset:5120
    v_lshlrev_b32 v16, 16, v48
    v_and_b32 v17, 0xffff0000, v48
    v_lshlrev_b32 v18, 16, v49
    v_and_b32 v19, 0xffff0000, v49
    v_lshlrev_b32 v20, 16, v50
    v_and_b32 v21, 0xffff0000, v50
    v_lshlrev_b32 v22, 16, v51
    v_and_b32 v23, 0xffff0000, v51
    v_lshlrev_b32 v24, 16, v52
    v_and_b32 v25, 0xffff0000, v52
    v_lshlrev_b32 v26, 16, v53
    v_and_b32 v27, 0xffff0000, v53
    v_lshlrev_b32 v28, 16, v54
    v_and_b32 v29, 0xffff0000, v54
    v_lshlrev_b32 v30, 16, v55
    v_and_b32 v31, 0xffff0000, v55
    s_waitcnt lgkmcnt(0)
    s_barrier
    ds_read_b128 v[104:107], v146
    ds_read_b128 v[108:111], v146 offset:1024
    ds_read_b128 v[112:115], v147
    ds_read_b128 v[116:119], v147 offset:1024
    s_cmp_lg_u32 s3, 7
    s_cbranch_scc1 pb_41
    s_and_b32 s59, s2, 3
    s_lshl_b32 s59, s59, 12
    s_add_u32 s59, s59, 26230784
    v_lshlrev_b32 v255, 8, v2
    buffer_load_dword v252, v255, s[32:35], s59 offen sc1
pb_41:
    s_waitcnt lgkmcnt(2)
    v_mfma_f32_16x16x32_bf16 v[120:123], v[164:167], v[104:107], v[16:19]
    v_mfma_f32_16x16x32_bf16 v[128:131], v[164:167], v[108:111], v[24:27]
    v_mfma_f32_16x16x32_bf16 v[120:123], v[64:67], v[108:111], v[120:123]
    v_mfma_f32_16x16x32_bf16 v[128:131], v[180:183], v[104:107], v[128:131]
    v_mfma_f32_16x16x32_bf16 v[124:127], v[172:175], v[104:107], v[20:23]
    v_mfma_f32_16x16x32_bf16 v[132:135], v[172:175], v[108:111], v[28:31]
    v_mfma_f32_16x16x32_bf16 v[124:127], v[72:75], v[108:111], v[124:127]
    v_mfma_f32_16x16x32_bf16 v[132:135], v[188:191], v[104:107], v[132:135]
    s_waitcnt lgkmcnt(0)
    v_mfma_f32_16x16x32_bf16 v[120:123], v[168:171], v[112:115], v[120:123]
    v_mfma_f32_16x16x32_bf16 v[128:131], v[168:171], v[116:119], v[128:131]
    v_mfma_f32_16x16x32_bf16 v[120:123], v[68:71], v[116:119], v[120:123]
    v_mfma_f32_16x16x32_bf16 v[128:131], v[184:187], v[112:115], v[128:131]
    v_mfma_f32_16x16x32_bf16 v[124:127], v[176:179], v[112:115], v[124:127]
    v_mfma_f32_16x16x32_bf16 v[132:135], v[176:179], v[116:119], v[132:135]
    v_mfma_f32_16x16x32_bf16 v[124:127], v[76:79], v[116:119], v[124:127]
    v_mfma_f32_16x16x32_bf16 v[132:135], v[192:195], v[112:115], v[132:135]
    s_nop 2
    v_cvt_pk_bf16_f32 v32, v120, v121
    v_cvt_pk_bf16_f32 v33, v122, v123
    s_nop 1
    v_cvt_pk_bf16_f32 v34, v124, v125
    v_cvt_pk_bf16_f32 v35, v126, v127
    v_cvt_pk_bf16_f32 v36, v128, v129
    v_cvt_pk_bf16_f32 v37, v130, v131
    v_cvt_pk_bf16_f32 v38, v132, v133
    v_cvt_pk_bf16_f32 v39, v134, v135
    s_lshl_b32 s40, s73, 1
    s_add_u32 s40, s40, s61
    s_cmp_lg_u32 s40, 319
    s_cbranch_scc1 nyq2_42
    v_mov_b32 v36, v52
    v_mov_b32 v37, v53
    v_mov_b32 v38, v54
    v_mov_b32 v39, v55
nyq2_42:
    v_max_u32 v32, 1, v32
    v_max_u32 v33, 1, v33
    v_max_u32 v34, 1, v34
    v_max_u32 v35, 1, v35
    v_max_u32 v36, 1, v36
    v_max_u32 v37, 1, v37
    v_max_u32 v38, 1, v38
    v_max_u32 v39, 1, v39
    buffer_store_dwordx4 v[32:35], v141, s[32:35], s47 offen sc1
    buffer_store_dwordx4 v[36:39], v141, s[32:35], s47 offen offset:64 sc1
    s_lshl_b32 s64, s80, 3
    s_add_u32 s64, s64, s3
    s_mul_i32 s65, s3, 6144
    s_add_u32 s65, s65, 102400
    v_lshrrev_b32 v112, 5, v1
    v_lshlrev_b32 v112, 5, v112
    v_xor_b32 v112, v112, v4
    v_lshrrev_b32 v113, 2, v2
    v_lshl_add_u32 v113, v3, 3, v113
    v_lshlrev_b32 v113, 6, v113
    v_and_b32 v114, 3, v2
    v_lshl_add_u32 v113, v114, 3, v113
    v_and_b32 v114, 1, v3
    v_lshl_add_u32 v113, v114, 5, v113
    v_add_u32 v113, s65, v113
    v_xor_b32 v114, 32, v113
    v_add_u32 v115, 40960, v4
    s_cmp_eq_u32 s71, 19
    s_cselect_b32 s40, 3, 99
    v_mov_b32 v116, 0xffff
    v_cmp_ne_u32 vcc, s40, v3
    s_nop 1
    v_cndmask_b32 v116, v116, -1, vcc
    v_lshrrev_b32 v117, 1, v3
    v_lshl_add_u32 v117, v117, 4, v2
    v_lshlrev_b32 v117, 2, v117
    v_lshrrev_b32 v8, 2, v0
    v_mul_u32_u24 v9, 781, v8
    v_lshrrev_b32 v9, 14, v9
    v_mul_u32_u24 v10, 21, v9
    v_sub_u32 v8, v8, v10
    v_lshlrev_b32 v10, 4, v9
    v_subrev_u32 v11, 12, v8
    v_cmp_eq_u32 vcc, 20, v8
    s_nop 1
    v_cndmask_b32 v11, v11, 0, vcc
    v_add_u32 v11, 128, v11
    v_cmp_gt_u32 vcc, 16, v8
    s_nop 1
    v_cndmask_b32 v11, v11, v8, vcc
    v_add_u32 v10, v10, v11
    v_and_b32 v11, 3, v0
    v_lshl_add_u32 v10, v10, 2, v11
    v_lshlrev_b32 v10, 2, v10
    v_min_u32 v10, 4092, v10
    v_add_u32 v118, 102400, v10
    v_lshrrev_b32 v8, 2, v2
    v_and_b32 v9, 1, v8
    v_cmp_eq_u32 vcc, 1, v9
    v_mov_b32 v10, 0x358637bd
    v_mov_b32 v11, 0xff800000
    v_cndmask_b32 v119, v10, 0, vcc
    v_cndmask_b32 v120, v10, v11, vcc
    v_cndmask_b32 v121, 1.0, 0, vcc
    v_cmp_eq_u32 vcc, 3, v8
    v_mov_b32 v10, 0x3b4ccccd
    s_nop 0
    v_cndmask_b32 v122, 1.0, 0, vcc
    v_cndmask_b32 v123, 0, v10, vcc
    v_lshlrev_b32 v8, 2, v3
    v_sub_u32 v8, v2, v8
    v_mov_b32 v10, 0x3f80
    v_mov_b32 v11, 0x3f800000
    v_cmp_eq_u32 vcc, 0, v8
    s_nop 1
    v_cndmask_b32 v124, 0, v10, vcc
    v_cmp_eq_u32 vcc, 1, v8
    s_nop 1
    v_cndmask_b32 v124, v124, v11, vcc
    v_cmp_eq_u32 vcc, 2, v8
    s_nop 1
    v_cndmask_b32 v125, 0, v10, vcc
    v_cmp_eq_u32 vcc, 3, v8
    s_nop 1
    v_cndmask_b32 v125, v125, v11, vcc
    v_mov_b32 v126, 0
    v_mov_b32 v127, 0
    v_mov_b32 v128, 0
    v_mov_b32 v129, 0
    v_mov_b32 v130, v124
    v_mov_b32 v131, v125
    v_lshrrev_b32 v8, 3, v1
    v_mul_u32_u24 v8, 1792, v8
    v_and_b32 v9, 7, v1
    v_lshl_add_u32 v132, v9, 4, v8
    s_lshl_b32 s40, s3, 8
    v_add_u32 v132, s40, v132
    v_lshrrev_b32 v8, 5, v1
    v_lshl_add_u32 v8, v8, 3, v9
    s_lshl_b32 s40, s3, 4
    v_add_u32 v8, s40, v8
    v_mul_u32_u24 v9, 781, v8
    v_lshrrev_b32 v9, 14, v9
    v_mul_u32_u24 v10, 21, v9
    v_sub_u32 v8, v8, v10
    v_add_u32 v10, 48, v8
    v_cmp_gt_u32 vcc, 16, v8
    s_nop 1
    v_cndmask_b32 v8, v10, v8, vcc
    v_lshlrev_b32 v8, 4, v8
    v_lshlrev_b32 v10, 8, v9
    v_mov_b32 v11, 520
    v_cmp_eq_u32 vcc, 4, v9
    s_nop 1
    v_cndmask_b32 v10, v10, v11, vcc
    v_mov_b32 v11, 2048
    v_cmp_lt_u32 vcc, 4, v9
    s_nop 1
    v_cndmask_b32 v10, v10, v11, vcc
    v_add_u32 v8, v8, v10
    v_and_b32 v9, 1, v3
    v_lshl_add_u32 v8, v9, 2, v8
    v_add_u32 v133, 151552, v8
    v_add_u32 v134, 151552, v4
    v_min_u32 v8, 4, v2
    v_lshl_add_u32 v8, v3, 4, v8
    v_lshlrev_b32 v8, 4, v8
    v_add_u32 v135, 152576, v8
    v_mov_b32 v8, 0
    v_lshlrev_b32 v9, 2, v0
    v_add_u32 v9, 151552, v9
    ds_write_b32 v9, v8
    v_bfe_u32 v8, v2, 2, 1
    v_mul_u32_u24 v8, 20480, v8
    v_lshrrev_b32 v9, 3, v2
    v_lshl_add_u32 v8, v9, 6, v8
    v_and_b32 v9, 3, v2
    v_lshl_add_u32 v8, v9, 4, v8
    s_mul_i32 s40, s71, 5
    v_add_u32 v9, s40, v3
    v_lshrrev_b32 v10, 1, v9
    v_lshl_add_u32 v136, v10, 8, v8
    v_and_b32 v10, 1, v9
    v_lshl_add_u32 v136, v10, 3, v136
    s_add_u32 s40, s40, 4
    s_lshr_b32 s41, s40, 1
    s_lshl_b32 s41, s41, 8
    s_and_b32 s40, s40, 1
    s_lshl_b32 s40, s40, 3
    s_add_u32 s40, s40, s41
    v_add_u32 v137, s40, v8
    v_lshlrev_b32 v138, 3, v2
    v_lshl_add_u32 v138, v3, 8, v138
    s_cmp_lg_u32 s3, 7
    s_cbranch_scc1 pc_43
    s_waitcnt vmcnt(2)
    v_cmp_gt_u32 vcc, 16, v252
    s_nop 0
    s_cmp_eq_u64 vcc, 0
    s_cbranch_scc1 pc_43
    s_cmp_lg_u32 s3, 7
    s_cbranch_scc1 wt_44
    s_and_b32 s59, s2, 3
    s_lshl_b32 s59, s59, 12
    s_add_u32 s59, s59, 26230784
    v_lshlrev_b32 v255, 8, v2
    s_mov_b32 s58, 40000
    s_cmp_lg_u32 s83, 0
    s_cbranch_scc1 polld_46
poll_45:
    buffer_load_dword v254, v255, s[32:35], s59 offen sc1
    s_waitcnt vmcnt(0)
    v_cmp_gt_u32 vcc, 16, v254
    s_nop 0
    s_cmp_eq_u64 vcc, 0
    s_cbranch_scc1 polld_46
    s_sub_u32 s58, s58, 1
    s_cmp_lg_u32 s58, 0
    s_cbranch_scc1 poll_45
    s_mov_b32 s83, 2
    v_mov_b32 v254, 2
    v_mov_b32 v255, 16
    buffer_store_dword v254, v255, s[36:39], 0 offen
polld_46:
wt_44:
pc_43:
    s_waitcnt vmcnt(0) lgkmcnt(0)
    s_barrier
    s_cmp_lg_u32 s3, 6
    s_cbranch_scc1 arr_47
    s_and_b32 s59, s2, 15
    s_lshl_b32 s59, s59, 8
    s_add_u32 s59, s59, 37715968
    v_lshlrev_b32 v255, 12, v1
    v_mov_b32 v254, 1
    s_mov_b64 exec, 15
    buffer_atomic_add v254, v255, s[32:35], s59 offen sc1
    s_mov_b64 exec, -1
arr_47:
    s_barrier
    s_cmp_ge_u32 s50, s51
    s_cselect_b32 s48, 3276800, 0
    s_sub_u32 s50, s50, s48
    s_add_u32 m0, s49, 0
    s_nop 0
    buffer_load_dwordx4 v149, s[32:35], s50 offen sc1 lds
    s_add_u32 s50, s50, 327680
    s_cmp_ge_u32 s50, s51
    s_cselect_b32 s48, 3276800, 0
    s_sub_u32 s50, s50, s48
    s_add_u32 m0, s49, 8192
    s_nop 0
    buffer_load_dwordx4 v149, s[32:35], s50 offen sc1 lds
    s_add_u32 s50, s50, 327680
    s_cmp_ge_u32 s50, s51
    s_cselect_b32 s48, 3276800, 0
    s_sub_u32 s50, s50, s48
    s_add_u32 m0, s49, 16384
    s_nop 0
    buffer_load_dwordx4 v149, s[32:35], s50 offen sc1 lds
    s_add_u32 s50, s50, 327680
    s_cmp_ge_u32 s50, s51
    s_cselect_b32 s48, 3276800, 0
    s_sub_u32 s50, s50, s48
    s_add_u32 m0, s49, 24576
    s_nop 0
    buffer_load_dwordx4 v149, s[32:35], s50 offen sc1 lds
    s_add_u32 s50, s50, 327680
    s_cmp_ge_u32 s50, s51
    s_cselect_b32 s48, 3276800, 0
    s_sub_u32 s50, s50, s48
    s_add_u32 m0, s49, 32768
    s_nop 0
    buffer_load_dwordx4 v149, s[32:35], s50 offen sc1 lds
    s_add_u32 s50, s50, 327680
    s_cmp_ge_u32 s50, s51
    s_cselect_b32 s48, 3276800, 0
    s_sub_u32 s50, s50, s48
    s_add_u32 m0, s49, 40960
    s_nop 0
    buffer_load_dwordx4 v149, s[32:35], s50 offen sc1 lds
    s_add_u32 s50, s50, 327680
    s_cmp_ge_u32 s50, s51
    s_cselect_b32 s48, 3276800, 0
    s_sub_u32 s50, s50, s48
    s_add_u32 m0, s49, 49152
    s_nop 0
    buffer_load_dwordx4 v149, s[32:35], s50 offen sc1 lds
    s_add_u32 s50, s50, 327680
    s_cmp_ge_u32 s50, s51
    s_cselect_b32 s48, 3276800, 0
    s_sub_u32 s50, s50, s48
    s_add_u32 m0, s49, 57344
    s_nop 0
    buffer_load_dwordx4 v149, s[32:35], s50 offen sc1 lds
    s_add_u32 s50, s50, 327680
    s_cmp_ge_u32 s50, s51
    s_cselect_b32 s48, 3276800, 0
    s_sub_u32 s50, s50, s48
    s_add_u32 m0, s49, 65536
    s_nop 0
    buffer_load_dwordx4 v149, s[32:35], s50 offen sc1 lds
    s_add_u32 s50, s50, 327680
    s_cmp_ge_u32 s50, s51
    s_cselect_b32 s48, 3276800, 0
    s_sub_u32 s50, s50, s48
    s_add_u32 m0, s49, 73728
    s_nop 0
    buffer_load_dwordx4 v149, s[32:35], s50 offen sc1 lds
    s_add_u32 s50, s50, 327680
    s_branch join_29
side_28:
    s_cmp_ge_u32 s7, 30
    s_cbranch_scc1 wq2_49
    s_cmp_lg_u32 s61, 0
    s_cbranch_scc1 wq2_49
    ds_read_b128 v[44:47], v7 offset:0
    ds_read_b128 v[48:51], v7 offset:1024
    ds_read_b128 v[52:55], v7 offset:2048
    ds_read_b128 v[56:59], v7 offset:3072
    ds_read_b128 v[60:63], v7 offset:4096
    s_mul_i32 s41, s7, 205
    s_lshr_b32 s41, s41, 11
    s_mul_i32 s42, s41, 10
    s_sub_u32 s42, s7, s42
    s_lshl_b32 s42, s42, 6
    s_lshl_b32 s43, s60, 4
    s_add_u32 s42, s42, s43
    v_add_u32 v10, s42, v2
    v_mul_u32_u24 v11, 3277, v10
    v_lshrrev_b32 v11, 16, v11
    v_mul_u32_u24 v12, 20, v11
    v_sub_u32 v10, v10, v12
    s_cmp_eq_u32 s41, 0
    s_cselect_b32 s42, 48, 0
    s_cselect_b32 s43, 24, 16
    s_cmp_eq_u32 s41, 2
    s_cselect_b32 s42, 16, s42
    s_cselect_b32 s43, 20, s43
    v_add_u32 v12, s42, v10
    v_add_u32 v13, s43, v10
    v_cmp_gt_u32 vcc, 16, v10
    s_nop 1
    v_cndmask_b32 v10, v13, v12, vcc
    v_mul_u32_u24 v11, 80, v11
    v_add_u32 v10, v10, v11
    v_lshrrev_b32 v12, 1, v3
    v_mul_u32_u24 v12, 2560, v12
    v_add_u32 v10, v10, v12
    v_lshlrev_b32 v10, 4, v10
    v_and_b32 v12, 1, v3
    v_lshl_add_u32 v10, v12, 3, v10
    s_mul_i32 s40, s6, 409600
    s_add_u32 s40, s40, 20971520
    s_mov_b32 s42, 0x3b4ccccd
    v_mov_b32 v12, s42
    s_cmp_eq_u32 s6, 7
    s_cselect_b32 s43, 3, 99
    v_cmp_ne_u32 vcc, s43, v3
    s_nop 1
    v_cndmask_b32 v12, 0, v12, vcc
    s_mul_i32 s44, s6, 5
    s_waitcnt lgkmcnt(0)
    v_sub_f32 v16, v24, v44
    v_mul_f32 v16, s42, v16
    v_sub_f32 v17, v25, v45
    v_mul_f32 v17, s42, v17
    v_add_f32 v18, v26, v46
    v_mul_f32 v18, s42, v18
    v_add_f32 v19, v27, v47
    v_mul_f32 v19, s42, v19
    v_cvt_pk_bf16_f32 v20, v16, v17
    v_cvt_pk_bf16_f32 v21, v18, v19
    buffer_store_dwordx2 v[20:21], v10, s[32:35], s40 offen sc1
    s_add_u32 s40, s40, 81920
    v_sub_f32 v16, v28, v48
    v_mul_f32 v16, s42, v16
    v_sub_f32 v17, v29, v49
    v_mul_f32 v17, s42, v17
    v_add_f32 v18, v30, v50
    v_mul_f32 v18, s42, v18
    v_add_f32 v19, v31, v51
    v_mul_f32 v19, s42, v19
    v_cvt_pk_bf16_f32 v22, v16, v17
    v_cvt_pk_bf16_f32 v23, v18, v19
    buffer_store_dwordx2 v[22:23], v10, s[32:35], s40 offen sc1
    s_add_u32 s40, s40, 81920
    v_sub_f32 v16, v32, v52
    v_mul_f32 v16, s42, v16
    v_sub_f32 v17, v33, v53
    v_mul_f32 v17, s42, v17
    v_add_f32 v18, v34, v54
    v_mul_f32 v18, s42, v18
    v_add_f32 v19, v35, v55
    v_mul_f32 v19, s42, v19
    v_cvt_pk_bf16_f32 v20, v16, v17
    v_cvt_pk_bf16_f32 v21, v18, v19
    buffer_store_dwordx2 v[20:21], v10, s[32:35], s40 offen sc1
    s_add_u32 s40, s40, 81920
    v_sub_f32 v16, v36, v56
    v_mul_f32 v16, s42, v16
    v_sub_f32 v17, v37, v57
    v_mul_f32 v17, s42, v17
    v_add_f32 v18, v38, v58
    v_mul_f32 v18, s42, v18
    v_add_f32 v19, v39, v59
    v_mul_f32 v19, s42, v19
    v_cvt_pk_bf16_f32 v22, v16, v17
    v_cvt_pk_bf16_f32 v23, v18, v19
    buffer_store_dwordx2 v[22:23], v10, s[32:35], s40 offen sc1
    s_add_u32 s40, s40, 81920
    v_sub_f32 v16, v40, v60
    v_mul_f32 v16, s42, v16
    v_sub_f32 v17, v41, v61
    v_mul_f32 v17, s42, v17
    v_add_f32 v18, v42, v62
    v_mul_f32 v18, s42, v18
    v_add_f32 v19, v43, v63
    v_mul_f32 v19, v12, v19
    v_cvt_pk_bf16_f32 v20, v16, v17
    v_cvt_pk_bf16_f32 v21, v18, v19
    buffer_store_dwordx2 v[20:21], v10, s[32:35], s40 offen sc1
wq2_49:
    s_waitcnt vmcnt(0) lgkmcnt(0)
    s_barrier
    s_cmp_lg_u32 s3, 6
    s_cbranch_scc1 arr_51
    s_and_b32 s59, s2, 15
    s_lshl_b32 s59, s59, 8
    s_add_u32 s59, s59, 26230784
    v_lshlrev_b32 v255, 12, v1
    v_mov_b32 v254, 1
    s_mov_b64 exec, 15
    buffer_atomic_add v254, v255, s[32:35], s59 offen sc1
    s_mov_b64 exec, -1
arr_51:
    s_sub_u32 s66, s72, 20
    s_cmp_ge_u32 s66, 10
    s_cbranch_scc1 side2_30
    v_lshrrev_b32 v8, 3, v1
    v_add_u32 v9, 8, v8
    s_lshl_b32 s40, s66, 1
    s_add_u32 s40, s40, s63
    s_lshl_b32 s40, s40, 5
    s_add_u32 s40, s40, s62
    v_lshrrev_b32 v11, 2, v8
    v_and_b32 v6, 3, v8
    v_lshl_add_u32 v6, v11, 3, v6
    v_add_u32 v6, s40, v6
    s_lshl_b32 s40, s66, 1
    s_add_u32 s40, s40, s63
    s_lshl_b32 s40, s40, 5
    s_add_u32 s40, s40, s62
    v_lshrrev_b32 v11, 2, v9
    v_and_b32 v7, 3, v9
    v_lshl_add_u32 v7, v11, 3, v7
    v_add_u32 v7, s40, v7
    s_movk_i32 s41, 1280
    v_mul_lo_u32 v6, v6, s41
    v_mul_lo_u32 v7, v7, s41
    v_and_b32 v9, 6, v8
    v_and_b32 v10, 7, v1
    v_xor_b32 v9, v9, v10
    v_lshl_add_u32 v6, v9, 4, v6
    v_lshl_add_u32 v7, v9, 4, v7
    s_mul_i32 s52, s61, 640
    s_mul_i32 s53, s3, 10240
    s_add_u32 s53, s53, 51200
    s_add_u32 m0, s53, 0
    s_nop 0
    buffer_load_dwordx4 v6, s[24:27], s52 offen offset:0 lds
    s_add_u32 m0, s53, 1024
    s_nop 0
    buffer_load_dwordx4 v7, s[24:27], s52 offen offset:0 lds
    s_add_u32 m0, s53, 1920
    s_nop 0
    buffer_load_dwordx4 v6, s[24:27], s52 offen offset:128 lds
    s_add_u32 m0, s53, 2944
    s_nop 0
    buffer_load_dwordx4 v7, s[24:27], s52 offen offset:128 lds
    s_add_u32 m0, s53, 3840
    s_nop 0
    buffer_load_dwordx4 v6, s[24:27], s52 offen offset:256 lds
    s_add_u32 m0, s53, 4864
    s_nop 0
    buffer_load_dwordx4 v7, s[24:27], s52 offen offset:256 lds
    s_add_u32 m0, s53, 5760
    s_nop 0
    buffer_load_dwordx4 v6, s[24:27], s52 offen offset:384 lds
    s_add_u32 m0, s53, 6784
    s_nop 0
    buffer_load_dwordx4 v7, s[24:27], s52 offen offset:384 lds
    s_add_u32 m0, s53, 7680
    s_nop 0
    buffer_load_dwordx4 v6, s[24:27], s52 offen offset:512 lds
    s_add_u32 m0, s53, 8704
    s_nop 0
    buffer_load_dwordx4 v7, s[24:27], s52 offen offset:512 lds
    v_lshrrev_b32 v10, 3, v1
    v_and_b32 v11, 7, v1
    s_lshl_b32 s42, s60, 3
    v_and_b32 v22, 2, v10
    v_cvt_f32_u32 v22, v22
    v_subrev_f32 v22, 1.0, v22
    v_lshrrev_b32 v9, 1, v11
    v_lshlrev_b32 v9, 8, v9
    v_lshl_add_u32 v9, v10, 4, v9
    v_and_b32 v8, 1, v11
    v_lshl_add_u32 v9, v8, 3, v9
    s_mul_i32 s43, s61, 5120
    s_lshl_b32 s44, s63, 10
    s_add_u32 s43, s43, s44
    s_lshl_b32 s44, s62, 5
    s_add_u32 s43, s43, s44
    v_add_u32 v9, s43, v9
    v_xor_b32 v11, v11, v10
    v_lshlrev_b32 v11, 4, v11
    v_lshl_add_u32 v10, v10, 7, v11
    s_mul_i32 s43, s61, 10240
    s_lshl_b32 s44, s60, 10
    s_add_u32 s43, s43, s44
    s_add_u32 s43, s43, 102400
    v_add_u32 v10, s43, v10
    v_lshlrev_b32 v8, 1, v3
    s_lshr_b32 s44, s62, 2
    v_add_u32 v8, s44, v8
    v_and_b32 v11, 7, v2
    v_xor_b32 v8, v8, v11
    v_lshlrev_b32 v8, 4, v8
    v_lshl_add_u32 v8, v2, 7, v8
    s_mul_i32 s43, s61, 20480
    s_mul_i32 s44, s63, 10240
    s_add_u32 s43, s43, s44
    s_add_u32 s43, s43, 102400
    v_add_u32 v8, s43, v8
    v_and_b32 v6, 6, v2
    v_xor_b32 v6, v6, v3
    v_lshlrev_b32 v6, 4, v6
    v_lshl_add_u32 v6, v2, 7, v6
    s_mul_i32 s41, s3, 10240
    s_add_u32 s41, s41, 51200
    v_add_u32 v6, s41, v6
    v_xor_b32 v7, 64, v6
    s_waitcnt vmcnt(0)
    ds_read_b128 v[84:87], v6 offset:0
    ds_read_b128 v[88:91], v7 offset:0
    ds_read_b128 v[92:95], v6 offset:2048
    ds_read_b128 v[96:99], v7 offset:2048
    ds_read_b128 v[100:103], v6 offset:4096
    ds_read_b128 v[104:107], v7 offset:4096
    ds_read_b128 v[108:111], v6 offset:6144
    ds_read_b128 v[112:115], v7 offset:6144
    ds_read_b128 v[116:119], v6 offset:8192
    ds_read_b128 v[120:123], v7 offset:8192
    s_waitcnt lgkmcnt(0)
    s_barrier
    ds_read_b128 v[44:47], v4 offset:0
    ds_read_b128 v[48:51], v4 offset:1024
    ds_read_b128 v[52:55], v4 offset:2048
    ds_read_b128 v[56:59], v4 offset:3072
    ds_read_b128 v[60:63], v4 offset:4096
    ds_read_b128 v[64:67], v4 offset:5120
    ds_read_b128 v[68:71], v4 offset:6144
    ds_read_b128 v[72:75], v4 offset:7168
    ds_read_b128 v[76:79], v4 offset:8192
    ds_read_b128 v[80:83], v4 offset:9216
    s_waitcnt lgkmcnt(5)
    v_mfma_f32_16x16x32_bf16 v[24:27], v[84:87], v[44:47], 0
    v_mfma_f32_16x16x32_bf16 v[28:31], v[84:87], v[48:51], 0
    v_mfma_f32_16x16x32_bf16 v[32:35], v[84:87], v[52:55], 0
    v_mfma_f32_16x16x32_bf16 v[36:39], v[84:87], v[56:59], 0
    v_mfma_f32_16x16x32_bf16 v[40:43], v[84:87], v[60:63], 0
    ds_read_b128 v[44:47], v4 offset:10240
    ds_read_b128 v[48:51], v4 offset:11264
    ds_read_b128 v[52:55], v4 offset:12288
    ds_read_b128 v[56:59], v4 offset:13312
    ds_read_b128 v[60:63], v4 offset:14336
    s_waitcnt lgkmcnt(5)
    v_mfma_f32_16x16x32_bf16 v[24:27], v[88:91], v[64:67], v[24:27]
    v_mfma_f32_16x16x32_bf16 v[28:31], v[88:91], v[68:71], v[28:31]
    v_mfma_f32_16x16x32_bf16 v[32:35], v[88:91], v[72:75], v[32:35]
    v_mfma_f32_16x16x32_bf16 v[36:39], v[88:91], v[76:79], v[36:39]
    v_mfma_f32_16x16x32_bf16 v[40:43], v[88:91], v[80:83], v[40:43]
    ds_read_b128 v[64:67], v4 offset:15360
    ds_read_b128 v[68:71], v4 offset:16384
    ds_read_b128 v[72:75], v4 offset:17408
    ds_read_b128 v[76:79], v4 offset:18432
    ds_read_b128 v[80:83], v4 offset:19456
    s_waitcnt lgkmcnt(5)
    v_mfma_f32_16x16x32_bf16 v[24:27], v[92:95], v[44:47], v[24:27]
    v_mfma_f32_16x16x32_bf16 v[28:31], v[92:95], v[48:51], v[28:31]
    v_mfma_f32_16x16x32_bf16 v[32:35], v[92:95], v[52:55], v[32:35]
    v_mfma_f32_16x16x32_bf16 v[36:39], v[92:95], v[56:59], v[36:39]
    v_mfma_f32_16x16x32_bf16 v[40:43], v[92:95], v[60:63], v[40:43]
    ds_read_b128 v[44:47], v4 offset:20480
    ds_read_b128 v[48:51], v4 offset:21504
    ds_read_b128 v[52:55], v4 offset:22528
    ds_read_b128 v[56:59], v4 offset:23552
    ds_read_b128 v[60:63], v4 offset:24576
    s_waitcnt lgkmcnt(5)
    v_mfma_f32_16x16x32_bf16 v[24:27], v[96:99], v[64:67], v[24:27]
    v_mfma_f32_16x16x32_bf16 v[28:31], v[96:99], v[68:71], v[28:31]
    v_mfma_f32_16x16x32_bf16 v[32:35], v[96:99], v[72:75], v[32:35]
    v_mfma_f32_16x16x32_bf16 v[36:39], v[96:99], v[76:79], v[36:39]
    v_mfma_f32_16x16x32_bf16 v[40:43], v[96:99], v[80:83], v[40:43]
    ds_read_b128 v[64:67], v4 offset:25600
    ds_read_b128 v[68:71], v4 offset:26624
    ds_read_b128 v[72:75], v4 offset:27648
    ds_read_b128 v[76:79], v4 offset:28672
    ds_read_b128 v[80:83], v4 offset:29696
    s_waitcnt lgkmcnt(5)
    v_mfma_f32_16x16x32_bf16 v[24:27], v[100:103], v[44:47], v[24:27]
    v_mfma_f32_16x16x32_bf16 v[28:31], v[100:103], v[48:51], v[28:31]
    v_mfma_f32_16x16x32_bf16 v[32:35], v[100:103], v[52:55], v[32:35]
    v_mfma_f32_16x16x32_bf16 v[36:39], v[100:103], v[56:59], v[36:39]
    v_mfma_f32_16x16x32_bf16 v[40:43], v[100:103], v[60:63], v[40:43]
    ds_read_b128 v[44:47], v4 offset:30720
    ds_read_b128 v[48:51], v4 offset:31744
    ds_read_b128 v[52:55], v4 offset:32768
    ds_read_b128 v[56:59], v4 offset:33792
    ds_read_b128 v[60:63], v4 offset:34816
    s_waitcnt lgkmcnt(5)
    v_mfma_f32_16x16x32_bf16 v[24:27], v[104:107], v[64:67], v[24:27]
    v_mfma_f32_16x16x32_bf16 v[28:31], v[104:107], v[68:71], v[28:31]
    v_mfma_f32_16x16x32_bf16 v[32:35], v[104:107], v[72:75], v[32:35]
    v_mfma_f32_16x16x32_bf16 v[36:39], v[104:107], v[76:79], v[36:39]
    v_mfma_f32_16x16x32_bf16 v[40:43], v[104:107], v[80:83], v[40:43]
    ds_read_b128 v[64:67], v4 offset:35840
    ds_read_b128 v[68:71], v4 offset:36864
    ds_read_b128 v[72:75], v4 offset:37888
    ds_read_b128 v[76:79], v4 offset:38912
    ds_read_b128 v[80:83], v4 offset:39936
    s_waitcnt lgkmcnt(5)
    v_mfma_f32_16x16x32_bf16 v[24:27], v[108:111], v[44:47], v[24:27]
    v_mfma_f32_16x16x32_bf16 v[28:31], v[108:111], v[48:51], v[28:31]
    v_mfma_f32_16x16x32_bf16 v[32:35], v[108:111], v[52:55], v[32:35]
    v_mfma_f32_16x16x32_bf16 v[36:39], v[108:111], v[56:59], v[36:39]
    v_mfma_f32_16x16x32_bf16 v[40:43], v[108:111], v[60:63], v[40:43]
    ds_read_b128 v[44:47], v4 offset:40960
    ds_read_b128 v[48:51], v4 offset:41984
    ds_read_b128 v[52:55], v4 offset:43008
    ds_read_b128 v[56:59], v4 offset:44032
    ds_read_b128 v[60:63], v4 offset:45056
    s_waitcnt lgkmcnt(5)
    v_mfma_f32_16x16x32_bf16 v[24:27], v[112:115], v[64:67], v[24:27]
    v_mfma_f32_16x16x32_bf16 v[28:31], v[112:115], v[68:71], v[28:31]
    v_mfma_f32_16x16x32_bf16 v[32:35], v[112:115], v[72:75], v[32:35]
    v_mfma_f32_16x16x32_bf16 v[36:39], v[112:115], v[76:79], v[36:39]
    v_mfma_f32_16x16x32_bf16 v[40:43], v[112:115], v[80:83], v[40:43]
    ds_read_b128 v[64:67], v4 offset:46080
    ds_read_b128 v[68:71], v4 offset:47104
    ds_read_b128 v[72:75], v4 offset:48128
    ds_read_b128 v[76:79], v4 offset:49152
    ds_read_b128 v[80:83], v4 offset:50176
    s_waitcnt lgkmcnt(5)
    v_mfma_f32_16x16x32_bf16 v[24:27], v[116:119], v[44:47], v[24:27]
    v_mfma_f32_16x16x32_bf16 v[28:31], v[116:119], v[48:51], v[28:31]
    v_mfma_f32_16x16x32_bf16 v[32:35], v[116:119], v[52:55], v[32:35]
    v_mfma_f32_16x16x32_bf16 v[36:39], v[116:119], v[56:59], v[36:39]
    v_mfma_f32_16x16x32_bf16 v[40:43], v[116:119], v[60:63], v[40:43]
    s_waitcnt lgkmcnt(0)
    v_mfma_f32_16x16x32_bf16 v[24:27], v[120:123], v[64:67], v[24:27]
    v_mfma_f32_16x16x32_bf16 v[28:31], v[120:123], v[68:71], v[28:31]
    v_mfma_f32_16x16x32_bf16 v[32:35], v[120:123], v[72:75], v[32:35]
    v_mfma_f32_16x16x32_bf16 v[36:39], v[120:123], v[76:79], v[36:39]
    v_mfma_f32_16x16x32_bf16 v[40:43], v[120:123], v[80:83], v[40:43]
    s_mul_i32 s64, s6, 102400
    s_mul_i32 s65, s66, 10240
    s_add_u32 s64, s64, s65
    s_add_u32 s64, s64, 24248320
    ds_write_b128 v8, v[24:27] offset:0
    ds_write_b128 v8, v[28:31] offset:2048
    ds_write_b128 v8, v[32:35] offset:4096
    ds_write_b128 v8, v[36:39] offset:6144
    ds_write_b128 v8, v[40:43] offset:8192
    s_add_u32 s46, s64, 4096
    s_cmp_ge_u32 s60, 2
    s_cselect_b32 s46, 2146435072, s46
    s_cselect_b32 s47, 0, 1.0
    s_waitcnt lgkmcnt(0)
    s_barrier
    ds_read_b128 v[44:47], v10 offset:0
    ds_read_b128 v[56:59], v10 offset:20480
    ds_read_b128 v[48:51], v10 offset:4096
    ds_read_b128 v[60:63], v10 offset:24576
    ds_read_b128 v[52:55], v10 offset:8192
    ds_read_b128 v[64:67], v10 offset:28672
    s_waitcnt lgkmcnt(4)
    v_fma_f32 v44, v22, v56, v44
    v_fma_f32 v45, v22, v57, v45
    v_fma_f32 v46, v22, v58, v46
    v_fma_f32 v47, v22, v59, v47
    v_cvt_pk_bf16_f32 v12, v44, v45
    v_cvt_pk_bf16_f32 v13, v46, v47
    buffer_store_dwordx2 v[12:13], v9, s[32:35], s64 offen offset:0 sc1
    s_waitcnt lgkmcnt(2)
    v_fma_f32 v48, v22, v60, v48
    v_fma_f32 v49, v22, v61, v49
    v_fma_f32 v50, v22, v62, v50
    v_fma_f32 v51, v22, v63, v51
    v_cvt_pk_bf16_f32 v14, v48, v49
    v_cvt_pk_bf16_f32 v15, v50, v51
    buffer_store_dwordx2 v[14:15], v9, s[32:35], s64 offen offset:2048 sc1
    s_waitcnt lgkmcnt(0)
    v_fma_f32 v52, v22, v64, v52
    v_fma_f32 v53, v22, v65, v53
    v_fma_f32 v54, v22, v66, v54
    v_fma_f32 v55, v22, v67, v55
    v_cvt_pk_bf16_f32 v16, v52, v53
    v_cvt_pk_bf16_f32 v17, v54, v55
    buffer_store_dwordx2 v[16:17], v9, s[32:35], s46 offen sc1
    s_branch side3_52
side2_30:
    s_sub_u32 s42, s66, 10
    s_lshl_b32 s42, s42, 3
    s_add_u32 s42, s42, s6
    s_lshl_b32 s42, s42, 3
    s_add_u32 s42, s42, s3
    v_lshl_add_u32 v10, v3, 2, 1
    v_mul_u32_u24 v9, 40960, v3
    v_mov_b32 v29, 0x3f353f35
gc_53:
    s_mul_i32 s40, s42, 1639
    s_lshr_b32 s40, s40, 16
    s_mul_i32 s41, s40, 40
    s_sub_u32 s41, s42, s41
    s_lshl_b32 s43, s41, 4
    v_add_u32 v8, s43, v2
    v_mul_u32_u24 v13, 3277, v8
    v_lshrrev_b32 v13, 16, v13
    v_mul_u32_u24 v14, 20, v13
    v_sub_u32 v14, v8, v14
    v_add_u32 v15, 64, v14
    v_add_u32 v24, 28, v14
    v_cmp_gt_u32 vcc, 16, v14
    s_nop 1
    v_cndmask_b32 v14, v24, v15, vcc
    v_mul_u32_u24 v13, 80, v13
    v_add_u32 v14, v14, v13
    v_lshl_add_u32 v14, v14, 4, v9
    v_cvt_f32_u32 v8, v8
    v_mul_f32 v8, 0x3acccccd, v8
    s_lshl_b32 s43, s40, 4
    v_add_u32 v11, s43, v10
    v_cvt_f32_u32 v12, v11
    v_cmp_eq_u32 vcc, 0x13d, v11
    s_mul_i32 s43, s40, 163840
    s_add_u32 s43, s43, 20971520
    v_mul_f32 v16, v12, v8
    v_fract_f32 v16, v16
    v_add_f32 v17, v16, v8
    v_fma_f32 v18, 2.0, v8, v16
    v_add_f32 v19, v18, v8
    v_sin_f32 v20, -v16
    v_sin_f32 v21, -v17
    v_sin_f32 v22, -v18
    v_sin_f32 v23, -v19
    v_cos_f32 v16, v16
    v_cos_f32 v17, v17
    v_cos_f32 v18, v18
    v_cos_f32 v19, v19
    v_cvt_pk_bf16_f32 v32, v16, v20
    v_cvt_pk_bf16_f32 v33, v17, v21
    v_cvt_pk_bf16_f32 v34, v18, v22
    v_cvt_pk_bf16_f32 v35, v19, v23
    v_and_b32 v28, 0x8000, v35
    v_or_b32 v28, v28, v29
    v_cndmask_b32 v35, v35, v28, vcc
    buffer_store_dwordx4 v[32:35], v14, s[32:35], s43 offen sc1
    s_add_u32 s42, s42, 128
    s_cmp_lt_u32 s42, 800
    s_cbranch_scc1 gc_53
side3_52:
    s_waitcnt lgkmcnt(0)
    s_cmp_lg_u32 s3, 7
    s_cbranch_scc1 wt_54
    s_and_b32 s59, s2, 3
    s_lshl_b32 s59, s59, 12
    s_add_u32 s59, s59, 26230784
    v_lshlrev_b32 v255, 8, v2
    s_mov_b32 s58, 40000
    s_cmp_lg_u32 s83, 0
    s_cbranch_scc1 polld_56
poll_55:
    buffer_load_dword v254, v255, s[32:35], s59 offen sc1
    s_waitcnt vmcnt(0)
    v_cmp_gt_u32 vcc, 16, v254
    s_nop 0
    s_cmp_eq_u64 vcc, 0
    s_cbranch_scc1 polld_56
    s_sub_u32 s58, s58, 1
    s_cmp_lg_u32 s58, 0
    s_cbranch_scc1 poll_55
    s_mov_b32 s83, 2
    v_mov_b32 v254, 2
    v_mov_b32 v255, 16
    buffer_store_dword v254, v255, s[36:39], 0 offen
polld_56:
wt_54:
    s_barrier
    v_mul_u32_u24 v150, 2560, v3
    s_mul_i32 s48, s71, 80
    v_add3_u32 v150, v150, v2, s48
    v_lshlrev_b32 v150, 4, v150
    s_lshl_b32 s48, s60, 8
    v_add_u32 v149, s48, v150
    v_add_u32 v150, 1024, v150
    s_mov_b32 s51, 24248320
    s_add_u32 s50, s68, s61
    s_mul_i32 s50, s50, 163840
    s_add_u32 s50, s50, 20971520
    s_add_u32 s76, s68, s3
    s_mul_i32 s76, s76, 163840
    s_add_u32 s76, s76, 20971520
    s_mul_i32 s49, s61, 4096
    s_lshl_b32 s48, s60, 10
    s_add_u32 s49, s49, s48
    s_mul_i32 s77, s3, 4096
    s_cmp_ge_u32 s50, s51
    s_cselect_b32 s48, 3276800, 0
    s_sub_u32 s50, s50, s48
    s_add_u32 m0, s49, 0
    s_nop 0
    buffer_load_dwordx4 v149, s[32:35], s50 offen sc1 lds
    s_add_u32 s50, s50, 327680
    s_cmp_ge_u32 s50, s51
    s_cselect_b32 s48, 3276800, 0
    s_sub_u32 s50, s50, s48
    s_add_u32 m0, s49, 8192
    s_nop 0
    buffer_load_dwordx4 v149, s[32:35], s50 offen sc1 lds
    s_add_u32 s50, s50, 327680
    s_cmp_ge_u32 s50, s51
    s_cselect_b32 s48, 3276800, 0
    s_sub_u32 s50, s50, s48
    s_add_u32 m0, s49, 16384
    s_nop 0
    buffer_load_dwordx4 v149, s[32:35], s50 offen sc1 lds
    s_add_u32 s50, s50, 327680
    s_cmp_ge_u32 s50, s51
    s_cselect_b32 s48, 3276800, 0
    s_sub_u32 s50, s50, s48
    s_add_u32 m0, s49, 24576
    s_nop 0
    buffer_load_dwordx4 v149, s[32:35], s50 offen sc1 lds
    s_add_u32 s50, s50, 327680
    s_cmp_ge_u32 s50, s51
    s_cselect_b32 s48, 3276800, 0
    s_sub_u32 s50, s50, s48
    s_add_u32 m0, s49, 32768
    s_nop 0
    buffer_load_dwordx4 v149, s[32:35], s50 offen sc1 lds
    s_add_u32 s50, s50, 327680
    s_cmp_ge_u32 s50, s51
    s_cselect_b32 s48, 3276800, 0
    s_sub_u32 s50, s50, s48
    s_add_u32 m0, s49, 40960
    s_nop 0
    buffer_load_dwordx4 v149, s[32:35], s50 offen sc1 lds
    s_add_u32 s50, s50, 327680
    s_cmp_ge_u32 s50, s51
    s_cselect_b32 s48, 3276800, 0
    s_sub_u32 s50, s50, s48
    s_add_u32 m0, s49, 49152
    s_nop 0
    buffer_load_dwordx4 v149, s[32:35], s50 offen sc1 lds
    s_add_u32 s50, s50, 327680
    s_cmp_ge_u32 s50, s51
    s_cselect_b32 s48, 3276800, 0
    s_sub_u32 s50, s50, s48
    s_add_u32 m0, s49, 57344
    s_nop 0
    buffer_load_dwordx4 v149, s[32:35], s50 offen sc1 lds
    s_add_u32 s50, s50, 327680
    s_cmp_ge_u32 s50, s51
    s_cselect_b32 s48, 3276800, 0
    s_sub_u32 s50, s50, s48
    s_add_u32 m0, s49, 65536
    s_nop 0
    buffer_load_dwordx4 v149, s[32:35], s50 offen sc1 lds
    s_add_u32 s50, s50, 327680
    s_cmp_ge_u32 s50, s51
    s_cselect_b32 s48, 3276800, 0
    s_sub_u32 s50, s50, s48
    s_add_u32 m0, s49, 73728
    s_nop 0
    buffer_load_dwordx4 v149, s[32:35], s50 offen sc1 lds
    s_add_u32 s50, s50, 327680
    s_waitcnt vmcnt(10)
    s_barrier
    s_cmp_lg_u32 s3, 6
    s_cbranch_scc1 arr_57
    s_and_b32 s59, s2, 15
    s_lshl_b32 s59, s59, 8
    s_add_u32 s59, s59, 37765120
    v_lshlrev_b32 v255, 12, v1
    v_mov_b32 v254, 1
    s_mov_b64 exec, 15
    buffer_atomic_add v254, v255, s[32:35], s59 offen sc1
    s_mov_b64 exec, -1
arr_57:
    s_lshl_b32 s64, s80, 3
    s_add_u32 s64, s64, s3
    s_mul_i32 s65, s3, 6144
    s_add_u32 s65, s65, 102400
    v_lshrrev_b32 v112, 5, v1
    v_lshlrev_b32 v112, 5, v112
    v_xor_b32 v112, v112, v4
    v_lshrrev_b32 v113, 2, v2
    v_lshl_add_u32 v113, v3, 3, v113
    v_lshlrev_b32 v113, 6, v113
    v_and_b32 v114, 3, v2
    v_lshl_add_u32 v113, v114, 3, v113
    v_and_b32 v114, 1, v3
    v_lshl_add_u32 v113, v114, 5, v113
    v_add_u32 v113, s65, v113
    v_xor_b32 v114, 32, v113
    v_add_u32 v115, 40960, v4
    s_cmp_eq_u32 s71, 19
    s_cselect_b32 s40, 3, 99
    v_mov_b32 v116, 0xffff
    v_cmp_ne_u32 vcc, s40, v3
    s_nop 1
    v_cndmask_b32 v116, v116, -1, vcc
    v_lshrrev_b32 v117, 1, v3
    v_lshl_add_u32 v117, v117, 4, v2
    v_lshlrev_b32 v117, 2, v117
    v_lshrrev_b32 v8, 2, v0
    v_mul_u32_u24 v9, 781, v8
    v_lshrrev_b32 v9, 14, v9
    v_mul_u32_u24 v10, 21, v9
    v_sub_u32 v8, v8, v10
    v_lshlrev_b32 v10, 4, v9
    v_subrev_u32 v11, 12, v8
    v_cmp_eq_u32 vcc, 20, v8
    s_nop 1
    v_cndmask_b32 v11, v11, 0, vcc
    v_add_u32 v11, 128, v11
    v_cmp_gt_u32 vcc, 16, v8
    s_nop 1
    v_cndmask_b32 v11, v11, v8, vcc
    v_add_u32 v10, v10, v11
    v_and_b32 v11, 3, v0
    v_lshl_add_u32 v10, v10, 2, v11
    v_lshlrev_b32 v10, 2, v10
    v_min_u32 v10, 4092, v10
    v_add_u32 v118, 102400, v10
    v_lshrrev_b32 v8, 2, v2
    v_and_b32 v9, 1, v8
    v_cmp_eq_u32 vcc, 1, v9
    v_mov_b32 v10, 0x358637bd
    v_mov_b32 v11, 0xff800000
    v_cndmask_b32 v119, v10, 0, vcc
    v_cndmask_b32 v120, v10, v11, vcc
    v_cndmask_b32 v121, 1.0, 0, vcc
    v_cmp_eq_u32 vcc, 3, v8
    v_mov_b32 v10, 0x3b4ccccd
    s_nop 0
    v_cndmask_b32 v122, 1.0, 0, vcc
    v_cndmask_b32 v123, 0, v10, vcc
    v_lshlrev_b32 v8, 2, v3
    v_sub_u32 v8, v2, v8
    v_mov_b32 v10, 0x3f80
    v_mov_b32 v11, 0x3f800000
    v_cmp_eq_u32 vcc, 0, v8
    s_nop 1
    v_cndmask_b32 v124, 0, v10, vcc
    v_cmp_eq_u32 vcc, 1, v8
    s_nop 1
    v_cndmask_b32 v124, v124, v11, vcc
    v_cmp_eq_u32 vcc, 2, v8
    s_nop 1
    v_cndmask_b32 v125, 0, v10, vcc
    v_cmp_eq_u32 vcc, 3, v8
    s_nop 1
    v_cndmask_b32 v125, v125, v11, vcc
    v_mov_b32 v126, 0
    v_mov_b32 v127, 0
    v_mov_b32 v128, 0
    v_mov_b32 v129, 0
    v_mov_b32 v130, v124
    v_mov_b32 v131, v125
    v_lshrrev_b32 v8, 3, v1
    v_mul_u32_u24 v8, 1792, v8
    v_and_b32 v9, 7, v1
    v_lshl_add_u32 v132, v9, 4, v8
    s_lshl_b32 s40, s3, 8
    v_add_u32 v132, s40, v132
    v_lshrrev_b32 v8, 5, v1
    v_lshl_add_u32 v8, v8, 3, v9
    s_lshl_b32 s40, s3, 4
    v_add_u32 v8, s40, v8
    v_mul_u32_u24 v9, 781, v8
    v_lshrrev_b32 v9, 14, v9
    v_mul_u32_u24 v10, 21, v9
    v_sub_u32 v8, v8, v10
    v_add_u32 v10, 48, v8
    v_cmp_gt_u32 vcc, 16, v8
    s_nop 1
    v_cndmask_b32 v8, v10, v8, vcc
    v_lshlrev_b32 v8, 4, v8
    v_lshlrev_b32 v10, 8, v9
    v_mov_b32 v11, 520
    v_cmp_eq_u32 vcc, 4, v9
    s_nop 1
    v_cndmask_b32 v10, v10, v11, vcc
    v_mov_b32 v11, 2048
    v_cmp_lt_u32 vcc, 4, v9
    s_nop 1
    v_cndmask_b32 v10, v10, v11, vcc
    v_add_u32 v8, v8, v10
    v_and_b32 v9, 1, v3
    v_lshl_add_u32 v8, v9, 2, v8
    v_add_u32 v133, 151552, v8
    v_add_u32 v134, 151552, v4
    v_min_u32 v8, 4, v2
    v_lshl_add_u32 v8, v3, 4, v8
    v_lshlrev_b32 v8, 4, v8
    v_add_u32 v135, 152576, v8
    v_mov_b32 v8, 0
    v_lshlrev_b32 v9, 2, v0
    v_add_u32 v9, 151552, v9
    ds_write_b32 v9, v8
    v_bfe_u32 v8, v2, 2, 1
    v_mul_u32_u24 v8, 20480, v8
    v_lshrrev_b32 v9, 3, v2
    v_lshl_add_u32 v8, v9, 6, v8
    v_and_b32 v9, 3, v2
    v_lshl_add_u32 v8, v9, 4, v8
    s_mul_i32 s40, s71, 5
    v_add_u32 v9, s40, v3
    v_lshrrev_b32 v10, 1, v9
    v_lshl_add_u32 v136, v10, 8, v8
    v_and_b32 v10, 1, v9
    v_lshl_add_u32 v136, v10, 3, v136
    s_add_u32 s40, s40, 4
    s_lshr_b32 s41, s40, 1
    s_lshl_b32 s41, s41, 8
    s_and_b32 s40, s40, 1
    s_lshl_b32 s40, s40, 3
    s_add_u32 s40, s40, s41
    v_add_u32 v137, s40, v8
    v_lshlrev_b32 v138, 3, v2
    v_lshl_add_u32 v138, v3, 8, v138
join_29:
    s_waitcnt vmcnt(0)
j6_48:
    s_cmp_lg_u32 s3, 7
    s_cbranch_scc1 wt_58
    s_and_b32 s59, s2, 3
    s_lshl_b32 s59, s59, 12
    s_add_u32 s59, s59, 37715968
    v_lshlrev_b32 v255, 8, v2
    v_cmp_gt_u32 vcc, 8, v2
    v_mov_b32 v253, 12
    s_nop 0
    v_cndmask_b32 v253, 8, v253, vcc
    s_mov_b32 s58, 40000
    s_cmp_lg_u32 s83, 0
    s_cbranch_scc1 polld_60
poll_59:
    buffer_load_dword v254, v255, s[32:35], s59 offen sc1
    s_waitcnt vmcnt(0)
    v_cmp_gt_u32 vcc, v253, v254
    s_nop 0
    s_cmp_eq_u64 vcc, 0
    s_cbranch_scc1 polld_60
    s_sub_u32 s58, s58, 1
    s_cmp_lg_u32 s58, 0
    s_cbranch_scc1 poll_59
    s_mov_b32 s83, 3
    v_mov_b32 v254, 3
    v_mov_b32 v255, 16
    buffer_store_dword v254, v255, s[36:39], 0 offen
polld_60:
wt_58:
    s_barrier
    s_mul_i32 s52, s64, 40960
    s_add_u32 s52, s52, 34078720
    s_add_u32 s54, s52, 40960
    s_lshl_b32 s53, s68, 11
    s_add_u32 s53, s53, s52
    s_add_u32 m0, s65, 0
    s_nop 0
    buffer_load_dwordx4 v112, s[32:35], s53 offen sc1 lds
    buffer_load_dwordx4 v112, s[32:35], s53 offen offset:1024 sc1 lds
    s_add_u32 s53, s53, 2048
    s_cmp_ge_u32 s53, s54
    s_cselect_b32 s53, s52, s53
    s_add_u32 m0, s65, 2048
    s_nop 0
    buffer_load_dwordx4 v112, s[32:35], s53 offen sc1 lds
    buffer_load_dwordx4 v112, s[32:35], s53 offen offset:1024 sc1 lds
    s_add_u32 s53, s53, 2048
    s_cmp_ge_u32 s53, s54
    s_cselect_b32 s53, s52, s53
    s_add_u32 m0, s65, 4096
    s_nop 0
    buffer_load_dwordx4 v112, s[32:35], s53 offen sc1 lds
    buffer_load_dwordx4 v112, s[32:35], s53 offen offset:1024 sc1 lds
    s_add_u32 s53, s53, 2048
    s_cmp_ge_u32 s53, s54
    s_cselect_b32 s53, s52, s53
    ds_read_b128 v[72:75], v4 offset:0
    ds_read_b128 v[76:79], v4 offset:1024
    ds_read_b128 v[80:83], v4 offset:2048
    ds_read_b128 v[84:87], v4 offset:3072
    s_lshl_b32 s55, s64, 7
    s_add_u32 s55, s55, 37650432
    s_lshl_b32 s56, s64, 8
    s_add_u32 s56, s56, 37666816
    s_waitcnt vmcnt(4)
    ds_read_b64_tr_b16 v[48:49], v113 offset:0
    ds_read_b64_tr_b16 v[50:51], v113 offset:256
    ds_read_b64_tr_b16 v[52:53], v114 offset:0
    ds_read_b64_tr_b16 v[54:55], v114 offset:256
    s_waitcnt vmcnt(2)
    ds_read_b64_tr_b16 v[56:57], v113 offset:2048
    ds_read_b64_tr_b16 v[58:59], v113 offset:2304
    ds_read_b64_tr_b16 v[60:61], v114 offset:2048
    ds_read_b64_tr_b16 v[62:63], v114 offset:2304
    s_waitcnt lgkmcnt(4)
    s_add_u32 m0, s65, 0
    s_nop 0
    buffer_load_dwordx4 v112, s[32:35], s53 offen sc1 lds
    buffer_load_dwordx4 v112, s[32:35], s53 offen offset:1024 sc1 lds
    s_add_u32 s53, s53, 2048
    s_cmp_ge_u32 s53, s54
    s_cselect_b32 s53, s52, s53
    v_mfma_f32_16x16x32_bf16 v[8:11], v[48:51], v[72:75], 0
    ds_read_b128 v[92:95], v4 offset:4096
    v_mfma_f32_16x16x32_bf16 v[12:15], v[52:55], v[72:75], 0
    ds_read_b128 v[96:99], v4 offset:5120
    v_mfma_f32_16x16x32_bf16 v[16:19], v[48:51], v[76:79], 0
    ds_read_b128 v[100:103], v4 offset:6144
    s_waitcnt lgkmcnt(3)
    s_add_u32 m0, s65, 2048
    s_nop 0
    buffer_load_dwordx4 v112, s[32:35], s53 offen sc1 lds
    v_mfma_f32_16x16x32_bf16 v[20:23], v[52:55], v[76:79], 0
    ds_read_b128 v[104:107], v4 offset:7168
    buffer_load_dwordx4 v112, s[32:35], s53 offen offset:1024 sc1 lds
    s_add_u32 s53, s53, 2048
    s_cmp_ge_u32 s53, s54
    s_cselect_b32 s53, s52, s53
    v_mfma_f32_16x16x32_bf16 v[24:27], v[48:51], v[80:83], 0
    s_waitcnt vmcnt(4)
    ds_read_b64_tr_b16 v[64:65], v113 offset:4096
    v_mfma_f32_16x16x32_bf16 v[28:31], v[52:55], v[80:83], 0
    ds_read_b64_tr_b16 v[66:67], v113 offset:4352
    v_mfma_f32_16x16x32_bf16 v[32:35], v[84:87], v[48:51], 0
    ds_read_b64_tr_b16 v[68:69], v114 offset:4096
    ds_read_b64_tr_b16 v[70:71], v114 offset:4352
    v_mfma_f32_16x16x32_bf16 v[36:39], v[84:87], v[52:55], 0
    s_cmp_ge_u32 s71, 20
    s_cbranch_scc1 ssq_61
    v_mov_b32 v5, 0
    v_mov_b32 v6, 0
    v_and_b32 v7, v116, v51
    v_and_b32 v139, v116, v55
    v_dot2c_f32_bf16 v5, v48, v48
    v_dot2c_f32_bf16 v6, v52, v52
    v_dot2c_f32_bf16 v5, v49, v49
    v_dot2c_f32_bf16 v6, v53, v53
    v_dot2c_f32_bf16 v5, v50, v50
    v_dot2c_f32_bf16 v6, v54, v54
    v_dot2c_f32_bf16 v5, v7, v7
    v_dot2c_f32_bf16 v6, v139, v139
    s_nop 2
    v_permlane32_swap_b32 v5, v6
    v_add_f32 v5, v5, v6
    v_mov_b32 v6, v5
    s_nop 1
    v_permlane16_swap_b32 v5, v6
    v_add_f32 v5, v5, v6
    s_mov_b32 exec_lo, 0xffff
    s_mov_b32 exec_hi, 0xffff
    buffer_atomic_add_f32 v5, v117, s[32:35], s55 offen
    s_mov_b64 exec, -1
ssq_61:
    s_waitcnt lgkmcnt(7)
    v_mfma_f32_16x16x32_bf16 v[8:11], v[56:59], v[92:95], v[8:11]
    ds_read_b128 v[72:75], v4 offset:8192
    v_mfma_f32_16x16x32_bf16 v[12:15], v[60:63], v[92:95], v[12:15]
    ds_read_b128 v[76:79], v4 offset:9216
    s_waitcnt lgkmcnt(8)
    v_mfma_f32_16x16x32_bf16 v[16:19], v[56:59], v[96:99], v[16:19]
    ds_read_b128 v[80:83], v4 offset:10240
    s_waitcnt lgkmcnt(3)
    s_add_u32 m0, s65, 4096
    s_nop 0
    buffer_load_dwordx4 v112, s[32:35], s53 offen sc1 lds
    v_mfma_f32_16x16x32_bf16 v[20:23], v[60:63], v[96:99], v[20:23]
    ds_read_b128 v[84:87], v4 offset:11264
    buffer_load_dwordx4 v112, s[32:35], s53 offen offset:1024 sc1 lds
    s_add_u32 s53, s53, 2048
    s_cmp_ge_u32 s53, s54
    s_cselect_b32 s53, s52, s53
    v_mfma_f32_16x16x32_bf16 v[24:27], v[56:59], v[100:103], v[24:27]
    s_waitcnt vmcnt(4)
    ds_read_b64_tr_b16 v[48:49], v113 offset:0
    v_mfma_f32_16x16x32_bf16 v[28:31], v[60:63], v[100:103], v[28:31]
    ds_read_b64_tr_b16 v[50:51], v113 offset:256
    v_mfma_f32_16x16x32_bf16 v[32:35], v[104:107], v[56:59], v[32:35]
    ds_read_b64_tr_b16 v[52:53], v114 offset:0
    ds_read_b64_tr_b16 v[54:55], v114 offset:256
    v_mfma_f32_16x16x32_bf16 v[36:39], v[104:107], v[60:63], v[36:39]
    s_waitcnt lgkmcnt(7)
    v_mfma_f32_16x16x32_bf16 v[8:11], v[64:67], v[72:75], v[8:11]
    ds_read_b128 v[92:95], v4 offset:12288
    v_mfma_f32_16x16x32_bf16 v[12:15], v[68:71], v[72:75], v[12:15]
    ds_read_b128 v[96:99], v4 offset:13312
    s_waitcnt lgkmcnt(8)
    v_mfma_f32_16x16x32_bf16 v[16:19], v[64:67], v[76:79], v[16:19]
    ds_read_b128 v[100:103], v4 offset:14336
    s_waitcnt lgkmcnt(3)
    s_add_u32 m0, s65, 0
    s_nop 0
    buffer_load_dwordx4 v112, s[32:35], s53 offen sc1 lds
    v_mfma_f32_16x16x32_bf16 v[20:23], v[68:71], v[76:79], v[20:23]
    ds_read_b128 v[104:107], v4 offset:15360
    buffer_load_dwordx4 v112, s[32:35], s53 offen offset:1024 sc1 lds
    s_add_u32 s53, s53, 2048
    s_cmp_ge_u32 s53, s54
    s_cselect_b32 s53, s52, s53
    v_mfma_f32_16x16x32_bf16 v[24:27], v[64:67], v[80:83], v[24:27]
    s_waitcnt vmcnt(4)
    ds_read_b64_tr_b16 v[56:57], v113 offset:2048
    v_mfma_f32_16x16x32_bf16 v[28:31], v[68:71], v[80:83], v[28:31]
    ds_read_b64_tr_b16 v[58:59], v113 offset:2304
    v_mfma_f32_16x16x32_bf16 v[32:35], v[84:87], v[64:67], v[32:35]
    ds_read_b64_tr_b16 v[60:61], v114 offset:2048
    ds_read_b64_tr_b16 v[62:63], v114 offset:2304
    v_mfma_f32_16x16x32_bf16 v[36:39], v[84:87], v[68:71], v[36:39]
    s_waitcnt lgkmcnt(7)
    v_mfma_f32_16x16x32_bf16 v[8:11], v[48:51], v[92:95], v[8:11]
    ds_read_b128 v[72:75], v4 offset:16384
    v_mfma_f32_16x16x32_bf16 v[12:15], v[52:55], v[92:95], v[12:15]
    ds_read_b128 v[76:79], v4 offset:17408
    s_waitcnt lgkmcnt(8)
    v_mfma_f32_16x16x32_bf16 v[16:19], v[48:51], v[96:99], v[16:19]
    ds_read_b128 v[80:83], v4 offset:18432
    s_waitcnt lgkmcnt(3)
    s_add_u32 m0, s65, 2048
    s_nop 0
    buffer_load_dwordx4 v112, s[32:35], s53 offen sc1 lds
    v_mfma_f32_16x16x32_bf16 v[20:23], v[52:55], v[96:99], v[20:23]
    ds_read_b128 v[84:87], v4 offset:19456
    buffer_load_dwordx4 v112, s[32:35], s53 offen offset:1024 sc1 lds
    s_add_u32 s53, s53, 2048
    s_cmp_ge_u32 s53, s54
    s_cselect_b32 s53, s52, s53
    v_mfma_f32_16x16x32_bf16 v[24:27], v[48:51], v[100:103], v[24:27]
    s_waitcnt vmcnt(4)
    ds_read_b64_tr_b16 v[64:65], v113 offset:4096
    v_mfma_f32_16x16x32_bf16 v[28:31], v[52:55], v[100:103], v[28:31]
    ds_read_b64_tr_b16 v[66:67], v113 offset:4352
    v_mfma_f32_16x16x32_bf16 v[32:35], v[104:107], v[48:51], v[32:35]
    ds_read_b64_tr_b16 v[68:69], v114 offset:4096
    ds_read_b64_tr_b16 v[70:71], v114 offset:4352
    v_mfma_f32_16x16x32_bf16 v[36:39], v[104:107], v[52:55], v[36:39]
    s_waitcnt lgkmcnt(7)
    v_mfma_f32_16x16x32_bf16 v[8:11], v[56:59], v[72:75], v[8:11]
    ds_read_b128 v[92:95], v4 offset:20480
    v_mfma_f32_16x16x32_bf16 v[12:15], v[60:63], v[72:75], v[12:15]
    ds_read_b128 v[96:99], v4 offset:21504
    s_waitcnt lgkmcnt(8)
    v_mfma_f32_16x16x32_bf16 v[16:19], v[56:59], v[76:79], v[16:19]
    ds_read_b128 v[100:103], v4 offset:22528
    s_waitcnt lgkmcnt(3)
    s_add_u32 m0, s65, 4096
    s_nop 0
    buffer_load_dwordx4 v112, s[32:35], s53 offen sc1 lds
    v_mfma_f32_16x16x32_bf16 v[20:23], v[60:63], v[76:79], v[20:23]
    ds_read_b128 v[104:107], v4 offset:23552
    buffer_load_dwordx4 v112, s[32:35], s53 offen offset:1024 sc1 lds
    s_add_u32 s53, s53, 2048
    s_cmp_ge_u32 s53, s54
    s_cselect_b32 s53, s52, s53
    v_mfma_f32_16x16x32_bf16 v[24:27], v[56:59], v[80:83], v[24:27]
    s_waitcnt vmcnt(4)
    ds_read_b64_tr_b16 v[48:49], v113 offset:0
    v_mfma_f32_16x16x32_bf16 v[28:31], v[60:63], v[80:83], v[28:31]
    ds_read_b64_tr_b16 v[50:51], v113 offset:256
    v_mfma_f32_16x16x32_bf16 v[32:35], v[84:87], v[56:59], v[32:35]
    ds_read_b64_tr_b16 v[52:53], v114 offset:0
    ds_read_b64_tr_b16 v[54:55], v114 offset:256
    v_mfma_f32_16x16x32_bf16 v[36:39], v[84:87], v[60:63], v[36:39]
    s_cmp_ge_u32 s71, 20
    s_cbranch_scc1 ssf_62
    v_mov_b32 v255, 0
    v_mov_b32 v254, 1
    s_mov_b64 exec, 1
    buffer_atomic_add v254, v255, s[32:35], s56 offen sc1
    s_mov_b64 exec, -1
ssf_62:
    s_waitcnt lgkmcnt(7)
    v_mfma_f32_16x16x32_bf16 v[8:11], v[64:67], v[92:95], v[8:11]
    ds_read_b128 v[72:75], v4 offset:24576
    v_mfma_f32_16x16x32_bf16 v[12:15], v[68:71], v[92:95], v[12:15]
    ds_read_b128 v[76:79], v4 offset:25600
    s_waitcnt lgkmcnt(8)
    v_mfma_f32_16x16x32_bf16 v[16:19], v[64:67], v[96:99], v[16:19]
    ds_read_b128 v[80:83], v4 offset:26624
    s_waitcnt lgkmcnt(3)
    s_add_u32 m0, s65, 0
    s_nop 0
    buffer_load_dwordx4 v112, s[32:35], s53 offen sc1 lds
    v_mfma_f32_16x16x32_bf16 v[20:23], v[68:71], v[96:99], v[20:23]
    ds_read_b128 v[84:87], v4 offset:27648
    buffer_load_dwordx4 v112, s[32:35], s53 offen offset:1024 sc1 lds
    s_add_u32 s53, s53, 2048
    s_cmp_ge_u32 s53, s54
    s_cselect_b32 s53, s52, s53
    v_mfma_f32_16x16x32_bf16 v[24:27], v[64:67], v[100:103], v[24:27]
    s_waitcnt vmcnt(4)
    ds_read_b64_tr_b16 v[56:57], v113 offset:2048
    v_mfma_f32_16x16x32_bf16 v[28:31], v[68:71], v[100:103], v[28:31]
    ds_read_b64_tr_b16 v[58:59], v113 offset:2304
    v_mfma_f32_16x16x32_bf16 v[32:35], v[104:107], v[64:67], v[32:35]
    ds_read_b64_tr_b16 v[60:61], v114 offset:2048
    ds_read_b64_tr_b16 v[62:63], v114 offset:2304
    v_mfma_f32_16x16x32_bf16 v[36:39], v[104:107], v[68:71], v[36:39]
    s_waitcnt lgkmcnt(7)
    v_mfma_f32_16x16x32_bf16 v[8:11], v[48:51], v[72:75], v[8:11]
    ds_read_b128 v[92:95], v4 offset:28672
    v_mfma_f32_16x16x32_bf16 v[12:15], v[52:55], v[72:75], v[12:15]
    ds_read_b128 v[96:99], v4 offset:29696
    s_waitcnt lgkmcnt(8)
    v_mfma_f32_16x16x32_bf16 v[16:19], v[48:51], v[76:79], v[16:19]
    ds_read_b128 v[100:103], v4 offset:30720
    s_waitcnt lgkmcnt(3)
    s_add_u32 m0, s65, 2048
    s_nop 0
    buffer_load_dwordx4 v112, s[32:35], s53 offen sc1 lds
    v_mfma_f32_16x16x32_bf16 v[20:23], v[52:55], v[76:79], v[20:23]
    ds_read_b128 v[104:107], v4 offset:31744
    buffer_load_dwordx4 v112, s[32:35], s53 offen offset:1024 sc1 lds
    s_add_u32 s53, s53, 2048
    s_cmp_ge_u32 s53, s54
    s_cselect_b32 s53, s52, s53
    v_mfma_f32_16x16x32_bf16 v[24:27], v[48:51], v[80:83], v[24:27]
    s_waitcnt vmcnt(4)
    ds_read_b64_tr_b16 v[64:65], v113 offset:4096
    v_mfma_f32_16x16x32_bf16 v[28:31], v[52:55], v[80:83], v[28:31]
    ds_read_b64_tr_b16 v[66:67], v113 offset:4352
    v_mfma_f32_16x16x32_bf16 v[32:35], v[84:87], v[48:51], v[32:35]
    ds_read_b64_tr_b16 v[68:69], v114 offset:4096
    ds_read_b64_tr_b16 v[70:71], v114 offset:4352
    v_mfma_f32_16x16x32_bf16 v[36:39], v[84:87], v[52:55], v[36:39]
    s_waitcnt lgkmcnt(7)
    v_mfma_f32_16x16x32_bf16 v[8:11], v[56:59], v[92:95], v[8:11]
    ds_read_b128 v[72:75], v4 offset:32768
    v_mfma_f32_16x16x32_bf16 v[12:15], v[60:63], v[92:95], v[12:15]
    ds_read_b128 v[76:79], v4 offset:33792
    s_waitcnt lgkmcnt(8)
    v_mfma_f32_16x16x32_bf16 v[16:19], v[56:59], v[96:99], v[16:19]
    ds_read_b128 v[80:83], v4 offset:34816
    s_waitcnt lgkmcnt(3)
    s_add_u32 m0, s65, 4096
    s_nop 0
    buffer_load_dwordx4 v112, s[32:35], s53 offen sc1 lds
    v_mfma_f32_16x16x32_bf16 v[20:23], v[60:63], v[96:99], v[20:23]
    ds_read_b128 v[84:87], v4 offset:35840
    buffer_load_dwordx4 v112, s[32:35], s53 offen offset:1024 sc1 lds
    s_add_u32 s53, s53, 2048
    s_cmp_ge_u32 s53, s54
    s_cselect_b32 s53, s52, s53
    v_mfma_f32_16x16x32_bf16 v[24:27], v[56:59], v[100:103], v[24:27]
    s_waitcnt vmcnt(4)
    ds_read_b64_tr_b16 v[48:49], v113 offset:0
    v_mfma_f32_16x16x32_bf16 v[28:31], v[60:63], v[100:103], v[28:31]
    ds_read_b64_tr_b16 v[50:51], v113 offset:256
    v_mfma_f32_16x16x32_bf16 v[32:35], v[104:107], v[56:59], v[32:35]
    ds_read_b64_tr_b16 v[52:53], v114 offset:0
    ds_read_b64_tr_b16 v[54:55], v114 offset:256
    v_mfma_f32_16x16x32_bf16 v[36:39], v[104:107], v[60:63], v[36:39]
    s_waitcnt lgkmcnt(7)
    v_mfma_f32_16x16x32_bf16 v[8:11], v[64:67], v[72:75], v[8:11]
    ds_read_b128 v[92:95], v4 offset:36864
    v_mfma_f32_16x16x32_bf16 v[12:15], v[68:71], v[72:75], v[12:15]
    ds_read_b128 v[96:99], v4 offset:37888
    s_waitcnt lgkmcnt(8)
    v_mfma_f32_16x16x32_bf16 v[16:19], v[64:67], v[76:79], v[16:19]
    ds_read_b128 v[100:103], v4 offset:38912
    s_waitcnt lgkmcnt(3)
    s_add_u32 m0, s65, 0
    s_nop 0
    buffer_load_dwordx4 v112, s[32:35], s53 offen sc1 lds
    v_mfma_f32_16x16x32_bf16 v[20:23], v[68:71], v[76:79], v[20:23]
    ds_read_b128 v[104:107], v4 offset:39936
    buffer_load_dwordx4 v112, s[32:35], s53 offen offset:1024 sc1 lds
    s_add_u32 s53, s53, 2048
    s_cmp_ge_u32 s53, s54
    s_cselect_b32 s53, s52, s53
    v_mfma_f32_16x16x32_bf16 v[24:27], v[64:67], v[80:83], v[24:27]
    s_waitcnt vmcnt(4)
    ds_read_b64_tr_b16 v[56:57], v113 offset:2048
    v_mfma_f32_16x16x32_bf16 v[28:31], v[68:71], v[80:83], v[28:31]
    ds_read_b64_tr_b16 v[58:59], v113 offset:2304
    v_mfma_f32_16x16x32_bf16 v[32:35], v[84:87], v[64:67], v[32:35]
    ds_read_b64_tr_b16 v[60:61], v114 offset:2048
    ds_read_b64_tr_b16 v[62:63], v114 offset:2304
    v_mfma_f32_16x16x32_bf16 v[36:39], v[84:87], v[68:71], v[36:39]
    s_cmp_lg_u32 s3, 7
    s_cbranch_scc1 pb_63
    s_and_b32 s59, s2, 3
    s_lshl_b32 s59, s59, 12
    s_add_u32 s59, s59, 37765120
    v_lshlrev_b32 v255, 8, v2
    buffer_load_dword v151, v255, s[32:35], s59 offen sc1
pb_63:
    s_waitcnt lgkmcnt(7)
    v_mfma_f32_16x16x32_bf16 v[8:11], v[48:51], v[92:95], v[8:11]
    ds_read_b128 v[72:75], v115 offset:0
    v_mfma_f32_16x16x32_bf16 v[12:15], v[52:55], v[92:95], v[12:15]
    ds_read_b128 v[76:79], v115 offset:1024
    s_waitcnt lgkmcnt(8)
    v_mfma_f32_16x16x32_bf16 v[16:19], v[48:51], v[96:99], v[16:19]
    ds_read_b128 v[80:83], v115 offset:2048
    s_waitcnt lgkmcnt(3)
    s_add_u32 m0, s65, 2048
    s_nop 0
    buffer_load_dwordx4 v112, s[32:35], s53 offen sc1 lds
    v_mfma_f32_16x16x32_bf16 v[20:23], v[52:55], v[96:99], v[20:23]
    ds_read_b128 v[84:87], v115 offset:3072
    buffer_load_dwordx4 v112, s[32:35], s53 offen offset:1024 sc1 lds
    s_add_u32 s53, s53, 2048
    s_cmp_ge_u32 s53, s54
    s_cselect_b32 s53, s52, s53
    v_mfma_f32_16x16x32_bf16 v[24:27], v[48:51], v[100:103], v[24:27]
    s_waitcnt vmcnt(4)
    ds_read_b64_tr_b16 v[64:65], v113 offset:4096
    v_mfma_f32_16x16x32_bf16 v[28:31], v[52:55], v[100:103], v[28:31]
    ds_read_b64_tr_b16 v[66:67], v113 offset:4352
    v_mfma_f32_16x16x32_bf16 v[32:35], v[104:107], v[48:51], v[32:35]
    ds_read_b64_tr_b16 v[68:69], v114 offset:4096
    ds_read_b64_tr_b16 v[70:71], v114 offset:4352
    v_mfma_f32_16x16x32_bf16 v[36:39], v[104:107], v[52:55], v[36:39]
    v_mov_b32 v152, 0
    v_mov_b32 v153, 0
    v_mov_b32 v154, 0
    v_mov_b32 v155, 0
    s_lshl_b32 s42, s3, 8
    s_add_u32 s42, s42, s2
    s_lshl_b32 s43, s42, 10
    s_add_u32 s43, s43, 10485760
    buffer_store_dwordx4 v[152:155], v4, s[32:35], s43 offen sc1
    s_add_u32 s43, s43, 2097152
zf_64:
    s_waitcnt lgkmcnt(7)
    v_mfma_f32_16x16x32_bf16 v[8:11], v[56:59], v[72:75], v[8:11]
    ds_read_b128 v[92:95], v115 offset:4096
    v_mfma_f32_16x16x32_bf16 v[12:15], v[60:63], v[72:75], v[12:15]
    ds_read_b128 v[96:99], v115 offset:5120
    s_waitcnt lgkmcnt(8)
    v_mfma_f32_16x16x32_bf16 v[16:19], v[56:59], v[76:79], v[16:19]
    ds_read_b128 v[100:103], v115 offset:6144
    s_waitcnt lgkmcnt(3)
    s_add_u32 m0, s65, 4096
    s_nop 0
    buffer_load_dwordx4 v112, s[32:35], s53 offen sc1 lds
    v_mfma_f32_16x16x32_bf16 v[20:23], v[60:63], v[76:79], v[20:23]
    ds_read_b128 v[104:107], v115 offset:7168
    buffer_load_dwordx4 v112, s[32:35], s53 offen offset:1024 sc1 lds
    s_add_u32 s53, s53, 2048
    s_cmp_ge_u32 s53, s54
    s_cselect_b32 s53, s52, s53
    v_mfma_f32_16x16x32_bf16 v[24:27], v[56:59], v[80:83], v[24:27]
    s_waitcnt vmcnt(4)
    ds_read_b64_tr_b16 v[48:49], v113 offset:0
    v_mfma_f32_16x16x32_bf16 v[28:31], v[60:63], v[80:83], v[28:31]
    ds_read_b64_tr_b16 v[50:51], v113 offset:256
    v_mfma_f32_16x16x32_bf16 v[32:35], v[84:87], v[56:59], v[32:35]
    ds_read_b64_tr_b16 v[52:53], v114 offset:0
    ds_read_b64_tr_b16 v[54:55], v114 offset:256
    v_mfma_f32_16x16x32_bf16 v[36:39], v[84:87], v[60:63], v[36:39]
    s_cmp_ge_u32 s42, 512
    s_cbranch_scc1 zf_65
    buffer_store_dwordx4 v[152:155], v4, s[32:35], s43 offen sc1
    s_add_u32 s43, s43, 2097152
zf_65:
    s_waitcnt lgkmcnt(7)
    v_mfma_f32_16x16x32_bf16 v[8:11], v[64:67], v[92:95], v[8:11]
    ds_read_b128 v[72:75], v115 offset:8192
    v_mfma_f32_16x16x32_bf16 v[12:15], v[68:71], v[92:95], v[12:15]
    ds_read_b128 v[76:79], v115 offset:9216
    s_waitcnt lgkmcnt(8)
    v_mfma_f32_16x16x32_bf16 v[16:19], v[64:67], v[96:99], v[16:19]
    ds_read_b128 v[80:83], v115 offset:10240
    s_waitcnt lgkmcnt(3)
    s_add_u32 m0, s65, 0
    s_nop 0
    buffer_load_dwordx4 v112, s[32:35], s53 offen sc1 lds
    v_mfma_f32_16x16x32_bf16 v[20:23], v[68:71], v[96:99], v[20:23]
    ds_read_b128 v[84:87], v115 offset:11264
    buffer_load_dwordx4 v112, s[32:35], s53 offen offset:1024 sc1 lds
    s_add_u32 s53, s53, 2048
    s_cmp_ge_u32 s53, s54
    s_cselect_b32 s53, s52, s53
    v_mfma_f32_16x16x32_bf16 v[24:27], v[64:67], v[100:103], v[24:27]
    s_waitcnt vmcnt(4)
    ds_read_b64_tr_b16 v[56:57], v113 offset:2048
    v_mfma_f32_16x16x32_bf16 v[28:31], v[68:71], v[100:103], v[28:31]
    ds_read_b64_tr_b16 v[58:59], v113 offset:2304
    v_mfma_f32_16x16x32_bf16 v[32:35], v[104:107], v[64:67], v[32:35]
    ds_read_b64_tr_b16 v[60:61], v114 offset:2048
    ds_read_b64_tr_b16 v[62:63], v114 offset:2304
    v_mfma_f32_16x16x32_bf16 v[36:39], v[104:107], v[68:71], v[36:39]
    s_waitcnt lgkmcnt(7)
    v_mfma_f32_16x16x32_bf16 v[8:11], v[48:51], v[72:75], v[8:11]
    ds_read_b128 v[92:95], v115 offset:12288
    v_mfma_f32_16x16x32_bf16 v[12:15], v[52:55], v[72:75], v[12:15]
    ds_read_b128 v[96:99], v115 offset:13312
    s_waitcnt lgkmcnt(8)
    v_mfma_f32_16x16x32_bf16 v[16:19], v[48:51], v[76:79], v[16:19]
    ds_read_b128 v[100:103], v115 offset:14336
    s_waitcnt lgkmcnt(3)
    s_add_u32 m0, s65, 2048
    s_nop 0
    buffer_load_dwordx4 v112, s[32:35], s53 offen sc1 lds
    v_mfma_f32_16x16x32_bf16 v[20:23], v[52:55], v[76:79], v[20:23]
    ds_read_b128 v[104:107], v115 offset:15360
    buffer_load_dwordx4 v112, s[32:35], s53 offen offset:1024 sc1 lds
    s_add_u32 s53, s53, 2048
    s_cmp_ge_u32 s53, s54
    s_cselect_b32 s53, s52, s53
    v_mfma_f32_16x16x32_bf16 v[24:27], v[48:51], v[80:83], v[24:27]
    s_waitcnt vmcnt(4)
    ds_read_b64_tr_b16 v[64:65], v113 offset:4096
    v_mfma_f32_16x16x32_bf16 v[28:31], v[52:55], v[80:83], v[28:31]
    ds_read_b64_tr_b16 v[66:67], v113 offset:4352
    v_mfma_f32_16x16x32_bf16 v[32:35], v[84:87], v[48:51], v[32:35]
    ds_read_b64_tr_b16 v[68:69], v114 offset:4096
    ds_read_b64_tr_b16 v[70:71], v114 offset:4352
    v_mfma_f32_16x16x32_bf16 v[36:39], v[84:87], v[52:55], v[36:39]
    s_waitcnt lgkmcnt(7)
    v_mfma_f32_16x16x32_bf16 v[8:11], v[56:59], v[92:95], v[8:11]
    ds_read_b128 v[72:75], v115 offset:16384
    v_mfma_f32_16x16x32_bf16 v[12:15], v[60:63], v[92:95], v[12:15]
    ds_read_b128 v[76:79], v115 offset:17408
    s_waitcnt lgkmcnt(8)
    v_mfma_f32_16x16x32_bf16 v[16:19], v[56:59], v[96:99], v[16:19]
    ds_read_b128 v[80:83], v115 offset:18432
    s_waitcnt lgkmcnt(3)
    s_add_u32 m0, s65, 4096
    s_nop 0
    buffer_load_dwordx4 v112, s[32:35], s53 offen sc1 lds
    v_mfma_f32_16x16x32_bf16 v[20:23], v[60:63], v[96:99], v[20:23]
    ds_read_b128 v[84:87], v115 offset:19456
    buffer_load_dwordx4 v112, s[32:35], s53 offen offset:1024 sc1 lds
    s_add_u32 s53, s53, 2048
    s_cmp_ge_u32 s53, s54
    s_cselect_b32 s53, s52, s53
    v_mfma_f32_16x16x32_bf16 v[24:27], v[56:59], v[100:103], v[24:27]
    s_waitcnt vmcnt(4)
    ds_read_b64_tr_b16 v[48:49], v113 offset:0
    v_mfma_f32_16x16x32_bf16 v[28:31], v[60:63], v[100:103], v[28:31]
    ds_read_b64_tr_b16 v[50:51], v113 offset:256
    v_mfma_f32_16x16x32_bf16 v[32:35], v[104:107], v[56:59], v[32:35]
    ds_read_b64_tr_b16 v[52:53], v114 offset:0
    ds_read_b64_tr_b16 v[54:55], v114 offset:256
    v_mfma_f32_16x16x32_bf16 v[36:39], v[104:107], v[60:63], v[36:39]
    v_mov_b32 v5, 0
    buffer_load_dword v140, v5, s[32:35], s56 offen sc1
    s_cmp_lg_u32 s3, 7
    s_cbranch_scc1 w5c_66
    v_cmp_gt_u32 vcc, 8, v2
    v_mov_b32 v253, 4
    s_nop 0
    v_cndmask_b32 v253, 8, v253, vcc
    v_cmp_gt_u32 vcc, v253, v151
    s_nop 0
    s_cmp_eq_u64 vcc, 0
    s_cbranch_scc1 w5c_66
    s_cmp_lg_u32 s3, 7
    s_cbranch_scc1 wt_67
    s_and_b32 s59, s2, 3
    s_lshl_b32 s59, s59, 12
    s_add_u32 s59, s59, 37765120
    v_lshlrev_b32 v255, 8, v2
    v_cmp_gt_u32 vcc, 8, v2
    v_mov_b32 v253, 4
    s_nop 0
    v_cndmask_b32 v253, 8, v253, vcc
    s_mov_b32 s58, 40000
    s_cmp_lg_u32 s83, 0
    s_cbranch_scc1 polld_69
poll_68:
    buffer_load_dword v254, v255, s[32:35], s59 offen sc1
    s_waitcnt vmcnt(0)
    v_cmp_gt_u32 vcc, v253, v254
    s_nop 0
    s_cmp_eq_u64 vcc, 0
    s_cbranch_scc1 polld_69
    s_sub_u32 s58, s58, 1
    s_cmp_lg_u32 s58, 0
    s_cbranch_scc1 poll_68
    s_mov_b32 s83, 6
    v_mov_b32 v254, 6
    v_mov_b32 v255, 16
    buffer_store_dword v254, v255, s[36:39], 0 offen
polld_69:
wt_67:
w5c_66:
    s_barrier
    s_waitcnt lgkmcnt(7)
    v_mfma_f32_16x16x32_bf16 v[8:11], v[64:67], v[72:75], v[8:11]
    ds_read_b128 v[92:95], v115 offset:20480
    v_mfma_f32_16x16x32_bf16 v[12:15], v[68:71], v[72:75], v[12:15]
    ds_read_b128 v[96:99], v115 offset:21504
    s_waitcnt lgkmcnt(8)
    v_mfma_f32_16x16x32_bf16 v[16:19], v[64:67], v[76:79], v[16:19]
    ds_read_b128 v[100:103], v115 offset:22528
    s_waitcnt lgkmcnt(3)
    s_add_u32 m0, s65, 0
    s_nop 0
    buffer_load_dwordx4 v112, s[32:35], s53 offen sc1 lds
    v_mfma_f32_16x16x32_bf16 v[20:23], v[68:71], v[76:79], v[20:23]
    ds_read_b128 v[104:107], v115 offset:23552
    buffer_load_dwordx4 v112, s[32:35], s53 offen offset:1024 sc1 lds
    s_add_u32 s53, s53, 2048
    s_cmp_ge_u32 s53, s54
    s_cselect_b32 s53, s52, s53
    v_mfma_f32_16x16x32_bf16 v[24:27], v[64:67], v[80:83], v[24:27]
    s_waitcnt vmcnt(4)
    ds_read_b64_tr_b16 v[56:57], v113 offset:2048
    v_mfma_f32_16x16x32_bf16 v[28:31], v[68:71], v[80:83], v[28:31]
    ds_read_b64_tr_b16 v[58:59], v113 offset:2304
    v_mfma_f32_16x16x32_bf16 v[32:35], v[84:87], v[64:67], v[32:35]
    ds_read_b64_tr_b16 v[60:61], v114 offset:2048
    ds_read_b64_tr_b16 v[62:63], v114 offset:2304
    v_mfma_f32_16x16x32_bf16 v[36:39], v[84:87], v[68:71], v[36:39]
    s_waitcnt lgkmcnt(7)
    v_mfma_f32_16x16x32_bf16 v[8:11], v[48:51], v[92:95], v[8:11]
    ds_read_b128 v[72:75], v115 offset:24576
    v_mfma_f32_16x16x32_bf16 v[12:15], v[52:55], v[92:95], v[12:15]
    ds_read_b128 v[76:79], v115 offset:25600
    s_waitcnt lgkmcnt(8)
    v_mfma_f32_16x16x32_bf16 v[16:19], v[48:51], v[96:99], v[16:19]
    ds_read_b128 v[80:83], v115 offset:26624
    s_waitcnt lgkmcnt(3)
    s_add_u32 m0, s65, 2048
    s_nop 0
    buffer_load_dwordx4 v112, s[32:35], s53 offen sc1 lds
    v_mfma_f32_16x16x32_bf16 v[20:23], v[52:55], v[96:99], v[20:23]
    ds_read_b128 v[84:87], v115 offset:27648
    buffer_load_dwordx4 v112, s[32:35], s53 offen offset:1024 sc1 lds
    s_add_u32 s53, s53, 2048
    s_cmp_ge_u32 s53, s54
    s_cselect_b32 s53, s52, s53
    v_mfma_f32_16x16x32_bf16 v[24:27], v[48:51], v[100:103], v[24:27]
    s_waitcnt vmcnt(4)
    ds_read_b64_tr_b16 v[64:65], v113 offset:4096
    v_mfma_f32_16x16x32_bf16 v[28:31], v[52:55], v[100:103], v[28:31]
    ds_read_b64_tr_b16 v[66:67], v113 offset:4352
    v_mfma_f32_16x16x32_bf16 v[32:35], v[104:107], v[48:51], v[32:35]
    ds_read_b64_tr_b16 v[68:69], v114 offset:4096
    ds_read_b64_tr_b16 v[70:71], v114 offset:4352
    v_mfma_f32_16x16x32_bf16 v[36:39], v[104:107], v[52:55], v[36:39]
    s_waitcnt lgkmcnt(7)
    v_mfma_f32_16x16x32_bf16 v[8:11], v[56:59], v[72:75], v[8:11]
    ds_read_b128 v[92:95], v115 offset:28672
    v_mfma_f32_16x16x32_bf16 v[12:15], v[60:63], v[72:75], v[12:15]
    ds_read_b128 v[96:99], v115 offset:29696
    s_waitcnt lgkmcnt(8)
    v_mfma_f32_16x16x32_bf16 v[16:19], v[56:59], v[76:79], v[16:19]
    ds_read_b128 v[100:103], v115 offset:30720
    v_mfma_f32_16x16x32_bf16 v[20:23], v[60:63], v[76:79], v[20:23]
    ds_read_b128 v[104:107], v115 offset:31744
    s_waitcnt lgkmcnt(9)
    v_mfma_f32_16x16x32_bf16 v[24:27], v[56:59], v[80:83], v[24:27]
    s_waitcnt vmcnt(2)
    ds_read_b64_tr_b16 v[48:49], v113 offset:0
    v_mfma_f32_16x16x32_bf16 v[28:31], v[60:63], v[80:83], v[28:31]
    ds_read_b64_tr_b16 v[50:51], v113 offset:256
    s_waitcnt lgkmcnt(10)
    v_mfma_f32_16x16x32_bf16 v[32:35], v[84:87], v[56:59], v[32:35]
    ds_read_b64_tr_b16 v[52:53], v114 offset:0
    ds_read_b64_tr_b16 v[54:55], v114 offset:256
    v_mfma_f32_16x16x32_bf16 v[36:39], v[84:87], v[60:63], v[36:39]
    v_cmp_gt_u32 vcc, 20, v140
    s_nop 0
    s_cmp_eq_u64 vcc, 0
    s_cbranch_scc1 ssp_70
    v_mov_b32 v255, 0
    s_mov_b32 s58, 40000
    s_cmp_lg_u32 s83, 0
    s_cbranch_scc1 polld_72
poll_71:
    buffer_load_dword v254, v255, s[32:35], s56 offen sc1
    s_waitcnt vmcnt(0)
    v_cmp_gt_u32 vcc, 20, v254
    s_nop 0
    s_cmp_eq_u64 vcc, 0
    s_cbranch_scc1 polld_72
    s_sub_u32 s58, s58, 1
    s_cmp_lg_u32 s58, 0
    s_cbranch_scc1 poll_71
    s_mov_b32 s83, 20
    v_mov_b32 v254, 20
    v_mov_b32 v255, 16
    buffer_store_dword v254, v255, s[36:39], 0 offen
polld_72:
ssp_70:
    v_lshlrev_b32 v5, 4, v3
    v_lshlrev_b32 v6, 2, v2
    buffer_load_dwordx4 v[140:143], v5, s[32:35], s55 offen sc1
    buffer_load_dwordx4 v[144:147], v5, s[32:35], s55 offen offset:64 sc1
    buffer_load_dword v148, v6, s[32:35], s55 offen sc1
    buffer_load_dword v149, v6, s[32:35], s55 offen offset:64 sc1
    s_waitcnt lgkmcnt(7)
    v_mfma_f32_16x16x32_bf16 v[8:11], v[64:67], v[92:95], v[8:11]
    ds_read_b128 v[72:75], v115 offset:32768
    v_mfma_f32_16x16x32_bf16 v[12:15], v[68:71], v[92:95], v[12:15]
    ds_read_b128 v[76:79], v115 offset:33792
    s_waitcnt lgkmcnt(8)
    v_mfma_f32_16x16x32_bf16 v[16:19], v[64:67], v[96:99], v[16:19]
    ds_read_b128 v[80:83], v115 offset:34816
    v_mfma_f32_16x16x32_bf16 v[20:23], v[68:71], v[96:99], v[20:23]
    ds_read_b128 v[84:87], v115 offset:35840
    s_waitcnt lgkmcnt(9)
    v_mfma_f32_16x16x32_bf16 v[24:27], v[64:67], v[100:103], v[24:27]
    s_waitcnt vmcnt(4)
    ds_read_b64_tr_b16 v[56:57], v113 offset:2048
    v_mfma_f32_16x16x32_bf16 v[28:31], v[68:71], v[100:103], v[28:31]
    ds_read_b64_tr_b16 v[58:59], v113 offset:2304
    s_waitcnt lgkmcnt(10)
    v_mfma_f32_16x16x32_bf16 v[32:35], v[104:107], v[64:67], v[32:35]
    ds_read_b64_tr_b16 v[60:61], v114 offset:2048
    ds_read_b64_tr_b16 v[62:63], v114 offset:2304
    v_mfma_f32_16x16x32_bf16 v[36:39], v[104:107], v[68:71], v[36:39]
    s_waitcnt lgkmcnt(7)
    v_mfma_f32_16x16x32_bf16 v[8:11], v[48:51], v[72:75], v[8:11]
    ds_read_b128 v[92:95], v115 offset:36864
    v_mfma_f32_16x16x32_bf16 v[12:15], v[52:55], v[72:75], v[12:15]
    ds_read_b128 v[96:99], v115 offset:37888
    s_waitcnt lgkmcnt(8)
    v_mfma_f32_16x16x32_bf16 v[16:19], v[48:51], v[76:79], v[16:19]
    ds_read_b128 v[100:103], v115 offset:38912
    v_mfma_f32_16x16x32_bf16 v[20:23], v[52:55], v[76:79], v[20:23]
    ds_read_b128 v[104:107], v115 offset:39936
    s_waitcnt lgkmcnt(9)
    v_mfma_f32_16x16x32_bf16 v[24:27], v[48:51], v[80:83], v[24:27]
    v_mfma_f32_16x16x32_bf16 v[28:31], v[52:55], v[80:83], v[28:31]
    s_waitcnt lgkmcnt(8)
    v_mfma_f32_16x16x32_bf16 v[32:35], v[84:87], v[48:51], v[32:35]
    v_mfma_f32_16x16x32_bf16 v[36:39], v[84:87], v[52:55], v[36:39]
    s_mov_b32 s40, 0x36a3d70a
    v_mov_b32 v7, 0x3727c5ac
    s_waitcnt vmcnt(0)
    v_fma_f32 v140, v140, s40, v7
    v_fma_f32 v141, v141, s40, v7
    v_fma_f32 v142, v142, s40, v7
    v_fma_f32 v143, v143, s40, v7
    v_fma_f32 v144, v144, s40, v7
    v_fma_f32 v145, v145, s40, v7
    v_fma_f32 v146, v146, s40, v7
    v_fma_f32 v147, v147, s40, v7
    v_fma_f32 v148, v148, s40, v7
    v_fma_f32 v149, v149, s40, v7
    v_rsq_f32 v140, v140
    v_rsq_f32 v141, v141
    v_rsq_f32 v142, v142
    v_rsq_f32 v143, v143
    v_rsq_f32 v144, v144
    v_rsq_f32 v145, v145
    v_rsq_f32 v146, v146
    v_rsq_f32 v147, v147
    v_rsq_f32 v148, v148
    v_rsq_f32 v149, v149
    s_waitcnt lgkmcnt(3)
    v_mfma_f32_16x16x32_bf16 v[8:11], v[56:59], v[92:95], v[8:11]
    v_mfma_f32_16x16x32_bf16 v[12:15], v[60:63], v[92:95], v[12:15]
    s_waitcnt lgkmcnt(2)
    v_mfma_f32_16x16x32_bf16 v[16:19], v[56:59], v[96:99], v[16:19]
    v_mfma_f32_16x16x32_bf16 v[20:23], v[60:63], v[96:99], v[20:23]
    s_waitcnt lgkmcnt(1)
    v_mfma_f32_16x16x32_bf16 v[24:27], v[56:59], v[100:103], v[24:27]
    v_mfma_f32_16x16x32_bf16 v[28:31], v[60:63], v[100:103], v[28:31]
    s_waitcnt lgkmcnt(0)
    v_mfma_f32_16x16x32_bf16 v[32:35], v[104:107], v[56:59], v[32:35]
    v_mfma_f32_16x16x32_bf16 v[36:39], v[104:107], v[60:63], v[36:39]
    v_mov_b32 v58, 0x358637bd
    s_mov_b32 s41, 0x3fb8aa3b
    v_mul_f32 v16, v16, v140
    v_mul_f32 v17, v17, v141
    v_mul_f32 v18, v18, v142
    v_mul_f32 v19, v19, v143
    v_mul_f32 v20, v20, v144
    v_mul_f32 v21, v21, v145
    v_mul_f32 v22, v22, v146
    v_mul_f32 v23, v23, v147
    v_cvt_pk_bf16_f32 v84, v16, v17
    v_cvt_pk_bf16_f32 v85, v18, v19
    v_cvt_pk_bf16_f32 v86, v20, v21
    v_cvt_pk_bf16_f32 v87, v22, v23
    v_fma_f32 v64, v140, v122, v123
    v_fma_f32 v65, v141, v122, v123
    v_fma_f32 v66, v142, v122, v123
    v_fma_f32 v67, v143, v122, v123
    v_fma_f32 v68, v144, v122, v123
    v_fma_f32 v69, v145, v122, v123
    v_fma_f32 v70, v146, v122, v123
    v_fma_f32 v71, v147, v122, v123
    v_fma_f32 v8, v8, v140, v58
    v_fma_f32 v9, v9, v141, v58
    v_fma_f32 v10, v10, v142, v58
    v_fma_f32 v11, v11, v143, v58
    v_fma_f32 v12, v12, v144, v58
    v_fma_f32 v13, v13, v145, v58
    v_fma_f32 v14, v14, v146, v58
    v_fma_f32 v15, v15, v147, v58
    v_mul_f32 v72, s41, v8
    v_mul_f32 v73, s41, v9
    v_mul_f32 v74, s41, v10
    v_mul_f32 v75, s41, v11
    v_mul_f32 v76, s41, v12
    v_mul_f32 v77, s41, v13
    v_mul_f32 v78, s41, v14
    v_mul_f32 v79, s41, v15
    v_exp_f32_e64 v72, v72 clamp
    v_exp_f32_e64 v73, v73 clamp
    v_exp_f32_e64 v74, v74 clamp
    v_exp_f32_e64 v75, v75 clamp
    v_exp_f32_e64 v76, v76 clamp
    v_exp_f32_e64 v77, v77 clamp
    v_exp_f32_e64 v78, v78 clamp
    v_exp_f32_e64 v79, v79 clamp
    v_max_f32 v8, v8, v58
    v_max_f32 v9, v9, v58
    v_max_f32 v10, v10, v58
    v_max_f32 v11, v11, v58
    v_max_f32 v12, v12, v58
    v_max_f32 v13, v13, v58
    v_max_f32 v14, v14, v58
    v_max_f32 v15, v15, v58
    v_add_f32 v8, v8, v72
    v_add_f32 v9, v9, v73
    v_add_f32 v10, v10, v74
    v_add_f32 v11, v11, v75
    v_add_f32 v12, v12, v76
    v_add_f32 v13, v13, v77
    v_add_f32 v14, v14, v78
    v_add_f32 v15, v15, v79
    v_cvt_pk_bf16_f32 v80, v8, v9
    v_cvt_pk_bf16_f32 v81, v10, v11
    v_cvt_pk_bf16_f32 v82, v12, v13
    v_cvt_pk_bf16_f32 v83, v14, v15
    v_fma_f32 v24, v24, v64, v119
    v_fma_f32 v25, v25, v65, v119
    v_fma_f32 v26, v26, v66, v119
    v_fma_f32 v27, v27, v67, v119
    v_fma_f32 v28, v28, v68, v119
    v_fma_f32 v29, v29, v69, v119
    v_fma_f32 v30, v30, v70, v119
    v_fma_f32 v31, v31, v71, v119
    v_mul_f32 v72, s41, v24
    v_mul_f32 v73, s41, v25
    v_mul_f32 v74, s41, v26
    v_mul_f32 v75, s41, v27
    v_mul_f32 v76, s41, v28
    v_mul_f32 v77, s41, v29
    v_mul_f32 v78, s41, v30
    v_mul_f32 v79, s41, v31
    v_exp_f32_e64 v72, v72 clamp
    v_exp_f32_e64 v73, v73 clamp
    v_exp_f32_e64 v74, v74 clamp
    v_exp_f32_e64 v75, v75 clamp
    v_exp_f32_e64 v76, v76 clamp
    v_exp_f32_e64 v77, v77 clamp
    v_exp_f32_e64 v78, v78 clamp
    v_exp_f32_e64 v79, v79 clamp
    v_max_f32 v24, v24, v120
    v_max_f32 v25, v25, v120
    v_max_f32 v26, v26, v120
    v_max_f32 v27, v27, v120
    v_max_f32 v28, v28, v120
    v_max_f32 v29, v29, v120
    v_max_f32 v30, v30, v120
    v_max_f32 v31, v31, v120
    v_fma_f32 v24, v72, v121, v24
    v_fma_f32 v25, v73, v121, v25
    v_fma_f32 v26, v74, v121, v26
    v_fma_f32 v27, v75, v121, v27
    v_fma_f32 v28, v76, v121, v28
    v_fma_f32 v29, v77, v121, v29
    v_fma_f32 v30, v78, v121, v30
    v_fma_f32 v31, v79, v121, v31
    v_cvt_pk_bf16_f32 v88, v24, v25
    v_cvt_pk_bf16_f32 v89, v26, v27
    v_cvt_pk_bf16_f32 v90, v28, v29
    v_cvt_pk_bf16_f32 v91, v30, v31
    v_cmp_gt_u32 vcc, 12, v2
    s_nop 1
    v_cndmask_b32 v88, 0, v88, vcc
    v_cndmask_b32 v89, 0, v89, vcc
    v_cndmask_b32 v90, 0, v90, vcc
    v_cndmask_b32 v91, 0, v91, vcc
    v_mov_b32 v5, 0x3f803f80
    v_cmp_gt_u32 vcc, 4, v2
    s_nop 1
    v_cndmask_b32 v92, v88, v5, vcc
    v_cndmask_b32 v93, v89, v5, vcc
    v_cndmask_b32 v94, v90, v5, vcc
    v_cndmask_b32 v95, v91, v5, vcc
    v_mfma_f32_16x16x32_bf16 v[8:11], v[80:83], v[84:87], 0
    v_mfma_f32_16x16x32_bf16 v[12:15], v[88:91], v[84:87], 0
    v_mfma_f32_16x16x32_bf16 v[16:19], v[80:83], v[92:95], 0
    v_mfma_f32_16x16x32_bf16 v[20:23], v[88:91], v[92:95], 0
    v_mfma_f32_16x16x32_bf16 v[24:27], v[88:91], v[124:127], 0
    v_mfma_f32_16x16x32_bf16 v[28:31], v[88:91], v[128:131], 0
    v_add_u32 v6, s65, v4
    s_nop 1
    ds_write_b128 v6, v[8:11] offset:0
    ds_write_b128 v6, v[12:15] offset:1024
    ds_write_b128 v6, v[16:19] offset:2048
    ds_write_b128 v6, v[20:23] offset:3072
    s_cmp_ge_u32 s3, 4
    s_cbranch_scc1 lead_73
    s_mul_i32 s40, s6, 102400
    s_add_u32 s40, s40, 24248320
    s_lshl_b32 s41, s3, 14
    s_cmp_eq_u32 s3, 3
    s_cselect_b32 s41, 86016, s41
    s_add_u32 s40, s40, s41
    s_add_u32 s45, s40, 0
    s_add_u32 m0, s41, 0
    s_nop 0
    buffer_load_dwordx4 v4, s[32:35], s45 offen offset:0 sc1 lds
    buffer_load_dwordx4 v4, s[32:35], s45 offen offset:1024 sc1 lds
    buffer_load_dwordx4 v4, s[32:35], s45 offen offset:2048 sc1 lds
    buffer_load_dwordx4 v4, s[32:35], s45 offen offset:3072 sc1 lds
    s_add_u32 s45, s40, 4096
    s_add_u32 m0, s41, 4096
    s_nop 0
    buffer_load_dwordx4 v4, s[32:35], s45 offen offset:0 sc1 lds
    buffer_load_dwordx4 v4, s[32:35], s45 offen offset:1024 sc1 lds
    buffer_load_dwordx4 v4, s[32:35], s45 offen offset:2048 sc1 lds
    buffer_load_dwordx4 v4, s[32:35], s45 offen offset:3072 sc1 lds
    s_add_u32 s45, s40, 8192
    s_add_u32 m0, s41, 8192
    s_nop 0
    buffer_load_dwordx4 v4, s[32:35], s45 offen offset:0 sc1 lds
    buffer_load_dwordx4 v4, s[32:35], s45 offen offset:1024 sc1 lds
    buffer_load_dwordx4 v4, s[32:35], s45 offen offset:2048 sc1 lds
    buffer_load_dwordx4 v4, s[32:35], s45 offen offset:3072 sc1 lds
    s_add_u32 s45, s40, 12288
    s_add_u32 m0, s41, 12288
    s_nop 0
    buffer_load_dwordx4 v4, s[32:35], s45 offen offset:0 sc1 lds
    buffer_load_dwordx4 v4, s[32:35], s45 offen offset:1024 sc1 lds
    buffer_load_dwordx4 v4, s[32:35], s45 offen offset:2048 sc1 lds
    buffer_load_dwordx4 v4, s[32:35], s45 offen offset:3072 sc1 lds
    s_mov_b32 s41, 0x3fb8aa3b
lead_73:
    s_waitcnt lgkmcnt(0)
    s_barrier
    s_mul_i32 s57, s71, 14336
    s_add_u32 s57, s57, 36700160
    s_cmp_eq_u32 s3, 7
    s_cbranch_scc1 kvs_76
    ds_read_b32 v8, v118 offset:0
    ds_read_b32 v9, v118 offset:6144
    ds_read_b32 v10, v118 offset:12288
    ds_read_b32 v11, v118 offset:18432
    ds_read_b32 v12, v118 offset:24576
    ds_read_b32 v13, v118 offset:30720
    ds_read_b32 v14, v118 offset:36864
    ds_read_b32 v15, v118 offset:43008
    v_lshlrev_b32 v6, 2, v0
    s_mul_i32 s40, s80, 1792
    s_add_u32 s40, s40, s57
    s_waitcnt lgkmcnt(0)
    v_add_f32 v8, v8, v9
    v_add_f32 v10, v10, v11
    v_add_f32 v12, v12, v13
    v_add_f32 v14, v14, v15
    v_add_f32 v8, v8, v10
    v_add_f32 v12, v12, v14
    v_add_f32 v8, v8, v12
    v_max_u32 v8, 1, v8
    buffer_store_dword v8, v6, s[32:35], s40 offen sc1
kvs_76:
    v_fma_f32 v32, v32, v148, v58
    v_fma_f32 v33, v33, v148, v58
    v_fma_f32 v34, v34, v148, v58
    v_fma_f32 v35, v35, v148, v58
    v_fma_f32 v36, v36, v149, v58
    v_fma_f32 v37, v37, v149, v58
    v_fma_f32 v38, v38, v149, v58
    v_fma_f32 v39, v39, v149, v58
    v_mul_f32 v72, s41, v32
    v_mul_f32 v73, s41, v33
    v_mul_f32 v74, s41, v34
    v_mul_f32 v75, s41, v35
    v_mul_f32 v76, s41, v36
    v_mul_f32 v77, s41, v37
    v_mul_f32 v78, s41, v38
    v_mul_f32 v79, s41, v39
    v_exp_f32_e64 v72, v72 clamp
    v_exp_f32_e64 v73, v73 clamp
    v_exp_f32_e64 v74, v74 clamp
    v_exp_f32_e64 v75, v75 clamp
    v_exp_f32_e64 v76, v76 clamp
    v_exp_f32_e64 v77, v77 clamp
    v_exp_f32_e64 v78, v78 clamp
    v_exp_f32_e64 v79, v79 clamp
    v_max_f32 v32, v32, v58
    v_max_f32 v33, v33, v58
    v_max_f32 v34, v34, v58
    v_max_f32 v35, v35, v58
    v_max_f32 v36, v36, v58
    v_max_f32 v37, v37, v58
    v_max_f32 v38, v38, v58
    v_max_f32 v39, v39, v58
    v_add_f32 v32, v32, v72
    v_add_f32 v33, v33, v73
    v_add_f32 v34, v34, v74
    v_add_f32 v35, v35, v75
    v_add_f32 v36, v36, v76
    v_add_f32 v37, v37, v77
    v_add_f32 v38, v38, v78
    v_add_f32 v39, v39, v79
    v_cvt_pk_bf16_f32 v96, v32, v33
    v_cvt_pk_bf16_f32 v97, v34, v35
    v_cvt_pk_bf16_f32 v98, v24, v25
    v_cvt_pk_bf16_f32 v99, v26, v27
    v_cvt_pk_bf16_f32 v100, v36, v37
    v_cvt_pk_bf16_f32 v101, v38, v39
    v_cvt_pk_bf16_f32 v102, v28, v29
    v_cvt_pk_bf16_f32 v103, v30, v31
    s_mul_i32 s44, s64, 40960
    s_add_u32 s44, s44, 5242880
    s_cmp_eq_u32 s3, 7
    s_cbranch_scc1 kv7_74
    s_mov_b32 s58, 40000
kvp_77:
    buffer_load_dwordx4 v[8:11], v132, s[32:35], s57 offen sc1
    buffer_load_dwordx4 v[12:15], v132, s[32:35], s57 offen offset:128 sc1
    s_waitcnt vmcnt(0)
    v_min3_u32 v16, v8, v9, v10
    v_min3_u32 v17, v11, v12, v13
    v_min3_u32 v16, v16, v14, v15
    v_min_u32 v16, v16, v17
    v_cmp_eq_u32 vcc, 0, v16
    s_nop 0
    s_cmp_eq_u64 vcc, 0
    s_cbranch_scc1 kvd_78
    s_cmp_lg_u32 s83, 0
    s_cbranch_scc1 kvd_78
    s_sub_u32 s58, s58, 1
    s_cmp_lg_u32 s58, 0
    s_cbranch_scc1 kvp_77
    s_mov_b32 s83, 30
    v_mov_b32 v254, 30
    v_mov_b32 v255, 16
    buffer_store_dword v254, v255, s[36:39], 0 offen
    s_branch kvd_78
kvd_78:
    v_permlane32_swap_b32 v8, v12
    v_permlane32_swap_b32 v9, v13
    v_permlane32_swap_b32 v10, v14
    v_permlane32_swap_b32 v11, v15
    v_add_f32 v8, v8, v12
    v_add_f32 v9, v9, v13
    v_add_f32 v10, v10, v14
    v_add_f32 v11, v11, v15
    s_nop 0
    v_permlane16_swap_b32 v8, v10
    v_permlane16_swap_b32 v9, v11
    v_add_f32 v8, v8, v10
    v_add_f32 v9, v9, v11
    s_nop 0
    v_add_f32_dpp v8, v8, v8 row_ror:8 row_mask:0xf bank_mask:0xf
    v_add_f32_dpp v9, v9, v9 row_ror:8 row_mask:0xf bank_mask:0xf
    v_cvt_pk_bf16_f32 v8, v8, v9
    ds_write_b32 v133, v8
    s_waitcnt lgkmcnt(0)
    s_branch kvj_75
kv7_74:
    s_mul_i32 s40, s6, 102400
    s_add_u32 s40, s40, 24248320
    s_add_u32 s41, s40, 49152
    s_mov_b32 m0, 49152
    s_nop 0
    buffer_load_dwordx4 v4, s[32:35], s41 offen offset:0 sc1 lds
    buffer_load_dwordx4 v4, s[32:35], s41 offen offset:1024 sc1 lds
    buffer_load_dwordx4 v4, s[32:35], s41 offen offset:2048 sc1 lds
    buffer_load_dwordx4 v4, s[32:35], s41 offen offset:3072 sc1 lds
    s_add_u32 s41, s40, 53248
    s_mov_b32 m0, 53248
    s_nop 0
    buffer_load_dwordx4 v4, s[32:35], s41 offen offset:0 sc1 lds
    buffer_load_dwordx4 v4, s[32:35], s41 offen offset:1024 sc1 lds
    buffer_load_dwordx4 v4, s[32:35], s41 offen offset:2048 sc1 lds
    buffer_load_dwordx4 v4, s[32:35], s41 offen offset:3072 sc1 lds
    s_add_u32 s41, s40, 57344
    s_mov_b32 m0, 57344
    s_nop 0
    buffer_load_dwordx4 v4, s[32:35], s41 offen offset:0 sc1 lds
    buffer_load_dwordx4 v4, s[32:35], s41 offen offset:1024 sc1 lds
    buffer_load_dwordx4 v4, s[32:35], s41 offen offset:2048 sc1 lds
    buffer_load_dwordx4 v4, s[32:35], s41 offen offset:3072 sc1 lds
    s_add_u32 s41, s40, 61440
    s_mov_b32 m0, 61440
    s_nop 0
    buffer_load_dwordx4 v4, s[32:35], s41 offen offset:0 sc1 lds
    buffer_load_dwordx4 v4, s[32:35], s41 offen offset:1024 sc1 lds
    buffer_load_dwordx4 v4, s[32:35], s41 offen offset:2048 sc1 lds
    buffer_load_dwordx4 v4, s[32:35], s41 offen offset:3072 sc1 lds
    s_add_u32 s41, s40, 65536
    s_mov_b32 m0, 65536
    s_nop 0
    buffer_load_dwordx4 v4, s[32:35], s41 offen offset:0 sc1 lds
    buffer_load_dwordx4 v4, s[32:35], s41 offen offset:1024 sc1 lds
    buffer_load_dwordx4 v4, s[32:35], s41 offen offset:2048 sc1 lds
    buffer_load_dwordx4 v4, s[32:35], s41 offen offset:3072 sc1 lds
    s_add_u32 s41, s40, 69632
    s_mov_b32 m0, 69632
    s_nop 0
    buffer_load_dwordx4 v4, s[32:35], s41 offen offset:0 sc1 lds
    buffer_load_dwordx4 v4, s[32:35], s41 offen offset:1024 sc1 lds
    buffer_load_dwordx4 v4, s[32:35], s41 offen offset:2048 sc1 lds
    buffer_load_dwordx4 v4, s[32:35], s41 offen offset:3072 sc1 lds
    s_add_u32 s41, s40, 73728
    s_mov_b32 m0, 73728
    s_nop 0
    buffer_load_dwordx4 v4, s[32:35], s41 offen offset:0 sc1 lds
    buffer_load_dwordx4 v4, s[32:35], s41 offen offset:1024 sc1 lds
    buffer_load_dwordx4 v4, s[32:35], s41 offen offset:2048 sc1 lds
    buffer_load_dwordx4 v4, s[32:35], s41 offen offset:3072 sc1 lds
    s_add_u32 s41, s40, 77824
    s_mov_b32 m0, 77824
    s_nop 0
    buffer_load_dwordx4 v4, s[32:35], s41 offen offset:0 sc1 lds
    buffer_load_dwordx4 v4, s[32:35], s41 offen offset:1024 sc1 lds
    buffer_load_dwordx4 v4, s[32:35], s41 offen offset:2048 sc1 lds
    buffer_load_dwordx4 v4, s[32:35], s41 offen offset:3072 sc1 lds
    s_add_u32 s41, s40, 81920
    s_mov_b32 m0, 81920
    s_nop 0
    buffer_load_dwordx4 v4, s[32:35], s41 offen offset:0 sc1 lds
    buffer_load_dwordx4 v4, s[32:35], s41 offen offset:1024 sc1 lds
    buffer_load_dwordx4 v4, s[32:35], s41 offen offset:2048 sc1 lds
    buffer_load_dwordx4 v4, s[32:35], s41 offen offset:3072 sc1 lds
kvj_75:
    s_barrier
    ds_read_b128 v[28:31], v135
    ds_read_b128 v[24:27], v134
    s_waitcnt lgkmcnt(0)
    v_mfma_f32_16x16x32_bf16 v[36:39], v[28:31], v[96:99], 0
    v_mfma_f32_16x16x32_bf16 v[44:47], v[28:31], v[100:103], 0
    v_mfma_f32_16x16x32_bf16 v[32:35], v[24:27], v[96:99], 0
    v_mfma_f32_16x16x32_bf16 v[40:43], v[24:27], v[100:103], 0
    s_nop 4
    v_mov_b32 v8, v36
    v_mov_b32 v9, v36
    v_mov_b32 v10, v44
    v_mov_b32 v11, v44
    v_permlane16_swap_b32 v8, v9
    s_nop 0
    v_permlane16_swap_b32 v10, v11
    v_add_f32 v9, v9, v58
    v_add_f32 v11, v11, v58
    v_rcp_f32 v9, v9
    v_rcp_f32 v11, v11
    v_mul_f32 v32, v32, v9
    v_mul_f32 v33, v33, v9
    v_mul_f32 v34, v34, v9
    v_mul_f32 v35, v35, v9
    v_mul_f32 v36, v36, v9
    v_mul_f32 v37, v37, v9
    v_mul_f32 v38, v38, v9
    v_mul_f32 v39, v39, v9
    v_cvt_pk_bf16_f32 v12, v32, v33
    v_cvt_pk_bf16_f32 v13, v34, v35
    v_cvt_pk_bf16_f32 v14, v36, v37
    v_cvt_pk_bf16_f32 v15, v38, v39
    v_max_u32 v12, 1, v12
    v_max_u32 v13, 1, v13
    v_max_u32 v14, 1, v14
    v_max_u32 v15, 1, v15
    buffer_store_dwordx2 v[12:13], v136, s[32:35], s44 offen offset:0 sc1
    v_mul_f32 v40, v40, v11
    v_mul_f32 v41, v41, v11
    v_mul_f32 v42, v42, v11
    v_mul_f32 v43, v43, v11
    v_mul_f32 v44, v44, v11
    v_mul_f32 v45, v45, v11
    v_mul_f32 v46, v46, v11
    v_mul_f32 v47, v47, v11
    v_cvt_pk_bf16_f32 v16, v40, v41
    v_cvt_pk_bf16_f32 v17, v42, v43
    v_cvt_pk_bf16_f32 v18, v44, v45
    v_cvt_pk_bf16_f32 v19, v46, v47
    v_max_u32 v16, 1, v16
    v_max_u32 v17, 1, v17
    v_max_u32 v18, 1, v18
    v_max_u32 v19, 1, v19
    buffer_store_dwordx2 v[16:17], v136, s[32:35], s44 offen offset:128 sc1
    s_mov_b64 exec, 0xffff
    buffer_store_dwordx2 v[14:15], v137, s[32:35], s44 offen sc1
    buffer_store_dwordx2 v[18:19], v137, s[32:35], s44 offen offset:128 sc1
    s_mov_b64 exec, -1
    s_mul_i32 s40, s61, 51200
    v_add_u32 v21, s40, v4
    s_mul_i32 s64, s7, 81920
    s_mul_i32 s40, s6, 5120
    s_add_u32 s64, s64, s40
    s_add_u32 s66, s64, 34078720
    s_add_u32 s64, s64, 10485760
    s_mov_b32 s65, 37617664
    v_lshrrev_b32 v10, 3, v1
    v_and_b32 v11, 7, v1
    s_lshl_b32 s42, s60, 3
    s_mul_i32 s43, s61, 40960
    s_lshl_b32 s44, s60, 9
    s_add_u32 s43, s43, s44
    v_lshlrev_b32 v9, 3, v1
    v_add_u32 v9, s43, v9
    v_xor_b32 v11, v11, v10
    v_lshlrev_b32 v11, 4, v11
    v_lshl_add_u32 v10, v10, 7, v11
    s_mul_i32 s43, s61, 10240
    s_lshl_b32 s44, s60, 10
    s_add_u32 s43, s43, s44
    s_add_u32 s43, s43, 102400
    v_add_u32 v10, s43, v10
    v_lshlrev_b32 v8, 1, v3
    s_lshr_b32 s44, s62, 2
    v_add_u32 v8, s44, v8
    v_and_b32 v11, 7, v2
    v_xor_b32 v8, v8, v11
    v_lshlrev_b32 v8, 4, v8
    v_lshl_add_u32 v8, v2, 7, v8
    s_mul_i32 s43, s61, 20480
    s_mul_i32 s44, s63, 10240
    s_add_u32 s43, s43, s44
    s_add_u32 s43, s43, 102400
    v_add_u32 v8, s43, v8
    s_add_u32 s46, s66, 4096
    s_cmp_ge_u32 s60, 2
    s_cselect_b32 s46, 2146435072, s46
    buffer_load_dwordx2 v[12:13], v9, s[32:35], s66 offen sc1
    buffer_load_dwordx2 v[14:15], v9, s[32:35], s66 offen offset:2048 sc1
    buffer_load_dwordx2 v[16:17], v9, s[32:35], s46 offen sc1
    v_lshrrev_b32 v140, 2, v2
    v_and_b32 v141, 3, v2
    v_lshl_add_u32 v141, v140, 3, v141
    v_add_u32 v141, s62, v141
    v_lshrrev_b32 v136, 3, v0
    s_mov_b32 s41, 40960
    v_mul_lo_u32 v136, v136, s41
    v_bfe_u32 v138, v0, 2, 1
    v_mul_u32_u24 v139, 3, v138
    v_xor_b32 v139, v139, v1
    v_and_b32 v137, 7, v139
    v_lshl_add_u32 v136, v137, 4, v136
    v_and_b32 v137, 3, v139
    v_lshlrev_b32 v137, 4, v137
    v_lshl_add_u32 v137, v138, 14, v137
    v_lshrrev_b32 v138, 3, v0
    v_lshl_add_u32 v137, v138, 6, v137
    s_lshl_b32 s40, s3, 10
    s_lshr_b32 s42, s3, 1
    s_lshr_b32 s43, s3, 2
    s_xor_b32 s42, s42, s43
    s_lshl_b32 s42, s42, 6
    v_lshlrev_b32 v138, 4, v139
    v_xor_b32 v138, s42, v138
    s_add_u32 s40, s40, 102400
    v_add_u32 v138, s40, v138
    v_lshrrev_b32 v141, 2, v141
    s_lshl_b32 s40, s63, 2
    v_add_u32 v140, s40, v3
    v_lshl_add_u32 v141, v141, 3, v140
    v_and_b32 v143, 3, v2
    v_lshl_add_u32 v139, v141, 3, v143
    v_lshrrev_b32 v144, 2, v2
    v_lshrrev_b32 v145, 3, v2
    v_xor_b32 v144, v144, v145
    v_lshlrev_b32 v144, 2, v144
    v_xor_b32 v139, v139, v144
    s_lshl_b32 s40, s61, 13
    s_add_u32 s42, s40, 102400
    v_lshl_add_u32 v139, v139, 4, s42
    v_xor_b32 v140, 512, v139
    v_mul_lo_u32 v141, v141, s41
    v_lshl_add_u32 v141, v143, 4, v141
    s_lshl_b32 s43, s63, 12
    s_add_u32 s43, s43, s40
    s_add_u32 s43, s43, 135168
    s_lshl_b32 s44, s62, 1
    s_add_u32 s45, s44, s43
    v_add_u32 v143, s45, v4
    s_lshl_b32 s45, s62, 9
    s_add_u32 s45, s45, s43
    v_add_u32 v144, s45, v4
    s_lshl_b32 s43, s63, 11
    s_add_u32 s43, s43, s40
    s_add_u32 s43, s43, 135168
    s_add_u32 s45, s44, s43
    v_add_u32 v145, s45, v4
    s_lshl_b32 s45, s62, 10
    s_add_u32 s45, s45, s43
    v_add_u32 v146, s45, v4
    v_xor_b32 v147, 2048, v146
    s_cmp_eq_u32 s73, 159
    s_cselect_b32 s40, 4, 99
    v_and_b32 v148, 4, v0
    v_cmp_ne_u32 vcc, s40, v148
    s_nop 1
    v_cndmask_b32 v148, 0, -1, vcc
    s_lshl_b32 s48, s7, 2
    s_add_u32 s48, s48, s60
    s_mul_i32 s48, s48, 20480
    s_mul_i32 s41, s61, 10240
    s_add_u32 s48, s48, s41
    s_add_u32 s48, s48, 5242880
    s_add_u32 s49, s48, 4096
    s_add_u32 s50, s48, 8192
    s_mov_b32 s58, 40000
    s_waitcnt vmcnt(0)
    s_barrier
    buffer_load_dwordx4 v[84:87], v4, s[32:35], s48 offen offset:0 sc1
    buffer_load_dwordx4 v[88:91], v4, s[32:35], s48 offen offset:1024 sc1
    buffer_load_dwordx4 v[92:95], v4, s[32:35], s48 offen offset:2048 sc1
    buffer_load_dwordx4 v[96:99], v4, s[32:35], s48 offen offset:3072 sc1
    ds_read_b128 v[44:47], v21 offset:0
    ds_read_b128 v[48:51], v21 offset:1024
    ds_read_b128 v[52:55], v21 offset:2048
    ds_read_b128 v[56:59], v21 offset:3072
    ds_read_b128 v[60:63], v21 offset:4096
    ds_read_b128 v[64:67], v21 offset:5120
    ds_read_b128 v[68:71], v21 offset:6144
    ds_read_b128 v[72:75], v21 offset:7168
    ds_read_b128 v[76:79], v21 offset:8192
    ds_read_b128 v[80:83], v21 offset:9216
    buffer_load_dwordx4 v[100:103], v4, s[32:35], s49 offen offset:0 sc1
    s_waitcnt vmcnt(4)
    v_min3_u32 v5, v84, v85, v86
    v_min_u32 v5, v5, v87
    v_cmp_eq_u32 vcc, 0, v5
    s_nop 0
    s_cmp_lg_u64 vcc, 0
    s_cbranch_scc1 aor_79
aob_80:
    s_waitcnt lgkmcnt(5)
    v_mfma_f32_16x16x32_bf16 v[24:27], v[84:87], v[44:47], 0
    v_mfma_f32_16x16x32_bf16 v[28:31], v[84:87], v[48:51], 0
    v_mfma_f32_16x16x32_bf16 v[32:35], v[84:87], v[52:55], 0
    v_mfma_f32_16x16x32_bf16 v[36:39], v[84:87], v[56:59], 0
    v_mfma_f32_16x16x32_bf16 v[40:43], v[84:87], v[60:63], 0
    ds_read_b128 v[44:47], v21 offset:10240
    ds_read_b128 v[48:51], v21 offset:11264
    ds_read_b128 v[52:55], v21 offset:12288
    ds_read_b128 v[56:59], v21 offset:13312
    ds_read_b128 v[60:63], v21 offset:14336
    buffer_load_dwordx4 v[104:107], v4, s[32:35], s49 offen offset:1024 sc1
    s_waitcnt vmcnt(4)
    v_min3_u32 v5, v88, v89, v90
    v_min_u32 v5, v5, v91
    v_cmp_eq_u32 vcc, 0, v5
    s_nop 0
    s_cmp_lg_u64 vcc, 0
    s_cbranch_scc1 aor_81
aob_82:
    s_waitcnt lgkmcnt(5)
    v_mfma_f32_16x16x32_bf16 v[24:27], v[88:91], v[64:67], v[24:27]
    v_mfma_f32_16x16x32_bf16 v[28:31], v[88:91], v[68:71], v[28:31]
    v_mfma_f32_16x16x32_bf16 v[32:35], v[88:91], v[72:75], v[32:35]
    v_mfma_f32_16x16x32_bf16 v[36:39], v[88:91], v[76:79], v[36:39]
    v_mfma_f32_16x16x32_bf16 v[40:43], v[88:91], v[80:83], v[40:43]
    ds_read_b128 v[64:67], v21 offset:15360
    ds_read_b128 v[68:71], v21 offset:16384
    ds_read_b128 v[72:75], v21 offset:17408
    ds_read_b128 v[76:79], v21 offset:18432
    ds_read_b128 v[80:83], v21 offset:19456
    buffer_load_dwordx4 v[108:111], v4, s[32:35], s49 offen offset:2048 sc1
    s_waitcnt vmcnt(4)
    v_min3_u32 v5, v92, v93, v94
    v_min_u32 v5, v5, v95
    v_cmp_eq_u32 vcc, 0, v5
    s_nop 0
    s_cmp_lg_u64 vcc, 0
    s_cbranch_scc1 aor_83
aob_84:
    s_waitcnt lgkmcnt(5)
    v_mfma_f32_16x16x32_bf16 v[24:27], v[92:95], v[44:47], v[24:27]
    v_mfma_f32_16x16x32_bf16 v[28:31], v[92:95], v[48:51], v[28:31]
    v_mfma_f32_16x16x32_bf16 v[32:35], v[92:95], v[52:55], v[32:35]
    v_mfma_f32_16x16x32_bf16 v[36:39], v[92:95], v[56:59], v[36:39]
    v_mfma_f32_16x16x32_bf16 v[40:43], v[92:95], v[60:63], v[40:43]
    ds_read_b128 v[44:47], v21 offset:20480
    ds_read_b128 v[48:51], v21 offset:21504
    ds_read_b128 v[52:55], v21 offset:22528
    ds_read_b128 v[56:59], v21 offset:23552
    ds_read_b128 v[60:63], v21 offset:24576
    buffer_load_dwordx4 v[112:115], v4, s[32:35], s49 offen offset:3072 sc1
    s_waitcnt vmcnt(4)
    v_min3_u32 v5, v96, v97, v98
    v_min_u32 v5, v5, v99
    v_cmp_eq_u32 vcc, 0, v5
    s_nop 0
    s_cmp_lg_u64 vcc, 0
    s_cbranch_scc1 aor_85
aob_86:
    s_waitcnt lgkmcnt(5)
    v_mfma_f32_16x16x32_bf16 v[24:27], v[96:99], v[64:67], v[24:27]
    v_mfma_f32_16x16x32_bf16 v[28:31], v[96:99], v[68:71], v[28:31]
    v_mfma_f32_16x16x32_bf16 v[32:35], v[96:99], v[72:75], v[32:35]
    v_mfma_f32_16x16x32_bf16 v[36:39], v[96:99], v[76:79], v[36:39]
    v_mfma_f32_16x16x32_bf16 v[40:43], v[96:99], v[80:83], v[40:43]
    ds_read_b128 v[64:67], v21 offset:25600
    ds_read_b128 v[68:71], v21 offset:26624
    ds_read_b128 v[72:75], v21 offset:27648
    ds_read_b128 v[76:79], v21 offset:28672
    ds_read_b128 v[80:83], v21 offset:29696
    buffer_load_dwordx4 v[116:119], v4, s[32:35], s50 offen offset:0 sc1
    s_waitcnt vmcnt(4)
    v_min3_u32 v5, v100, v101, v102
    v_min_u32 v5, v5, v103
    v_cmp_eq_u32 vcc, 0, v5
    s_nop 0
    s_cmp_lg_u64 vcc, 0
    s_cbranch_scc1 aor_87
aob_88:
    s_waitcnt lgkmcnt(5)
    v_mfma_f32_16x16x32_bf16 v[24:27], v[100:103], v[44:47], v[24:27]
    v_mfma_f32_16x16x32_bf16 v[28:31], v[100:103], v[48:51], v[28:31]
    v_mfma_f32_16x16x32_bf16 v[32:35], v[100:103], v[52:55], v[32:35]
    v_mfma_f32_16x16x32_bf16 v[36:39], v[100:103], v[56:59], v[36:39]
    v_mfma_f32_16x16x32_bf16 v[40:43], v[100:103], v[60:63], v[40:43]
    ds_read_b128 v[44:47], v21 offset:30720
    ds_read_b128 v[48:51], v21 offset:31744
    ds_read_b128 v[52:55], v21 offset:32768
    ds_read_b128 v[56:59], v21 offset:33792
    ds_read_b128 v[60:63], v21 offset:34816
    buffer_load_dwordx4 v[120:123], v4, s[32:35], s50 offen offset:1024 sc1
    s_waitcnt vmcnt(4)
    v_min3_u32 v5, v104, v105, v106
    v_min_u32 v5, v5, v107
    v_cmp_eq_u32 vcc, 0, v5
    s_nop 0
    s_cmp_lg_u64 vcc, 0
    s_cbranch_scc1 aor_89
aob_90:
    s_waitcnt lgkmcnt(5)
    v_mfma_f32_16x16x32_bf16 v[24:27], v[104:107], v[64:67], v[24:27]
    v_mfma_f32_16x16x32_bf16 v[28:31], v[104:107], v[68:71], v[28:31]
    v_mfma_f32_16x16x32_bf16 v[32:35], v[104:107], v[72:75], v[32:35]
    v_mfma_f32_16x16x32_bf16 v[36:39], v[104:107], v[76:79], v[36:39]
    v_mfma_f32_16x16x32_bf16 v[40:43], v[104:107], v[80:83], v[40:43]
    ds_read_b128 v[64:67], v21 offset:35840
    ds_read_b128 v[68:71], v21 offset:36864
    ds_read_b128 v[72:75], v21 offset:37888
    ds_read_b128 v[76:79], v21 offset:38912
    ds_read_b128 v[80:83], v21 offset:39936
    s_waitcnt vmcnt(3)
    v_min3_u32 v5, v108, v109, v110
    v_min_u32 v5, v5, v111
    v_cmp_eq_u32 vcc, 0, v5
    s_nop 0
    s_cmp_lg_u64 vcc, 0
    s_cbranch_scc1 aor_91
aob_92:
    s_waitcnt lgkmcnt(5)
    v_mfma_f32_16x16x32_bf16 v[24:27], v[108:111], v[44:47], v[24:27]
    v_mfma_f32_16x16x32_bf16 v[28:31], v[108:111], v[48:51], v[28:31]
    v_mfma_f32_16x16x32_bf16 v[32:35], v[108:111], v[52:55], v[32:35]
    v_mfma_f32_16x16x32_bf16 v[36:39], v[108:111], v[56:59], v[36:39]
    v_mfma_f32_16x16x32_bf16 v[40:43], v[108:111], v[60:63], v[40:43]
    ds_read_b128 v[44:47], v21 offset:40960
    ds_read_b128 v[48:51], v21 offset:41984
    ds_read_b128 v[52:55], v21 offset:43008
    ds_read_b128 v[56:59], v21 offset:44032
    ds_read_b128 v[60:63], v21 offset:45056
    s_waitcnt vmcnt(2)
    v_min3_u32 v5, v112, v113, v114
    v_min_u32 v5, v5, v115
    v_cmp_eq_u32 vcc, 0, v5
    s_nop 0
    s_cmp_lg_u64 vcc, 0
    s_cbranch_scc1 aor_93
aob_94:
    s_waitcnt lgkmcnt(5)
    v_mfma_f32_16x16x32_bf16 v[24:27], v[112:115], v[64:67], v[24:27]
    v_mfma_f32_16x16x32_bf16 v[28:31], v[112:115], v[68:71], v[28:31]
    v_mfma_f32_16x16x32_bf16 v[32:35], v[112:115], v[72:75], v[32:35]
    v_mfma_f32_16x16x32_bf16 v[36:39], v[112:115], v[76:79], v[36:39]
    v_mfma_f32_16x16x32_bf16 v[40:43], v[112:115], v[80:83], v[40:43]
    ds_read_b128 v[64:67], v21 offset:46080
    ds_read_b128 v[68:71], v21 offset:47104
    ds_read_b128 v[72:75], v21 offset:48128
    ds_read_b128 v[76:79], v21 offset:49152
    ds_read_b128 v[80:83], v21 offset:50176
    s_waitcnt vmcnt(1)
    v_min3_u32 v5, v116, v117, v118
    v_min_u32 v5, v5, v119
    v_cmp_eq_u32 vcc, 0, v5
    s_nop 0
    s_cmp_lg_u64 vcc, 0
    s_cbranch_scc1 aor_95
aob_96:
    s_waitcnt lgkmcnt(5)
    v_mfma_f32_16x16x32_bf16 v[24:27], v[116:119], v[44:47], v[24:27]
    v_mfma_f32_16x16x32_bf16 v[28:31], v[116:119], v[48:51], v[28:31]
    v_mfma_f32_16x16x32_bf16 v[32:35], v[116:119], v[52:55], v[32:35]
    v_mfma_f32_16x16x32_bf16 v[36:39], v[116:119], v[56:59], v[36:39]
    v_mfma_f32_16x16x32_bf16 v[40:43], v[116:119], v[60:63], v[40:43]
    s_waitcnt vmcnt(0)
    v_min3_u32 v5, v120, v121, v122
    v_min_u32 v5, v5, v123
    v_cmp_eq_u32 vcc, 0, v5
    s_nop 0
    s_cmp_lg_u64 vcc, 0
    s_cbranch_scc1 aor_97
aob_98:
    s_waitcnt lgkmcnt(0)
    v_mfma_f32_16x16x32_bf16 v[24:27], v[120:123], v[64:67], v[24:27]
    v_mfma_f32_16x16x32_bf16 v[28:31], v[120:123], v[68:71], v[28:31]
    v_mfma_f32_16x16x32_bf16 v[32:35], v[120:123], v[72:75], v[32:35]
    v_mfma_f32_16x16x32_bf16 v[36:39], v[120:123], v[76:79], v[36:39]
    v_mfma_f32_16x16x32_bf16 v[40:43], v[120:123], v[80:83], v[40:43]
    s_nop 3
    ds_write_b128 v8, v[24:27] offset:0
    ds_write_b128 v8, v[28:31] offset:2048
    ds_write_b128 v8, v[32:35] offset:4096
    ds_write_b128 v8, v[36:39] offset:6144
    ds_write_b128 v8, v[40:43] offset:8192
    s_add_u32 s46, s64, 4096
    s_cmp_ge_u32 s60, 2
    s_cselect_b32 s46, 2146435072, s46
    s_cselect_b32 s47, 0, 1.0
    s_waitcnt vmcnt(0)
    v_lshlrev_b32 v68, 16, v12
    v_and_b32 v69, 0xffff0000, v12
    v_lshlrev_b32 v70, 16, v13
    v_and_b32 v71, 0xffff0000, v13
    v_lshlrev_b32 v72, 16, v14
    v_and_b32 v73, 0xffff0000, v14
    v_lshlrev_b32 v74, 16, v15
    v_and_b32 v75, 0xffff0000, v15
    v_lshlrev_b32 v76, 16, v16
    v_and_b32 v77, 0xffff0000, v16
    v_lshlrev_b32 v78, 16, v17
    v_and_b32 v79, 0xffff0000, v17
    v_mov_b32 v18, s47
    s_cmp_eq_u32 s6, 7
    s_cselect_b32 s47, 1, 99
    s_cmp_eq_u32 s60, s47
    s_cselect_b32 s47, 7, 99
    v_lshrrev_b32 v19, 3, v1
    v_cmp_ne_u32 vcc, s47, v19
    s_nop 1
    v_cndmask_b32 v18, 0, v18, vcc
    v_and_b32 v20, 7, v1
    v_lshlrev_b32 v20, 4, v20
    v_lshl_add_u32 v20, v3, 2, v20
    s_lshl_b32 s47, s61, 7
    s_lshl_b32 s45, s60, 8
    s_add_u32 s47, s47, s45
    s_add_u32 s47, s47, 147456
    v_add_u32 v20, s47, v20
    s_waitcnt lgkmcnt(0)
    s_barrier
    ds_read_b128 v[44:47], v10 offset:0
    ds_read_b128 v[56:59], v10 offset:20480
    ds_read_b128 v[48:51], v10 offset:4096
    ds_read_b128 v[60:63], v10 offset:24576
    ds_read_b128 v[52:55], v10 offset:8192
    ds_read_b128 v[64:67], v10 offset:28672
    s_waitcnt lgkmcnt(4)
    v_add_f32 v44, v44, v56
    v_add_f32 v44, v44, v68
    v_add_f32 v45, v45, v57
    v_add_f32 v45, v45, v69
    v_add_f32 v46, v46, v58
    v_add_f32 v46, v46, v70
    v_add_f32 v47, v47, v59
    v_add_f32 v47, v47, v71
    v_cvt_pk_bf16_f32 v12, v44, v45
    v_cvt_pk_bf16_f32 v13, v46, v47
    v_max_u32 v12, 1, v12
    v_max_u32 v13, 1, v13
    buffer_store_dwordx2 v[12:13], v9, s[32:35], s64 offen offset:0 sc1
    s_waitcnt lgkmcnt(2)
    v_add_f32 v48, v48, v60
    v_add_f32 v48, v48, v72
    v_add_f32 v49, v49, v61
    v_add_f32 v49, v49, v73
    v_add_f32 v50, v50, v62
    v_add_f32 v50, v50, v74
    v_add_f32 v51, v51, v63
    v_add_f32 v51, v51, v75
    v_cvt_pk_bf16_f32 v14, v48, v49
    v_cvt_pk_bf16_f32 v15, v50, v51
    v_max_u32 v14, 1, v14
    v_max_u32 v15, 1, v15
    buffer_store_dwordx2 v[14:15], v9, s[32:35], s64 offen offset:2048 sc1
    s_waitcnt lgkmcnt(0)
    v_add_f32 v52, v52, v64
    v_add_f32 v52, v52, v76
    v_add_f32 v53, v53, v65
    v_add_f32 v53, v53, v77
    v_add_f32 v54, v54, v66
    v_add_f32 v54, v54, v78
    v_add_f32 v55, v55, v67
    v_add_f32 v55, v55, v79
    v_cvt_pk_bf16_f32 v16, v52, v53
    v_cvt_pk_bf16_f32 v17, v54, v55
    v_max_u32 v16, 1, v16
    v_max_u32 v17, 1, v17
    buffer_store_dwordx2 v[16:17], v9, s[32:35], s46 offen sc1
    v_cmp_lt_f32 vcc, 0, v18
    v_mul_f32 v44, v44, v44
    v_mul_f32 v45, v45, v45
    v_mul_f32 v46, v46, v46
    v_mul_f32 v47, v47, v47
    v_cndmask_b32 v52, 0, v52, vcc
    v_cndmask_b32 v53, 0, v53, vcc
    v_cndmask_b32 v54, 0, v54, vcc
    v_cndmask_b32 v55, 0, v55, vcc
    v_fmac_f32 v44, v48, v48
    v_fmac_f32 v45, v49, v49
    v_fmac_f32 v46, v50, v50
    v_fmac_f32 v47, v51, v51
    v_fmac_f32 v44, v52, v52
    v_fmac_f32 v45, v53, v53
    v_fmac_f32 v46, v54, v54
    v_fmac_f32 v47, v55, v55
    s_nop 0
    v_permlane32_swap_b32 v44, v46
    v_permlane32_swap_b32 v45, v47
    v_add_f32 v44, v44, v46
    v_add_f32 v45, v45, v47
    s_nop 1
    v_permlane16_swap_b32 v44, v45
    v_add_f32 v44, v44, v45
    s_nop 1
    v_add_f32_dpp v44, v44, v44 row_ror:8 row_mask:0xf bank_mask:0xf
    ds_write_b32 v20, v44
    v_lshlrev_b32 v18, 3, v1
    v_add_u32 v18, 147456, v18
    v_lshlrev_b32 v11, 2, v1
    s_lshl_b32 s47, s6, 12
    s_lshl_b32 s46, s7, 7
    s_add_u32 s47, s47, s46
    s_add_u32 s47, s47, s65
    s_waitcnt lgkmcnt(0)
    s_barrier
    s_cmp_lg_u32 s3, 6
    s_cbranch_scc1 xv_99
    ds_read_b64 v[44:45], v18
    ds_read_b64 v[46:47], v18 offset:256
    ds_read_b64 v[48:49], v18 offset:512
    ds_read_b64 v[50:51], v18 offset:768
    s_waitcnt lgkmcnt(0)
    v_add_f32 v44, v44, v46
    v_add_f32 v45, v45, v47
    v_add_f32 v48, v48, v50
    v_add_f32 v49, v49, v51
    v_add_f32 v44, v44, v48
    v_add_f32 v45, v45, v49
    v_cvt_pk_bf16_f32 v10, v44, v45
    v_max_u32 v10, 1, v10
    s_mov_b32 exec_hi, 0
    buffer_store_dword v10, v11, s[32:35], s47 offen sc1
    s_mov_b32 exec_hi, -1
xv_99:
    s_lshr_b32 s81, s2, 3
    s_and_b32 s80, s4, 3
    s_mul_i32 s80, s80, 2
    s_and_b32 s82, s81, 1
    s_add_u32 s80, s80, s82
    s_lshr_b32 s71, s4, 2
    s_mul_i32 s71, s71, 16
    s_lshr_b32 s81, s81, 1
    s_add_u32 s71, s71, s81
    s_and_b32 s68, s71, 3
    s_mul_i32 s68, s68, 5
    s_lshr_b32 s81, s71, 2
    s_add_u32 s68, s68, s81
    s_cmp_ge_u32 s68, 20
    s_cselect_b32 s81, 20, 0
    s_sub_u32 s68, s68, s81
    s_cmp_ge_u32 s72, 20
    s_cbranch_scc1 side_100
    s_lshl_b32 s46, s73, 8
    s_add_u32 s47, s46, 7864320
    s_add_u32 s46, s46, 10485760
    s_mov_b32 s42, 37617664
    s_mov_b32 s43, 37621760
    s_mov_b32 s44, 37625856
    s_mov_b32 s45, 37629952
    s_mov_b32 s58, 40000
    s_mov_b32 s41, 0x80008000
    v_xor_b32 v64, s41, v180
    v_xor_b32 v65, s41, v181
    v_xor_b32 v66, s41, v182
    v_xor_b32 v67, s41, v183
    v_xor_b32 v68, s41, v184
    v_xor_b32 v69, s41, v185
    v_xor_b32 v70, s41, v186
    v_xor_b32 v71, s41, v187
    v_xor_b32 v72, s41, v188
    v_xor_b32 v73, s41, v189
    v_xor_b32 v74, s41, v190
    v_xor_b32 v75, s41, v191
    v_xor_b32 v76, s41, v192
    v_xor_b32 v77, s41, v193
    v_xor_b32 v78, s41, v194
    v_xor_b32 v79, s41, v195
    v_xor_b32 v80, s41, v204
    v_xor_b32 v81, s41, v205
    v_xor_b32 v82, s41, v206
    v_xor_b32 v83, s41, v207
    v_xor_b32 v84, s41, v208
    v_xor_b32 v85, s41, v209
    v_xor_b32 v86, s41, v210
    v_xor_b32 v87, s41, v211
    v_lshlrev_b32 v88, 16, v244
    v_and_b32 v96, 0xffff0000, v244
    v_lshlrev_b32 v89, 16, v245
    v_and_b32 v97, 0xffff0000, v245
    v_lshlrev_b32 v90, 16, v246
    v_and_b32 v98, 0xffff0000, v246
    v_lshlrev_b32 v91, 16, v247
    v_and_b32 v99, 0xffff0000, v247
    v_lshlrev_b32 v92, 16, v248
    v_and_b32 v100, 0xffff0000, v248
    v_lshlrev_b32 v93, 16, v249
    v_and_b32 v101, 0xffff0000, v249
    v_lshlrev_b32 v94, 16, v250
    v_and_b32 v102, 0xffff0000, v250
    v_lshlrev_b32 v95, 16, v251
    v_and_b32 v103, 0xffff0000, v251
    v_mul_u32_u24 v150, 2560, v3
    s_mul_i32 s48, s71, 80
    v_add3_u32 v150, v150, v2, s48
    v_lshlrev_b32 v150, 4, v150
    s_lshl_b32 s48, s60, 8
    v_add_u32 v149, s48, v150
    v_add_u32 v150, 1024, v150
    s_mov_b32 s51, 24248320
    s_add_u32 s50, s68, s61
    s_mul_i32 s50, s50, 163840
    s_add_u32 s50, s50, 20971520
    s_add_u32 s76, s68, s3
    s_mul_i32 s76, s76, 163840
    s_add_u32 s76, s76, 20971520
    s_mul_i32 s49, s61, 5120
    s_lshl_b32 s48, s60, 10
    s_add_u32 s49, s49, s48
    s_mul_i32 s77, s3, 5120
    s_barrier
    buffer_load_dwordx4 v[16:19], v137, s[32:35], s42 offen sc1
    buffer_load_dwordx4 v[20:23], v137, s[32:35], s43 offen sc1
    buffer_load_dwordx4 v[24:27], v137, s[32:35], s44 offen sc1
    buffer_load_dwordx4 v[28:31], v137, s[32:35], s45 offen sc1
    buffer_load_dwordx4 v[48:51], v136, s[32:35], s46 offen sc1
    buffer_load_dwordx4 v[52:55], v136, s[32:35], s46 offen offset:128 sc1
    s_lshl_b32 s41, s61, 7
    s_add_u32 s47, s47, s41
    s_mov_b32 s40, 0x36a3d70a
    v_mov_b32 v8, 0x3727c5ac
    s_waitcnt vmcnt(2)
    v_min3_u32 v9, v16, v17, v18
    v_min3_u32 v9, v9, v19, v20
    v_min3_u32 v9, v9, v21, v22
    v_min3_u32 v9, v9, v23, v24
    v_min3_u32 v9, v9, v25, v26
    v_min3_u32 v9, v9, v27, v28
    v_min3_u32 v9, v9, v29, v30
    v_min_u32 v9, v9, v31
    v_cmp_eq_u32 vcc, 0, v9
    s_nop 0
    s_cmp_lg_u64 vcc, 0
    s_cbranch_scc1 fvr_103
fvb_104:
    v_lshlrev_b32 v40, 16, v16
    v_and_b32 v41, 0xffff0000, v16
    v_lshlrev_b32 v42, 16, v17
    v_and_b32 v43, 0xffff0000, v17
    v_lshlrev_b32 v44, 16, v18
    v_and_b32 v45, 0xffff0000, v18
    v_lshlrev_b32 v46, 16, v19
    v_and_b32 v47, 0xffff0000, v19
    v_lshlrev_b32 v32, 16, v20
    v_and_b32 v33, 0xffff0000, v20
    v_lshlrev_b32 v34, 16, v21
    v_and_b32 v35, 0xffff0000, v21
    v_lshlrev_b32 v36, 16, v22
    v_and_b32 v37, 0xffff0000, v22
    v_lshlrev_b32 v38, 16, v23
    v_and_b32 v39, 0xffff0000, v23
    v_add_f32 v40, v40, v32
    v_add_f32 v41, v41, v33
    v_add_f32 v42, v42, v34
    v_add_f32 v43, v43, v35
    v_add_f32 v44, v44, v36
    v_add_f32 v45, v45, v37
    v_add_f32 v46, v46, v38
    v_add_f32 v47, v47, v39
    v_lshlrev_b32 v32, 16, v24
    v_and_b32 v33, 0xffff0000, v24
    v_lshlrev_b32 v34, 16, v25
    v_and_b32 v35, 0xffff0000, v25
    v_lshlrev_b32 v36, 16, v26
    v_and_b32 v37, 0xffff0000, v26
    v_lshlrev_b32 v38, 16, v27
    v_and_b32 v39, 0xffff0000, v27
    v_add_f32 v40, v40, v32
    v_add_f32 v41, v41, v33
    v_add_f32 v42, v42, v34
    v_add_f32 v43, v43, v35
    v_add_f32 v44, v44, v36
    v_add_f32 v45, v45, v37
    v_add_f32 v46, v46, v38
    v_add_f32 v47, v47, v39
    v_lshlrev_b32 v32, 16, v28
    v_and_b32 v33, 0xffff0000, v28
    v_lshlrev_b32 v34, 16, v29
    v_and_b32 v35, 0xffff0000, v29
    v_lshlrev_b32 v36, 16, v30
    v_and_b32 v37, 0xffff0000, v30
    v_lshlrev_b32 v38, 16, v31
    v_and_b32 v39, 0xffff0000, v31
    v_add_f32 v40, v40, v32
    v_add_f32 v41, v41, v33
    v_add_f32 v42, v42, v34
    v_add_f32 v43, v43, v35
    v_add_f32 v44, v44, v36
    v_add_f32 v45, v45, v37
    v_add_f32 v46, v46, v38
    v_add_f32 v47, v47, v39
    v_add_f32_dpp v40, v40, v40 row_half_mirror row_mask:0xf bank_mask:0xf
    v_add_f32_dpp v41, v41, v41 row_half_mirror row_mask:0xf bank_mask:0xf
    v_add_f32_dpp v42, v42, v42 row_half_mirror row_mask:0xf bank_mask:0xf
    v_add_f32_dpp v43, v43, v43 row_half_mirror row_mask:0xf bank_mask:0xf
    v_add_f32_dpp v44, v44, v44 row_half_mirror row_mask:0xf bank_mask:0xf
    v_add_f32_dpp v45, v45, v45 row_half_mirror row_mask:0xf bank_mask:0xf
    v_add_f32_dpp v46, v46, v46 row_half_mirror row_mask:0xf bank_mask:0xf
    v_add_f32_dpp v47, v47, v47 row_half_mirror row_mask:0xf bank_mask:0xf
    v_fma_f32 v40, v40, s40, v8
    v_fma_f32 v41, v41, s40, v8
    v_fma_f32 v42, v42, s40, v8
    v_fma_f32 v43, v43, s40, v8
    v_fma_f32 v44, v44, s40, v8
    v_fma_f32 v45, v45, s40, v8
    v_fma_f32 v46, v46, s40, v8
    v_fma_f32 v47, v47, s40, v8
    v_rsq_f32 v40, v40
    v_rsq_f32 v41, v41
    v_rsq_f32 v42, v42
    v_rsq_f32 v43, v43
    v_rsq_f32 v44, v44
    v_rsq_f32 v45, v45
    v_rsq_f32 v46, v46
    v_rsq_f32 v47, v47
    s_waitcnt vmcnt(0)
    v_min3_u32 v9, v48, v49, v50
    v_min3_u32 v9, v9, v51, v52
    v_min3_u32 v9, v9, v53, v54
    v_min_u32 v9, v9, v55
    v_cmp_eq_u32 vcc, 0, v9
    s_nop 0
    s_cmp_lg_u64 vcc, 0
    s_cbranch_scc1 fdr_105
fdb_106:
    ds_write_b128 v138, v[48:51] offset:16384
    v_lshlrev_b32 v16, 16, v48
    v_and_b32 v17, 0xffff0000, v48
    v_lshlrev_b32 v18, 16, v49
    v_and_b32 v19, 0xffff0000, v49
    v_lshlrev_b32 v20, 16, v50
    v_and_b32 v21, 0xffff0000, v50
    v_lshlrev_b32 v22, 16, v51
    v_and_b32 v23, 0xffff0000, v51
    v_mul_f32 v16, v16, v40
    v_mul_f32 v17, v17, v41
    v_mul_f32 v18, v18, v42
    v_mul_f32 v19, v19, v43
    v_mul_f32 v20, v20, v44
    v_mul_f32 v21, v21, v45
    v_mul_f32 v22, v22, v46
    v_mul_f32 v23, v23, v47
    v_cvt_pk_bf16_f32 v56, v16, v17
    v_cvt_pk_bf16_f32 v57, v18, v19
    v_cvt_pk_bf16_f32 v58, v20, v21
    v_cvt_pk_bf16_f32 v59, v22, v23
    ds_write_b128 v138, v[56:59] offset:0
    ds_write_b128 v138, v[52:55] offset:24576
    v_lshlrev_b32 v16, 16, v52
    v_and_b32 v17, 0xffff0000, v52
    v_lshlrev_b32 v18, 16, v53
    v_and_b32 v19, 0xffff0000, v53
    v_lshlrev_b32 v20, 16, v54
    v_and_b32 v21, 0xffff0000, v54
    v_lshlrev_b32 v22, 16, v55
    v_and_b32 v23, 0xffff0000, v55
    v_mul_f32 v16, v16, v40
    v_mul_f32 v17, v17, v41
    v_mul_f32 v18, v18, v42
    v_mul_f32 v19, v19, v43
    v_mul_f32 v20, v20, v44
    v_mul_f32 v21, v21, v45
    v_mul_f32 v22, v22, v46
    v_mul_f32 v23, v23, v47
    v_cvt_pk_bf16_f32 v60, v16, v17
    v_cvt_pk_bf16_f32 v61, v18, v19
    v_cvt_pk_bf16_f32 v62, v20, v21
    v_cvt_pk_bf16_f32 v63, v22, v23
    v_and_b32 v60, v60, v148
    v_and_b32 v61, v61, v148
    v_and_b32 v62, v62, v148
    v_and_b32 v63, v63, v148
    ds_write_b128 v138, v[60:63] offset:8192
    s_cmp_ge_u32 s50, s51
    s_cselect_b32 s48, 3276800, 0
    s_sub_u32 s50, s50, s48
    s_add_u32 m0, s49, 0
    s_nop 0
    buffer_load_dwordx4 v149, s[32:35], s50 offen sc1 lds
    s_add_u32 s50, s50, 327680
    v_xor_b32 v8, 64, v139
    v_and_b32 v10, 0xfffffbff, v139
    v_xor_b32 v11, 64, v10
    v_xor_b32 v12, 512, v10
    v_xor_b32 v13, 512, v11
    s_waitcnt lgkmcnt(0)
    s_barrier
    ds_read_b128 v[104:107], v10
    ds_read_b128 v[108:111], v11
    ds_read_b128 v[16:19], v10 offset:1024
    ds_read_b128 v[20:23], v11 offset:1024
    ds_read_b128 v[112:115], v12
    ds_read_b128 v[116:119], v13
    ds_read_b128 v[24:27], v12 offset:1024
    ds_read_b128 v[28:31], v13 offset:1024
    ds_read_b128 v[48:51], v139 offset:16384
    ds_read_b128 v[52:55], v8 offset:16384
    s_cmp_ge_u32 s50, s51
    s_cselect_b32 s48, 3276800, 0
    s_sub_u32 s50, s50, s48
    s_add_u32 m0, s49, 10240
    s_nop 0
    buffer_load_dwordx4 v149, s[32:35], s50 offen sc1 lds
    s_add_u32 s50, s50, 327680
    s_cmp_ge_u32 s50, s51
    s_cselect_b32 s48, 3276800, 0
    s_sub_u32 s50, s50, s48
    s_add_u32 m0, s49, 20480
    s_nop 0
    buffer_load_dwordx4 v149, s[32:35], s50 offen sc1 lds
    s_add_u32 s50, s50, 327680
    s_cmp_lg_u32 s62, 0
    s_cbranch_scc1 s1t_107
    s_waitcnt lgkmcnt(8)
    v_mfma_f32_16x16x32_bf16 v[120:123], v[104:107], v[164:167], 0
    v_mfma_f32_16x16x32_bf16 v[128:131], v[108:111], v[164:167], 0
    v_mfma_f32_16x16x32_bf16 v[120:123], v[108:111], v[180:183], v[120:123]
    v_mfma_f32_16x16x32_bf16 v[128:131], v[104:107], v[64:67], v[128:131]
    s_waitcnt lgkmcnt(6)
    v_mfma_f32_16x16x32_bf16 v[124:127], v[16:19], v[164:167], 0
    v_mfma_f32_16x16x32_bf16 v[132:135], v[20:23], v[164:167], 0
    v_mfma_f32_16x16x32_bf16 v[124:127], v[20:23], v[180:183], v[124:127]
    v_mfma_f32_16x16x32_bf16 v[132:135], v[16:19], v[64:67], v[132:135]
    s_waitcnt lgkmcnt(4)
    v_mfma_f32_16x16x32_bf16 v[120:123], v[112:115], v[168:171], v[120:123]
    v_mfma_f32_16x16x32_bf16 v[128:131], v[116:119], v[168:171], v[128:131]
    v_mfma_f32_16x16x32_bf16 v[120:123], v[116:119], v[184:187], v[120:123]
    v_mfma_f32_16x16x32_bf16 v[128:131], v[112:115], v[68:71], v[128:131]
    s_waitcnt lgkmcnt(2)
    v_mfma_f32_16x16x32_bf16 v[124:127], v[24:27], v[168:171], v[124:127]
    v_mfma_f32_16x16x32_bf16 v[132:135], v[28:31], v[168:171], v[132:135]
    v_mfma_f32_16x16x32_bf16 v[124:127], v[28:31], v[184:187], v[124:127]
    v_mfma_f32_16x16x32_bf16 v[132:135], v[24:27], v[68:71], v[132:135]
    s_branch s1u_108
s1t_107:
    s_waitcnt lgkmcnt(8)
    v_mfma_f32_16x16x32_bf16 v[120:123], v[104:107], v[172:175], 0
    v_mfma_f32_16x16x32_bf16 v[128:131], v[108:111], v[172:175], 0
    v_mfma_f32_16x16x32_bf16 v[120:123], v[108:111], v[188:191], v[120:123]
    v_mfma_f32_16x16x32_bf16 v[128:131], v[104:107], v[72:75], v[128:131]
    s_waitcnt lgkmcnt(6)
    v_mfma_f32_16x16x32_bf16 v[124:127], v[16:19], v[172:175], 0
    v_mfma_f32_16x16x32_bf16 v[132:135], v[20:23], v[172:175], 0
    v_mfma_f32_16x16x32_bf16 v[124:127], v[20:23], v[188:191], v[124:127]
    v_mfma_f32_16x16x32_bf16 v[132:135], v[16:19], v[72:75], v[132:135]
    s_waitcnt lgkmcnt(4)
    v_mfma_f32_16x16x32_bf16 v[120:123], v[112:115], v[176:179], v[120:123]
    v_mfma_f32_16x16x32_bf16 v[128:131], v[116:119], v[176:179], v[128:131]
    v_mfma_f32_16x16x32_bf16 v[120:123], v[116:119], v[192:195], v[120:123]
    v_mfma_f32_16x16x32_bf16 v[128:131], v[112:115], v[76:79], v[128:131]
    s_waitcnt lgkmcnt(2)
    v_mfma_f32_16x16x32_bf16 v[124:127], v[24:27], v[176:179], v[124:127]
    v_mfma_f32_16x16x32_bf16 v[132:135], v[28:31], v[176:179], v[132:135]
    v_mfma_f32_16x16x32_bf16 v[124:127], v[28:31], v[192:195], v[124:127]
    v_mfma_f32_16x16x32_bf16 v[132:135], v[24:27], v[76:79], v[132:135]
s1u_108:
    s_cmp_ge_u32 s50, s51
    s_cselect_b32 s48, 3276800, 0
    s_sub_u32 s50, s50, s48
    s_add_u32 m0, s49, 30720
    s_nop 0
    buffer_load_dwordx4 v149, s[32:35], s50 offen sc1 lds
    s_add_u32 s50, s50, 327680
    s_cmp_ge_u32 s50, s51
    s_cselect_b32 s48, 3276800, 0
    s_sub_u32 s50, s50, s48
    s_add_u32 m0, s49, 40960
    s_nop 0
    buffer_load_dwordx4 v149, s[32:35], s50 offen sc1 lds
    s_add_u32 s50, s50, 327680
    v_mul_f32 v16, v120, v212
    v_mul_f32 v24, v128, v212
    v_mul_f32 v17, v121, v213
    v_mul_f32 v25, v129, v213
    v_mul_f32 v18, v122, v214
    v_mul_f32 v26, v130, v214
    v_mul_f32 v19, v123, v215
    v_mul_f32 v27, v131, v215
    v_mul_f32 v20, v124, v216
    v_mul_f32 v28, v132, v216
    v_mul_f32 v21, v125, v217
    v_mul_f32 v29, v133, v217
    v_mul_f32 v22, v126, v218
    v_mul_f32 v30, v134, v218
    v_mul_f32 v23, v127, v219
    v_mul_f32 v31, v135, v219
    v_fma_f32 v16, v128, v220, v16
    v_fma_f32 v24, -v120, v220, v24
    v_fma_f32 v17, v129, v221, v17
    v_fma_f32 v25, -v121, v221, v25
    v_fma_f32 v18, v130, v222, v18
    v_fma_f32 v26, -v122, v222, v26
    v_fma_f32 v19, v131, v223, v19
    v_fma_f32 v27, -v123, v223, v27
    v_fma_f32 v20, v132, v224, v20
    v_fma_f32 v28, -v124, v224, v28
    v_fma_f32 v21, v133, v225, v21
    v_fma_f32 v29, -v125, v225, v29
    v_fma_f32 v22, v134, v226, v22
    v_fma_f32 v30, -v126, v226, v30
    v_fma_f32 v23, v135, v227, v23
    v_fma_f32 v31, -v127, v227, v31
    s_cmp_ge_u32 s50, s51
    s_cselect_b32 s48, 3276800, 0
    s_sub_u32 s50, s50, s48
    s_add_u32 m0, s49, 51200
    s_nop 0
    buffer_load_dwordx4 v149, s[32:35], s50 offen sc1 lds
    s_add_u32 s50, s50, 327680
    v_cvt_pk_bf16_f32 v104, v16, v17
    v_cvt_pk_bf16_f32 v105, v18, v19
    v_cvt_pk_bf16_f32 v106, v20, v21
    v_cvt_pk_bf16_f32 v107, v22, v23
    v_cvt_pk_bf16_f32 v108, v24, v25
    v_cvt_pk_bf16_f32 v109, v26, v27
    v_cvt_pk_bf16_f32 v110, v28, v29
    v_cvt_pk_bf16_f32 v111, v30, v31
    s_cmp_ge_u32 s50, s51
    s_cselect_b32 s48, 3276800, 0
    s_sub_u32 s50, s50, s48
    s_add_u32 m0, s49, 61440
    s_nop 0
    buffer_load_dwordx4 v149, s[32:35], s50 offen sc1 lds
    s_add_u32 s50, s50, 327680
    s_waitcnt lgkmcnt(0)
    v_mfma_f32_16x16x32_bf16 v[120:123], v[196:199], v[104:107], 0
    v_mfma_f32_16x16x32_bf16 v[128:131], v[196:199], v[108:111], 0
    v_mfma_f32_16x16x32_bf16 v[120:123], v[204:207], v[108:111], v[120:123]
    v_mfma_f32_16x16x32_bf16 v[128:131], v[80:83], v[104:107], v[128:131]
    v_mfma_f32_16x16x32_bf16 v[124:127], v[200:203], v[104:107], 0
    v_mfma_f32_16x16x32_bf16 v[132:135], v[200:203], v[108:111], 0
    v_mfma_f32_16x16x32_bf16 v[124:127], v[208:211], v[108:111], v[124:127]
    v_mfma_f32_16x16x32_bf16 v[132:135], v[84:87], v[104:107], v[132:135]
    s_cmp_ge_u32 s50, s51
    s_cselect_b32 s48, 3276800, 0
    s_sub_u32 s50, s50, s48
    s_add_u32 m0, s49, 71680
    s_nop 0
    buffer_load_dwordx4 v149, s[32:35], s50 offen sc1 lds
    s_add_u32 s50, s50, 327680
    v_mul_f32 v16, v120, v88
    v_mul_f32 v24, v128, v88
    v_mul_f32 v17, v121, v89
    v_mul_f32 v25, v129, v89
    v_mul_f32 v18, v122, v90
    v_mul_f32 v26, v130, v90
    v_mul_f32 v19, v123, v91
    v_mul_f32 v27, v131, v91
    v_mul_f32 v20, v124, v92
    v_mul_f32 v28, v132, v92
    v_mul_f32 v21, v125, v93
    v_mul_f32 v29, v133, v93
    v_mul_f32 v22, v126, v94
    v_mul_f32 v30, v134, v94
    v_mul_f32 v23, v127, v95
    v_mul_f32 v31, v135, v95
    v_fma_f32 v16, -v128, v96, v16
    v_fma_f32 v24, v120, v96, v24
    v_fma_f32 v17, -v129, v97, v17
    v_fma_f32 v25, v121, v97, v25
    v_fma_f32 v18, -v130, v98, v18
    v_fma_f32 v26, v122, v98, v26
    v_fma_f32 v19, -v131, v99, v19
    v_fma_f32 v27, v123, v99, v27
    v_fma_f32 v20, -v132, v100, v20
    v_fma_f32 v28, v124, v100, v28
    v_fma_f32 v21, -v133, v101, v21
    v_fma_f32 v29, v125, v101, v29
    v_fma_f32 v22, -v134, v102, v22
    v_fma_f32 v30, v126, v102, v30
    v_fma_f32 v23, -v135, v103, v23
    v_fma_f32 v31, v127, v103, v31
    s_cmp_ge_u32 s50, s51
    s_cselect_b32 s48, 3276800, 0
    s_sub_u32 s50, s50, s48
    s_add_u32 m0, s49, 81920
    s_nop 0
    buffer_load_dwordx4 v149, s[32:35], s50 offen sc1 lds
    s_add_u32 s50, s50, 327680
    v_cvt_pk_bf16_f32 v112, v16, v17
    v_cvt_pk_bf16_f32 v113, v18, v19
    v_cvt_pk_bf16_f32 v114, v20, v21
    v_cvt_pk_bf16_f32 v115, v22, v23
    v_cvt_pk_bf16_f32 v116, v24, v25
    v_cvt_pk_bf16_f32 v117, v26, v27
    v_cvt_pk_bf16_f32 v118, v28, v29
    v_cvt_pk_bf16_f32 v119, v30, v31
    v_mfma_f32_16x16x32_bf16 v[120:123], v[112:115], v[196:199], 0
    s_nop 0
    v_mfma_f32_16x16x32_bf16 v[128:131], v[116:119], v[196:199], 0
    v_mfma_f32_16x16x32_bf16 v[120:123], v[116:119], v[80:83], v[120:123]
    v_mfma_f32_16x16x32_bf16 v[128:131], v[112:115], v[204:207], v[128:131]
    v_mfma_f32_16x16x32_bf16 v[124:127], v[112:115], v[200:203], 0
    v_mfma_f32_16x16x32_bf16 v[132:135], v[116:119], v[200:203], 0
    v_mfma_f32_16x16x32_bf16 v[124:127], v[116:119], v[84:87], v[124:127]
    v_mfma_f32_16x16x32_bf16 v[132:135], v[112:115], v[208:211], v[132:135]
    s_cmp_ge_u32 s50, s51
    s_cselect_b32 s48, 3276800, 0
    s_sub_u32 s50, s50, s48
    s_add_u32 m0, s49, 92160
    s_nop 0
    buffer_load_dwordx4 v149, s[32:35], s50 offen sc1 lds
    s_add_u32 s50, s50, 327680
    v_mul_f32 v16, v120, v228
    v_mul_f32 v24, v128, v228
    v_mul_f32 v17, v121, v229
    v_mul_f32 v25, v129, v229
    v_mul_f32 v18, v122, v230
    v_mul_f32 v26, v130, v230
    v_mul_f32 v19, v123, v231
    v_mul_f32 v27, v131, v231
    v_mul_f32 v20, v124, v232
    v_mul_f32 v28, v132, v232
    v_mul_f32 v21, v125, v233
    v_mul_f32 v29, v133, v233
    v_mul_f32 v22, v126, v234
    v_mul_f32 v30, v134, v234
    v_mul_f32 v23, v127, v235
    v_mul_f32 v31, v135, v235
    v_fma_f32 v16, -v128, v236, v16
    v_fma_f32 v24, v120, v236, v24
    v_fma_f32 v17, -v129, v237, v17
    v_fma_f32 v25, v121, v237, v25
    v_fma_f32 v18, -v130, v238, v18
    v_fma_f32 v26, v122, v238, v26
    v_fma_f32 v19, -v131, v239, v19
    v_fma_f32 v27, v123, v239, v27
    v_fma_f32 v20, -v132, v240, v20
    v_fma_f32 v28, v124, v240, v28
    v_fma_f32 v21, -v133, v241, v21
    v_fma_f32 v29, v125, v241, v29
    v_fma_f32 v22, -v134, v242, v22
    v_fma_f32 v30, v126, v242, v30
    v_fma_f32 v23, -v135, v243, v23
    v_fma_f32 v31, v127, v243, v31
    s_cmp_ge_u32 s76, s51
    s_cselect_b32 s48, 3276800, 0
    s_sub_u32 s76, s76, s48
    s_add_u32 m0, s77, 4096
    s_nop 0
    buffer_load_dwordx4 v150, s[32:35], s76 offen sc1 lds
    s_add_u32 s76, s76, 1310720
    v_cvt_pk_bf16_f32 v32, v16, v17
    v_cvt_pk_bf16_f32 v33, v18, v19
    ds_write_b64 v145, v[32:33] offset:0
    v_cvt_pk_bf16_f32 v34, v24, v25
    v_cvt_pk_bf16_f32 v35, v26, v27
    ds_write_b64 v145, v[34:35] offset:1024
    v_cvt_pk_bf16_f32 v36, v20, v21
    v_cvt_pk_bf16_f32 v37, v22, v23
    ds_write_b64 v145, v[36:37] offset:4096
    v_cvt_pk_bf16_f32 v38, v28, v29
    v_cvt_pk_bf16_f32 v39, v30, v31
    ds_write_b64 v145, v[38:39] offset:5120
    s_cmp_ge_u32 s76, s51
    s_cselect_b32 s48, 3276800, 0
    s_sub_u32 s76, s76, s48
    s_add_u32 m0, s77, 45056
    s_nop 0
    buffer_load_dwordx4 v150, s[32:35], s76 offen sc1 lds
    s_add_u32 s76, s76, 1310720
    s_cmp_ge_u32 s3, 4
    s_cbranch_scc1 qb_109
    s_cmp_ge_u32 s76, s51
    s_cselect_b32 s48, 3276800, 0
    s_sub_u32 s76, s76, s48
    s_add_u32 m0, s77, 86016
    s_nop 0
    buffer_load_dwordx4 v150, s[32:35], s76 offen sc1 lds
    s_add_u32 s76, s76, 1310720
qb_109:
    v_lshlrev_b32 v16, 16, v48
    v_and_b32 v17, 0xffff0000, v48
    v_lshlrev_b32 v18, 16, v49
    v_and_b32 v19, 0xffff0000, v49
    v_lshlrev_b32 v20, 16, v50
    v_and_b32 v21, 0xffff0000, v50
    v_lshlrev_b32 v22, 16, v51
    v_and_b32 v23, 0xffff0000, v51
    v_lshlrev_b32 v24, 16, v52
    v_and_b32 v25, 0xffff0000, v52
    v_lshlrev_b32 v26, 16, v53
    v_and_b32 v27, 0xffff0000, v53
    v_lshlrev_b32 v28, 16, v54
    v_and_b32 v29, 0xffff0000, v54
    v_lshlrev_b32 v30, 16, v55
    v_and_b32 v31, 0xffff0000, v55
    s_waitcnt lgkmcnt(0)
    s_barrier
    ds_read_b128 v[104:107], v146
    ds_read_b128 v[108:111], v146 offset:1024
    ds_read_b128 v[112:115], v147
    ds_read_b128 v[116:119], v147 offset:1024
    s_waitcnt lgkmcnt(2)
    v_mfma_f32_16x16x32_bf16 v[120:123], v[164:167], v[104:107], v[16:19]
    v_mfma_f32_16x16x32_bf16 v[128:131], v[164:167], v[108:111], v[24:27]
    v_mfma_f32_16x16x32_bf16 v[120:123], v[64:67], v[108:111], v[120:123]
    v_mfma_f32_16x16x32_bf16 v[128:131], v[180:183], v[104:107], v[128:131]
    v_mfma_f32_16x16x32_bf16 v[124:127], v[172:175], v[104:107], v[20:23]
    v_mfma_f32_16x16x32_bf16 v[132:135], v[172:175], v[108:111], v[28:31]
    v_mfma_f32_16x16x32_bf16 v[124:127], v[72:75], v[108:111], v[124:127]
    v_mfma_f32_16x16x32_bf16 v[132:135], v[188:191], v[104:107], v[132:135]
    s_waitcnt lgkmcnt(0)
    v_mfma_f32_16x16x32_bf16 v[120:123], v[168:171], v[112:115], v[120:123]
    v_mfma_f32_16x16x32_bf16 v[128:131], v[168:171], v[116:119], v[128:131]
    v_mfma_f32_16x16x32_bf16 v[120:123], v[68:71], v[116:119], v[120:123]
    v_mfma_f32_16x16x32_bf16 v[128:131], v[184:187], v[112:115], v[128:131]
    v_mfma_f32_16x16x32_bf16 v[124:127], v[176:179], v[112:115], v[124:127]
    v_mfma_f32_16x16x32_bf16 v[132:135], v[176:179], v[116:119], v[132:135]
    v_mfma_f32_16x16x32_bf16 v[124:127], v[76:79], v[116:119], v[124:127]
    v_mfma_f32_16x16x32_bf16 v[132:135], v[192:195], v[112:115], v[132:135]
    s_nop 2
    v_cvt_pk_bf16_f32 v32, v120, v121
    v_cvt_pk_bf16_f32 v33, v122, v123
    s_nop 1
    v_cvt_pk_bf16_f32 v34, v124, v125
    v_cvt_pk_bf16_f32 v35, v126, v127
    v_cvt_pk_bf16_f32 v36, v128, v129
    v_cvt_pk_bf16_f32 v37, v130, v131
    v_cvt_pk_bf16_f32 v38, v132, v133
    v_cvt_pk_bf16_f32 v39, v134, v135
    s_lshl_b32 s40, s73, 1
    s_add_u32 s40, s40, s61
    s_cmp_lg_u32 s40, 319
    s_cbranch_scc1 nyq2_110
    v_mov_b32 v36, v52
    v_mov_b32 v37, v53
    v_mov_b32 v38, v54
    v_mov_b32 v39, v55
nyq2_110:
    v_max_u32 v32, 1, v32
    v_max_u32 v33, 1, v33
    v_max_u32 v34, 1, v34
    v_max_u32 v35, 1, v35
    v_max_u32 v36, 1, v36
    v_max_u32 v37, 1, v37
    v_max_u32 v38, 1, v38
    v_max_u32 v39, 1, v39
    buffer_store_dwordx4 v[32:35], v141, s[32:35], s47 offen sc1
    buffer_store_dwordx4 v[36:39], v141, s[32:35], s47 offen offset:64 sc1
    s_lshl_b32 s64, s80, 3
    s_add_u32 s64, s64, s3
    s_mul_i32 s65, s3, 6144
    s_add_u32 s65, s65, 102400
    v_lshrrev_b32 v112, 5, v1
    v_lshlrev_b32 v112, 5, v112
    v_xor_b32 v112, v112, v4
    v_lshrrev_b32 v113, 2, v2
    v_lshl_add_u32 v113, v3, 3, v113
    v_lshlrev_b32 v113, 6, v113
    v_and_b32 v114, 3, v2
    v_lshl_add_u32 v113, v114, 3, v113
    v_and_b32 v114, 1, v3
    v_lshl_add_u32 v113, v114, 5, v113
    v_add_u32 v113, s65, v113
    v_xor_b32 v114, 32, v113
    v_add_u32 v115, 51200, v4
    s_cmp_eq_u32 s71, 19
    s_cselect_b32 s40, 3, 99
    v_mov_b32 v116, 0xffff
    v_cmp_ne_u32 vcc, s40, v3
    s_nop 1
    v_cndmask_b32 v116, v116, -1, vcc
    v_lshrrev_b32 v117, 1, v3
    v_lshl_add_u32 v117, v117, 4, v2
    v_lshlrev_b32 v117, 2, v117
    v_lshrrev_b32 v8, 2, v0
    v_mul_u32_u24 v9, 781, v8
    v_lshrrev_b32 v9, 14, v9
    v_mul_u32_u24 v10, 21, v9
    v_sub_u32 v8, v8, v10
    v_lshlrev_b32 v10, 4, v9
    v_subrev_u32 v11, 12, v8
    v_cmp_eq_u32 vcc, 20, v8
    s_nop 1
    v_cndmask_b32 v11, v11, 0, vcc
    v_add_u32 v11, 128, v11
    v_cmp_gt_u32 vcc, 16, v8
    s_nop 1
    v_cndmask_b32 v11, v11, v8, vcc
    v_add_u32 v10, v10, v11
    v_and_b32 v11, 3, v0
    v_lshl_add_u32 v10, v10, 2, v11
    v_lshlrev_b32 v10, 2, v10
    v_min_u32 v10, 4092, v10
    v_add_u32 v118, 102400, v10
    v_lshrrev_b32 v8, 2, v2
    v_and_b32 v9, 1, v8
    v_cmp_eq_u32 vcc, 1, v9
    v_mov_b32 v10, 0x358637bd
    v_mov_b32 v11, 0xff800000
    v_cndmask_b32 v119, v10, 0, vcc
    v_cndmask_b32 v120, v10, v11, vcc
    v_cndmask_b32 v121, 1.0, 0, vcc
    v_cmp_eq_u32 vcc, 3, v8
    v_mov_b32 v10, 0x3b4ccccd
    s_nop 0
    v_cndmask_b32 v122, 1.0, 0, vcc
    v_cndmask_b32 v123, 0, v10, vcc
    v_lshlrev_b32 v8, 2, v3
    v_sub_u32 v8, v2, v8
    v_mov_b32 v10, 0x3f80
    v_mov_b32 v11, 0x3f800000
    v_cmp_eq_u32 vcc, 0, v8
    s_nop 1
    v_cndmask_b32 v124, 0, v10, vcc
    v_cmp_eq_u32 vcc, 1, v8
    s_nop 1
    v_cndmask_b32 v124, v124, v11, vcc
    v_cmp_eq_u32 vcc, 2, v8
    s_nop 1
    v_cndmask_b32 v125, 0, v10, vcc
    v_cmp_eq_u32 vcc, 3, v8
    s_nop 1
    v_cndmask_b32 v125, v125, v11, vcc
    v_mov_b32 v126, 0
    v_mov_b32 v127, 0
    v_mov_b32 v128, 0
    v_mov_b32 v129, 0
    v_mov_b32 v130, v124
    v_mov_b32 v131, v125
    v_lshrrev_b32 v8, 3, v1
    v_mul_u32_u24 v8, 1792, v8
    v_and_b32 v9, 7, v1
    v_lshl_add_u32 v132, v9, 4, v8
    s_lshl_b32 s40, s3, 8
    v_add_u32 v132, s40, v132
    v_lshrrev_b32 v8, 5, v1
    v_lshl_add_u32 v8, v8, 3, v9
    s_lshl_b32 s40, s3, 4
    v_add_u32 v8, s40, v8
    v_mul_u32_u24 v9, 781, v8
    v_lshrrev_b32 v9, 14, v9
    v_mul_u32_u24 v10, 21, v9
    v_sub_u32 v8, v8, v10
    v_add_u32 v10, 48, v8
    v_cmp_gt_u32 vcc, 16, v8
    s_nop 1
    v_cndmask_b32 v8, v10, v8, vcc
    v_lshlrev_b32 v8, 4, v8
    v_lshlrev_b32 v10, 8, v9
    v_mov_b32 v11, 520
    v_cmp_eq_u32 vcc, 4, v9
    s_nop 1
    v_cndmask_b32 v10, v10, v11, vcc
    v_mov_b32 v11, 2048
    v_cmp_lt_u32 vcc, 4, v9
    s_nop 1
    v_cndmask_b32 v10, v10, v11, vcc
    v_add_u32 v8, v8, v10
    v_and_b32 v9, 1, v3
    v_lshl_add_u32 v8, v9, 2, v8
    v_add_u32 v133, 151552, v8
    v_add_u32 v134, 151552, v4
    v_min_u32 v8, 4, v2
    v_lshl_add_u32 v8, v3, 4, v8
    v_lshlrev_b32 v8, 4, v8
    v_add_u32 v135, 152576, v8
    v_mov_b32 v8, 0
    v_lshlrev_b32 v9, 2, v0
    v_add_u32 v9, 151552, v9
    ds_write_b32 v9, v8
    v_bfe_u32 v8, v2, 2, 1
    v_mul_u32_u24 v8, 20480, v8
    v_lshrrev_b32 v9, 3, v2
    v_lshl_add_u32 v8, v9, 6, v8
    v_and_b32 v9, 3, v2
    v_lshl_add_u32 v8, v9, 4, v8
    s_mul_i32 s40, s71, 5
    v_add_u32 v9, s40, v3
    v_lshrrev_b32 v10, 1, v9
    v_lshl_add_u32 v136, v10, 8, v8
    v_and_b32 v10, 1, v9
    v_lshl_add_u32 v136, v10, 3, v136
    s_add_u32 s40, s40, 4
    s_lshr_b32 s41, s40, 1
    s_lshl_b32 s41, s41, 8
    s_and_b32 s40, s40, 1
    s_lshl_b32 s40, s40, 3
    s_add_u32 s40, s40, s41
    v_add_u32 v137, s40, v8
    v_lshlrev_b32 v138, 3, v2
    v_lshl_add_u32 v138, v3, 8, v138
    s_waitcnt vmcnt(0) lgkmcnt(0)
    s_barrier
    s_cmp_lg_u32 s3, 6
    s_cbranch_scc1 arr_111
    s_and_b32 s59, s2, 15
    s_lshl_b32 s59, s59, 8
    s_add_u32 s59, s59, 37748736
    v_lshlrev_b32 v255, 12, v1
    v_mov_b32 v254, 1
    s_mov_b64 exec, 15
    buffer_atomic_add v254, v255, s[32:35], s59 offen sc1
    s_mov_b64 exec, -1
arr_111:
    s_branch j6_112
side_100:
    s_sub_u32 s67, s72, 20
    s_lshl_b32 s67, s67, 3
    s_add_u32 s67, s67, s6
    s_lshl_b32 s67, s67, 3
    s_add_u32 s67, s67, s3
    v_and_b32 v7, 7, v1
    s_mul_i32 s42, s67, 6554
    s_lshr_b32 s42, s42, 16
    s_mul_i32 s43, s42, 10
    s_sub_u32 s43, s67, s43
    v_bfe_u32 v6, v1, 3, 1
    v_lshrrev_b32 v8, 4, v1
    v_lshl_add_u32 v6, v6, 3, v8
    v_mul_u32_u24 v6, 1280, v6
    v_lshl_add_u32 v6, v7, 4, v6
    s_mul_i32 s40, s42, 20480
    s_lshl_b32 s41, s43, 7
    s_add_u32 s40, s40, s41
    s_add_u32 s41, s40, 5120
    buffer_load_dwordx4 v[180:183], v6, s[24:27], s40 offen
    buffer_load_dwordx4 v[184:187], v6, s[24:27], s41 offen
wol_113:
    v_and_b32 v6, 3, v2
    v_cmp_eq_u32 vcc, v6, v3
    v_lshrrev_b32 v6, 2, v2
    s_nop 0
    v_cndmask_b32 v6, 7, v6, vcc
    v_mov_b32 v28, 0x3f80
    v_mov_b32 v29, 0x3f800000
    v_cmp_eq_u32 vcc, 0, v6
    s_nop 1
    v_cndmask_b32 v8, 0, v28, vcc
    v_cmp_eq_u32 vcc, 1, v6
    s_nop 1
    v_cndmask_b32 v8, v8, v29, vcc
    v_cmp_eq_u32 vcc, 2, v6
    s_nop 1
    v_cndmask_b32 v9, 0, v28, vcc
    v_cmp_eq_u32 vcc, 3, v6
    s_nop 1
    v_cndmask_b32 v9, v9, v29, vcc
    v_mov_b32 v10, 0
    v_mov_b32 v11, 0
    v_mov_b32 v12, 0
    v_mov_b32 v13, 0
    v_mov_b32 v14, v8
    v_mov_b32 v15, v9
    v_and_b32 v7, 7, v2
    v_lshrrev_b32 v17, 3, v2
    s_lshr_b32 s40, s70, 1
    s_lshl_b32 s40, s40, 6
    s_sub_u32 s40, s40, s69
    s_sub_u32 s40, s40, 1
    v_lshl_add_u32 v18, v7, 3, v3
    v_add_u32 v18, s40, v18
    v_add_u32 v19, 4, v18
    v_and_b32 v20, 1, v18
    v_lshlrev_b32 v20, 5, v20
    v_lshl_add_u32 v20, v17, 4, v20
    v_mov_b32 v21, 2146435072
    v_lshrrev_b32 v16, 1, v18
    v_lshl_add_u32 v16, v16, 14, v20
    v_cmp_gt_u32 vcc, 0x140, v18
    s_nop 1
    v_cndmask_b32 v16, v21, v16, vcc
    v_lshrrev_b32 v22, 1, v19
    v_lshl_add_u32 v22, v22, 14, v20
    v_cmp_gt_u32 vcc, 0x140, v19
    s_nop 1
    v_cndmask_b32 v22, v21, v22, vcc
    s_lshl_b32 s40, s69, 8
    s_and_b32 s41, s70, 1
    s_lshl_b32 s41, s41, 7
    s_add_u32 s40, s40, s41
    s_add_u32 s40, s40, 28835840
    s_waitcnt vmcnt(0)
    v_mfma_f32_16x16x32_bf16 v[64:67], v[8:11], v[180:183], 0
    v_mfma_f32_16x16x32_bf16 v[68:71], v[8:11], v[184:187], 0
    v_mfma_f32_16x16x32_bf16 v[72:75], v[12:15], v[180:183], 0
    v_mfma_f32_16x16x32_bf16 v[76:79], v[12:15], v[184:187], 0
    s_cmp_ge_u32 s67, 400
    s_cbranch_scc1 wtskip_114
    s_mul_i32 s42, s67, 6554
    s_lshr_b32 s42, s42, 16
    s_mul_i32 s43, s42, 10
    s_sub_u32 s43, s67, s43
    s_lshl_b32 s43, s43, 4
    s_lshr_b32 s40, s42, 1
    s_mul_i32 s40, s40, 5120
    s_and_b32 s42, s42, 1
    s_lshl_b32 s42, s42, 9
    s_add_u32 s40, s40, s42
    s_add_u32 s40, s40, 25067520
    s_mov_b32 s41, 102400
    v_lshlrev_b32 v18, 8, v17
    v_lshl_add_u32 v18, v3, 4, v18
    v_lshl_add_u32 v19, v7, 1, s43
    v_add_u32 v19, 0, v19
    v_mul_u32_u24 v20, 205, v19
    v_lshrrev_b32 v20, 10, v20
    v_mul_u32_u24 v21, 5, v20
    v_sub_u32 v19, v19, v21
    v_lshrrev_b32 v21, 2, v20
    v_and_b32 v20, 3, v20
    v_mul_lo_u32 v21, v21, s41
    v_lshl_add_u32 v21, v19, 10, v21
    v_lshl_add_u32 v21, v20, 6, v21
    v_add_u32 v21, v21, v18
    v_cvt_pk_bf16_f32 v204, v64, v65
    v_cvt_pk_bf16_f32 v205, v66, v67
    v_cvt_pk_bf16_f32 v206, v68, v69
    v_cvt_pk_bf16_f32 v207, v70, v71
    buffer_store_dwordx4 v[204:207], v21, s[32:35], s40 offen sc1
    v_lshl_add_u32 v19, v7, 1, s43
    v_add_u32 v19, 1, v19
    v_mul_u32_u24 v20, 205, v19
    v_lshrrev_b32 v20, 10, v20
    v_mul_u32_u24 v21, 5, v20
    v_sub_u32 v19, v19, v21
    v_lshrrev_b32 v21, 2, v20
    v_and_b32 v20, 3, v20
    v_mul_lo_u32 v21, v21, s41
    v_lshl_add_u32 v21, v19, 10, v21
    v_lshl_add_u32 v21, v20, 6, v21
    v_add_u32 v21, v21, v18
    v_cvt_pk_bf16_f32 v208, v72, v73
    v_cvt_pk_bf16_f32 v209, v74, v75
    v_cvt_pk_bf16_f32 v210, v76, v77
    v_cvt_pk_bf16_f32 v211, v78, v79
    buffer_store_dwordx4 v[208:211], v21, s[32:35], s40 offen sc1
wtskip_114:
    s_waitcnt vmcnt(0) lgkmcnt(0)
    s_barrier
    s_cmp_lg_u32 s3, 6
    s_cbranch_scc1 arr_116
    s_and_b32 s59, s2, 15
    s_lshl_b32 s59, s59, 8
    s_add_u32 s59, s59, 37732352
    v_lshlrev_b32 v255, 12, v1
    v_mov_b32 v254, 1
    s_mov_b64 exec, 15
    buffer_atomic_add v254, v255, s[32:35], s59 offen sc1
    s_mov_b64 exec, -1
arr_116:
    v_mul_u32_u24 v150, 2560, v3
    s_mul_i32 s48, s71, 80
    v_add3_u32 v150, v150, v2, s48
    v_lshlrev_b32 v150, 4, v150
    s_lshl_b32 s48, s60, 8
    v_add_u32 v149, s48, v150
    v_add_u32 v150, 1024, v150
    s_mov_b32 s51, 24248320
    s_add_u32 s50, s68, s61
    s_mul_i32 s50, s50, 163840
    s_add_u32 s50, s50, 20971520
    s_add_u32 s76, s68, s3
    s_mul_i32 s76, s76, 163840
    s_add_u32 s76, s76, 20971520
    s_mul_i32 s49, s61, 5120
    s_lshl_b32 s48, s60, 10
    s_add_u32 s49, s49, s48
    s_mul_i32 s77, s3, 5120
    s_cmp_ge_u32 s50, s51
    s_cselect_b32 s48, 3276800, 0
    s_sub_u32 s50, s50, s48
    s_add_u32 m0, s49, 0
    s_nop 0
    buffer_load_dwordx4 v149, s[32:35], s50 offen sc1 lds
    s_add_u32 s50, s50, 327680
    s_cmp_ge_u32 s50, s51
    s_cselect_b32 s48, 3276800, 0
    s_sub_u32 s50, s50, s48
    s_add_u32 m0, s49, 10240
    s_nop 0
    buffer_load_dwordx4 v149, s[32:35], s50 offen sc1 lds
    s_add_u32 s50, s50, 327680
    s_cmp_ge_u32 s50, s51
    s_cselect_b32 s48, 3276800, 0
    s_sub_u32 s50, s50, s48
    s_add_u32 m0, s49, 20480
    s_nop 0
    buffer_load_dwordx4 v149, s[32:35], s50 offen sc1 lds
    s_add_u32 s50, s50, 327680
    s_cmp_ge_u32 s50, s51
    s_cselect_b32 s48, 3276800, 0
    s_sub_u32 s50, s50, s48
    s_add_u32 m0, s49, 30720
    s_nop 0
    buffer_load_dwordx4 v149, s[32:35], s50 offen sc1 lds
    s_add_u32 s50, s50, 327680
    s_cmp_ge_u32 s50, s51
    s_cselect_b32 s48, 3276800, 0
    s_sub_u32 s50, s50, s48
    s_add_u32 m0, s49, 40960
    s_nop 0
    buffer_load_dwordx4 v149, s[32:35], s50 offen sc1 lds
    s_add_u32 s50, s50, 327680
    s_cmp_ge_u32 s50, s51
    s_cselect_b32 s48, 3276800, 0
    s_sub_u32 s50, s50, s48
    s_add_u32 m0, s49, 51200
    s_nop 0
    buffer_load_dwordx4 v149, s[32:35], s50 offen sc1 lds
    s_add_u32 s50, s50, 327680
    s_cmp_ge_u32 s50, s51
    s_cselect_b32 s48, 3276800, 0
    s_sub_u32 s50, s50, s48
    s_add_u32 m0, s49, 61440
    s_nop 0
    buffer_load_dwordx4 v149, s[32:35], s50 offen sc1 lds
    s_add_u32 s50, s50, 327680
    s_cmp_ge_u32 s50, s51
    s_cselect_b32 s48, 3276800, 0
    s_sub_u32 s50, s50, s48
    s_add_u32 m0, s49, 71680
    s_nop 0
    buffer_load_dwordx4 v149, s[32:35], s50 offen sc1 lds
    s_add_u32 s50, s50, 327680
    s_cmp_ge_u32 s50, s51
    s_cselect_b32 s48, 3276800, 0
    s_sub_u32 s50, s50, s48
    s_add_u32 m0, s49, 81920
    s_nop 0
    buffer_load_dwordx4 v149, s[32:35], s50 offen sc1 lds
    s_add_u32 s50, s50, 327680
    s_cmp_ge_u32 s50, s51
    s_cselect_b32 s48, 3276800, 0
    s_sub_u32 s50, s50, s48
    s_add_u32 m0, s49, 92160
    s_nop 0
    buffer_load_dwordx4 v149, s[32:35], s50 offen sc1 lds
    s_add_u32 s50, s50, 327680
    s_cmp_ge_u32 s76, s51
    s_cselect_b32 s48, 3276800, 0
    s_sub_u32 s76, s76, s48
    s_add_u32 m0, s77, 4096
    s_nop 0
    buffer_load_dwordx4 v150, s[32:35], s76 offen sc1 lds
    s_add_u32 s76, s76, 1310720
    s_cmp_ge_u32 s76, s51
    s_cselect_b32 s48, 3276800, 0
    s_sub_u32 s76, s76, s48
    s_add_u32 m0, s77, 45056
    s_nop 0
    buffer_load_dwordx4 v150, s[32:35], s76 offen sc1 lds
    s_add_u32 s76, s76, 1310720
    s_cmp_ge_u32 s3, 4
    s_cbranch_scc1 qb_117
    s_cmp_ge_u32 s76, s51
    s_cselect_b32 s48, 3276800, 0
    s_sub_u32 s76, s76, s48
    s_add_u32 m0, s77, 86016
    s_nop 0
    buffer_load_dwordx4 v150, s[32:35], s76 offen sc1 lds
    s_add_u32 s76, s76, 1310720
qb_117:
    v_mov_b32 v8, 0
    v_mov_b32 v9, 0
    v_mov_b32 v10, 0
    v_mov_b32 v11, 0
    s_lshl_b32 s41, s67, 10
    s_add_u32 s41, s41, 13107200
    buffer_store_dwordx4 v[8:11], v4, s[32:35], s41 offen sc1
    s_add_u32 s41, s41, 786432
    buffer_store_dwordx4 v[8:11], v4, s[32:35], s41 offen sc1
    s_add_u32 s41, s41, 786432
    buffer_store_dwordx4 v[8:11], v4, s[32:35], s41 offen sc1
    s_add_u32 s41, s41, 786432
    buffer_store_dwordx4 v[8:11], v4, s[32:35], s41 offen sc1
    s_add_u32 s41, s41, 786432
    buffer_store_dwordx4 v[8:11], v4, s[32:35], s41 offen sc1
    s_add_u32 s41, s41, 786432
    buffer_store_dwordx4 v[8:11], v4, s[32:35], s41 offen sc1
    s_add_u32 s41, s41, 786432
    s_cmp_ge_u32 s67, 512
    s_cbranch_scc1 z4_118
    buffer_store_dwordx4 v[8:11], v4, s[32:35], s41 offen sc1
    s_add_u32 s41, s41, 786432
z4_118:
    s_lshl_b32 s64, s80, 3
    s_add_u32 s64, s64, s3
    s_mul_i32 s65, s3, 6144
    s_add_u32 s65, s65, 102400
    v_lshrrev_b32 v112, 5, v1
    v_lshlrev_b32 v112, 5, v112
    v_xor_b32 v112, v112, v4
    v_lshrrev_b32 v113, 2, v2
    v_lshl_add_u32 v113, v3, 3, v113
    v_lshlrev_b32 v113, 6, v113
    v_and_b32 v114, 3, v2
    v_lshl_add_u32 v113, v114, 3, v113
    v_and_b32 v114, 1, v3
    v_lshl_add_u32 v113, v114, 5, v113
    v_add_u32 v113, s65, v113
    v_xor_b32 v114, 32, v113
    v_add_u32 v115, 51200, v4
    s_cmp_eq_u32 s71, 19
    s_cselect_b32 s40, 3, 99
    v_mov_b32 v116, 0xffff
    v_cmp_ne_u32 vcc, s40, v3
    s_nop 1
    v_cndmask_b32 v116, v116, -1, vcc
    v_lshrrev_b32 v117, 1, v3
    v_lshl_add_u32 v117, v117, 4, v2
    v_lshlrev_b32 v117, 2, v117
    v_lshrrev_b32 v8, 2, v0
    v_mul_u32_u24 v9, 781, v8
    v_lshrrev_b32 v9, 14, v9
    v_mul_u32_u24 v10, 21, v9
    v_sub_u32 v8, v8, v10
    v_lshlrev_b32 v10, 4, v9
    v_subrev_u32 v11, 12, v8
    v_cmp_eq_u32 vcc, 20, v8
    s_nop 1
    v_cndmask_b32 v11, v11, 0, vcc
    v_add_u32 v11, 128, v11
    v_cmp_gt_u32 vcc, 16, v8
    s_nop 1
    v_cndmask_b32 v11, v11, v8, vcc
    v_add_u32 v10, v10, v11
    v_and_b32 v11, 3, v0
    v_lshl_add_u32 v10, v10, 2, v11
    v_lshlrev_b32 v10, 2, v10
    v_min_u32 v10, 4092, v10
    v_add_u32 v118, 102400, v10
    v_lshrrev_b32 v8, 2, v2
    v_and_b32 v9, 1, v8
    v_cmp_eq_u32 vcc, 1, v9
    v_mov_b32 v10, 0x358637bd
    v_mov_b32 v11, 0xff800000
    v_cndmask_b32 v119, v10, 0, vcc
    v_cndmask_b32 v120, v10, v11, vcc
    v_cndmask_b32 v121, 1.0, 0, vcc
    v_cmp_eq_u32 vcc, 3, v8
    v_mov_b32 v10, 0x3b4ccccd
    s_nop 0
    v_cndmask_b32 v122, 1.0, 0, vcc
    v_cndmask_b32 v123, 0, v10, vcc
    v_lshlrev_b32 v8, 2, v3
    v_sub_u32 v8, v2, v8
    v_mov_b32 v10, 0x3f80
    v_mov_b32 v11, 0x3f800000
    v_cmp_eq_u32 vcc, 0, v8
    s_nop 1
    v_cndmask_b32 v124, 0, v10, vcc
    v_cmp_eq_u32 vcc, 1, v8
    s_nop 1
    v_cndmask_b32 v124, v124, v11, vcc
    v_cmp_eq_u32 vcc, 2, v8
    s_nop 1
    v_cndmask_b32 v125, 0, v10, vcc
    v_cmp_eq_u32 vcc, 3, v8
    s_nop 1
    v_cndmask_b32 v125, v125, v11, vcc
    v_mov_b32 v126, 0
    v_mov_b32 v127, 0
    v_mov_b32 v128, 0
    v_mov_b32 v129, 0
    v_mov_b32 v130, v124
    v_mov_b32 v131, v125
    v_lshrrev_b32 v8, 3, v1
    v_mul_u32_u24 v8, 1792, v8
    v_and_b32 v9, 7, v1
    v_lshl_add_u32 v132, v9, 4, v8
    s_lshl_b32 s40, s3, 8
    v_add_u32 v132, s40, v132
    v_lshrrev_b32 v8, 5, v1
    v_lshl_add_u32 v8, v8, 3, v9
    s_lshl_b32 s40, s3, 4
    v_add_u32 v8, s40, v8
    v_mul_u32_u24 v9, 781, v8
    v_lshrrev_b32 v9, 14, v9
    v_mul_u32_u24 v10, 21, v9
    v_sub_u32 v8, v8, v10
    v_add_u32 v10, 48, v8
    v_cmp_gt_u32 vcc, 16, v8
    s_nop 1
    v_cndmask_b32 v8, v10, v8, vcc
    v_lshlrev_b32 v8, 4, v8
    v_lshlrev_b32 v10, 8, v9
    v_mov_b32 v11, 520
    v_cmp_eq_u32 vcc, 4, v9
    s_nop 1
    v_cndmask_b32 v10, v10, v11, vcc
    v_mov_b32 v11, 2048
    v_cmp_lt_u32 vcc, 4, v9
    s_nop 1
    v_cndmask_b32 v10, v10, v11, vcc
    v_add_u32 v8, v8, v10
    v_and_b32 v9, 1, v3
    v_lshl_add_u32 v8, v9, 2, v8
    v_add_u32 v133, 151552, v8
    v_add_u32 v134, 151552, v4
    v_min_u32 v8, 4, v2
    v_lshl_add_u32 v8, v3, 4, v8
    v_lshlrev_b32 v8, 4, v8
    v_add_u32 v135, 152576, v8
    v_mov_b32 v8, 0
    v_lshlrev_b32 v9, 2, v0
    v_add_u32 v9, 151552, v9
    ds_write_b32 v9, v8
    v_bfe_u32 v8, v2, 2, 1
    v_mul_u32_u24 v8, 20480, v8
    v_lshrrev_b32 v9, 3, v2
    v_lshl_add_u32 v8, v9, 6, v8
    v_and_b32 v9, 3, v2
    v_lshl_add_u32 v8, v9, 4, v8
    s_mul_i32 s40, s71, 5
    v_add_u32 v9, s40, v3
    v_lshrrev_b32 v10, 1, v9
    v_lshl_add_u32 v136, v10, 8, v8
    v_and_b32 v10, 1, v9
    v_lshl_add_u32 v136, v10, 3, v136
    s_add_u32 s40, s40, 4
    s_lshr_b32 s41, s40, 1
    s_lshl_b32 s41, s41, 8
    s_and_b32 s40, s40, 1
    s_lshl_b32 s40, s40, 3
    s_add_u32 s40, s40, s41
    v_add_u32 v137, s40, v8
    v_lshlrev_b32 v138, 3, v2
    v_lshl_add_u32 v138, v3, 8, v138
join_101:
    s_waitcnt vmcnt(0)
j6_112:
    s_cmp_lg_u32 s3, 7
    s_cbranch_scc1 wt_119
    s_and_b32 s59, s2, 3
    s_lshl_b32 s59, s59, 12
    s_add_u32 s59, s59, 37748736
    v_lshlrev_b32 v255, 8, v2
    v_cmp_gt_u32 vcc, 8, v2
    v_mov_b32 v253, 12
    s_nop 0
    v_cndmask_b32 v253, 8, v253, vcc
    s_mov_b32 s58, 40000
    s_cmp_lg_u32 s83, 0
    s_cbranch_scc1 polld_121
poll_120:
    buffer_load_dword v254, v255, s[32:35], s59 offen sc1
    s_waitcnt vmcnt(0)
    v_cmp_gt_u32 vcc, v253, v254
    s_nop 0
    s_cmp_eq_u64 vcc, 0
    s_cbranch_scc1 polld_121
    s_sub_u32 s58, s58, 1
    s_cmp_lg_u32 s58, 0
    s_cbranch_scc1 poll_120
    s_mov_b32 s83, 5
    v_mov_b32 v254, 5
    v_mov_b32 v255, 16
    buffer_store_dword v254, v255, s[36:39], 0 offen
polld_121:
wt_119:
    s_barrier
    s_mul_i32 s52, s64, 40960
    s_add_u32 s52, s52, 7864320
    s_add_u32 s54, s52, 40960
    s_lshl_b32 s53, s68, 11
    s_add_u32 s53, s53, s52
    s_add_u32 m0, s65, 0
    s_nop 0
    buffer_load_dwordx4 v112, s[32:35], s53 offen sc1 lds
    buffer_load_dwordx4 v112, s[32:35], s53 offen offset:1024 sc1 lds
    s_add_u32 s53, s53, 2048
    s_cmp_ge_u32 s53, s54
    s_cselect_b32 s53, s52, s53
    s_add_u32 m0, s65, 2048
    s_nop 0
    buffer_load_dwordx4 v112, s[32:35], s53 offen sc1 lds
    buffer_load_dwordx4 v112, s[32:35], s53 offen offset:1024 sc1 lds
    s_add_u32 s53, s53, 2048
    s_cmp_ge_u32 s53, s54
    s_cselect_b32 s53, s52, s53
    s_add_u32 m0, s65, 4096
    s_nop 0
    buffer_load_dwordx4 v112, s[32:35], s53 offen sc1 lds
    buffer_load_dwordx4 v112, s[32:35], s53 offen offset:1024 sc1 lds
    s_add_u32 s53, s53, 2048
    s_cmp_ge_u32 s53, s54
    s_cselect_b32 s53, s52, s53
    ds_read_b128 v[72:75], v4 offset:0
    ds_read_b128 v[76:79], v4 offset:1024
    ds_read_b128 v[80:83], v4 offset:2048
    ds_read_b128 v[84:87], v4 offset:3072
    ds_read_b128 v[88:91], v4 offset:4096
    s_lshl_b32 s55, s64, 7
    s_add_u32 s55, s55, 37658624
    s_lshl_b32 s56, s64, 8
    s_add_u32 s56, s56, 37683200
    s_waitcnt vmcnt(4)
    ds_read_b64_tr_b16 v[48:49], v113 offset:0
    ds_read_b64_tr_b16 v[50:51], v113 offset:256
    ds_read_b64_tr_b16 v[52:53], v114 offset:0
    ds_read_b64_tr_b16 v[54:55], v114 offset:256
    s_waitcnt vmcnt(2)
    ds_read_b64_tr_b16 v[56:57], v113 offset:2048
    ds_read_b64_tr_b16 v[58:59], v113 offset:2304
    ds_read_b64_tr_b16 v[60:61], v114 offset:2048
    ds_read_b64_tr_b16 v[62:63], v114 offset:2304
    s_waitcnt lgkmcnt(4)
    s_add_u32 m0, s65, 0
    s_nop 0
    buffer_load_dwordx4 v112, s[32:35], s53 offen sc1 lds
    buffer_load_dwordx4 v112, s[32:35], s53 offen offset:1024 sc1 lds
    s_add_u32 s53, s53, 2048
    s_cmp_ge_u32 s53, s54
    s_cselect_b32 s53, s52, s53
    v_mfma_f32_16x16x32_bf16 v[8:11], v[48:51], v[72:75], 0
    ds_read_b128 v[92:95], v4 offset:5120
    v_mfma_f32_16x16x32_bf16 v[12:15], v[52:55], v[72:75], 0
    ds_read_b128 v[96:99], v4 offset:6144
    v_mfma_f32_16x16x32_bf16 v[16:19], v[48:51], v[76:79], 0
    ds_read_b128 v[100:103], v4 offset:7168
    s_waitcnt lgkmcnt(3)
    s_add_u32 m0, s65, 2048
    s_nop 0
    buffer_load_dwordx4 v112, s[32:35], s53 offen sc1 lds
    v_mfma_f32_16x16x32_bf16 v[20:23], v[52:55], v[76:79], 0
    ds_read_b128 v[104:107], v4 offset:8192
    buffer_load_dwordx4 v112, s[32:35], s53 offen offset:1024 sc1 lds
    s_add_u32 s53, s53, 2048
    s_cmp_ge_u32 s53, s54
    s_cselect_b32 s53, s52, s53
    v_mfma_f32_16x16x32_bf16 v[24:27], v[48:51], v[80:83], 0
    ds_read_b128 v[108:111], v4 offset:9216
    v_mfma_f32_16x16x32_bf16 v[28:31], v[52:55], v[80:83], 0
    s_waitcnt vmcnt(4)
    ds_read_b64_tr_b16 v[64:65], v113 offset:4096
    v_mfma_f32_16x16x32_bf16 v[32:35], v[84:87], v[48:51], 0
    ds_read_b64_tr_b16 v[66:67], v113 offset:4352
    v_mfma_f32_16x16x32_bf16 v[36:39], v[84:87], v[52:55], 0
    ds_read_b64_tr_b16 v[68:69], v114 offset:4096
    ds_read_b64_tr_b16 v[70:71], v114 offset:4352
    v_mfma_f32_16x16x32_bf16 v[40:43], v[88:91], v[48:51], 0
    v_mfma_f32_16x16x32_bf16 v[44:47], v[88:91], v[52:55], 0
    s_cmp_ge_u32 s71, 20
    s_cbranch_scc1 ssq_122
    v_mov_b32 v5, 0
    v_mov_b32 v6, 0
    v_and_b32 v7, v116, v51
    v_and_b32 v139, v116, v55
    v_dot2c_f32_bf16 v5, v48, v48
    v_dot2c_f32_bf16 v6, v52, v52
    v_dot2c_f32_bf16 v5, v49, v49
    v_dot2c_f32_bf16 v6, v53, v53
    v_dot2c_f32_bf16 v5, v50, v50
    v_dot2c_f32_bf16 v6, v54, v54
    v_dot2c_f32_bf16 v5, v7, v7
    v_dot2c_f32_bf16 v6, v139, v139
    s_nop 2
    v_permlane32_swap_b32 v5, v6
    v_add_f32 v5, v5, v6
    v_mov_b32 v6, v5
    s_nop 1
    v_permlane16_swap_b32 v5, v6
    v_add_f32 v5, v5, v6
    s_mov_b32 exec_lo, 0xffff
    s_mov_b32 exec_hi, 0xffff
    buffer_atomic_add_f32 v5, v117, s[32:35], s55 offen
    s_mov_b64 exec, -1
ssq_122:
    s_waitcnt lgkmcnt(8)
    v_mfma_f32_16x16x32_bf16 v[8:11], v[56:59], v[92:95], v[8:11]
    ds_read_b128 v[72:75], v4 offset:10240
    v_mfma_f32_16x16x32_bf16 v[12:15], v[60:63], v[92:95], v[12:15]
    ds_read_b128 v[76:79], v4 offset:11264
    s_waitcnt lgkmcnt(9)
    v_mfma_f32_16x16x32_bf16 v[16:19], v[56:59], v[96:99], v[16:19]
    ds_read_b128 v[80:83], v4 offset:12288
    s_waitcnt lgkmcnt(3)
    s_add_u32 m0, s65, 4096
    s_nop 0
    buffer_load_dwordx4 v112, s[32:35], s53 offen sc1 lds
    v_mfma_f32_16x16x32_bf16 v[20:23], v[60:63], v[96:99], v[20:23]
    ds_read_b128 v[84:87], v4 offset:13312
    buffer_load_dwordx4 v112, s[32:35], s53 offen offset:1024 sc1 lds
    s_add_u32 s53, s53, 2048
    s_cmp_ge_u32 s53, s54
    s_cselect_b32 s53, s52, s53
    v_mfma_f32_16x16x32_bf16 v[24:27], v[56:59], v[100:103], v[24:27]
    ds_read_b128 v[88:91], v4 offset:14336
    v_mfma_f32_16x16x32_bf16 v[28:31], v[60:63], v[100:103], v[28:31]
    s_waitcnt vmcnt(4)
    ds_read_b64_tr_b16 v[48:49], v113 offset:0
    v_mfma_f32_16x16x32_bf16 v[32:35], v[104:107], v[56:59], v[32:35]
    ds_read_b64_tr_b16 v[50:51], v113 offset:256
    v_mfma_f32_16x16x32_bf16 v[36:39], v[104:107], v[60:63], v[36:39]
    ds_read_b64_tr_b16 v[52:53], v114 offset:0
    ds_read_b64_tr_b16 v[54:55], v114 offset:256
    v_mfma_f32_16x16x32_bf16 v[40:43], v[108:111], v[56:59], v[40:43]
    v_mfma_f32_16x16x32_bf16 v[44:47], v[108:111], v[60:63], v[44:47]
    s_waitcnt lgkmcnt(8)
    v_mfma_f32_16x16x32_bf16 v[8:11], v[64:67], v[72:75], v[8:11]
    ds_read_b128 v[92:95], v4 offset:15360
    v_mfma_f32_16x16x32_bf16 v[12:15], v[68:71], v[72:75], v[12:15]
    ds_read_b128 v[96:99], v4 offset:16384
    s_waitcnt lgkmcnt(9)
    v_mfma_f32_16x16x32_bf16 v[16:19], v[64:67], v[76:79], v[16:19]
    ds_read_b128 v[100:103], v4 offset:17408
    s_waitcnt lgkmcnt(3)
    s_add_u32 m0, s65, 0
    s_nop 0
    buffer_load_dwordx4 v112, s[32:35], s53 offen sc1 lds
    v_mfma_f32_16x16x32_bf16 v[20:23], v[68:71], v[76:79], v[20:23]
    ds_read_b128 v[104:107], v4 offset:18432
    buffer_load_dwordx4 v112, s[32:35], s53 offen offset:1024 sc1 lds
    s_add_u32 s53, s53, 2048
    s_cmp_ge_u32 s53, s54
    s_cselect_b32 s53, s52, s53
    v_mfma_f32_16x16x32_bf16 v[24:27], v[64:67], v[80:83], v[24:27]
    ds_read_b128 v[108:111], v4 offset:19456
    v_mfma_f32_16x16x32_bf16 v[28:31], v[68:71], v[80:83], v[28:31]
    s_waitcnt vmcnt(4)
    ds_read_b64_tr_b16 v[56:57], v113 offset:2048
    v_mfma_f32_16x16x32_bf16 v[32:35], v[84:87], v[64:67], v[32:35]
    ds_read_b64_tr_b16 v[58:59], v113 offset:2304
    v_mfma_f32_16x16x32_bf16 v[36:39], v[84:87], v[68:71], v[36:39]
    ds_read_b64_tr_b16 v[60:61], v114 offset:2048
    ds_read_b64_tr_b16 v[62:63], v114 offset:2304
    v_mfma_f32_16x16x32_bf16 v[40:43], v[88:91], v[64:67], v[40:43]
    v_mfma_f32_16x16x32_bf16 v[44:47], v[88:91], v[68:71], v[44:47]
    s_waitcnt lgkmcnt(8)
    v_mfma_f32_16x16x32_bf16 v[8:11], v[48:51], v[92:95], v[8:11]
    ds_read_b128 v[72:75], v4 offset:20480
    v_mfma_f32_16x16x32_bf16 v[12:15], v[52:55], v[92:95], v[12:15]
    ds_read_b128 v[76:79], v4 offset:21504
    s_waitcnt lgkmcnt(9)
    v_mfma_f32_16x16x32_bf16 v[16:19], v[48:51], v[96:99], v[16:19]
    ds_read_b128 v[80:83], v4 offset:22528
    s_waitcnt lgkmcnt(3)
    s_add_u32 m0, s65, 2048
    s_nop 0
    buffer_load_dwordx4 v112, s[32:35], s53 offen sc1 lds
    v_mfma_f32_16x16x32_bf16 v[20:23], v[52:55], v[96:99], v[20:23]
    ds_read_b128 v[84:87], v4 offset:23552
    buffer_load_dwordx4 v112, s[32:35], s53 offen offset:1024 sc1 lds
    s_add_u32 s53, s53, 2048
    s_cmp_ge_u32 s53, s54
    s_cselect_b32 s53, s52, s53
    v_mfma_f32_16x16x32_bf16 v[24:27], v[48:51], v[100:103], v[24:27]
    ds_read_b128 v[88:91], v4 offset:24576
    v_mfma_f32_16x16x32_bf16 v[28:31], v[52:55], v[100:103], v[28:31]
    s_waitcnt vmcnt(4)
    ds_read_b64_tr_b16 v[64:65], v113 offset:4096
    v_mfma_f32_16x16x32_bf16 v[32:35], v[104:107], v[48:51], v[32:35]
    ds_read_b64_tr_b16 v[66:67], v113 offset:4352
    v_mfma_f32_16x16x32_bf16 v[36:39], v[104:107], v[52:55], v[36:39]
    ds_read_b64_tr_b16 v[68:69], v114 offset:4096
    ds_read_b64_tr_b16 v[70:71], v114 offset:4352
    v_mfma_f32_16x16x32_bf16 v[40:43], v[108:111], v[48:51], v[40:43]
    v_mfma_f32_16x16x32_bf16 v[44:47], v[108:111], v[52:55], v[44:47]
    s_waitcnt lgkmcnt(8)
    v_mfma_f32_16x16x32_bf16 v[8:11], v[56:59], v[72:75], v[8:11]
    ds_read_b128 v[92:95], v4 offset:25600
    v_mfma_f32_16x16x32_bf16 v[12:15], v[60:63], v[72:75], v[12:15]
    ds_read_b128 v[96:99], v4 offset:26624
    s_waitcnt lgkmcnt(9)
    v_mfma_f32_16x16x32_bf16 v[16:19], v[56:59], v[76:79], v[16:19]
    ds_read_b128 v[100:103], v4 offset:27648
    s_waitcnt lgkmcnt(3)
    s_add_u32 m0, s65, 4096
    s_nop 0
    buffer_load_dwordx4 v112, s[32:35], s53 offen sc1 lds
    v_mfma_f32_16x16x32_bf16 v[20:23], v[60:63], v[76:79], v[20:23]
    ds_read_b128 v[104:107], v4 offset:28672
    buffer_load_dwordx4 v112, s[32:35], s53 offen offset:1024 sc1 lds
    s_add_u32 s53, s53, 2048
    s_cmp_ge_u32 s53, s54
    s_cselect_b32 s53, s52, s53
    v_mfma_f32_16x16x32_bf16 v[24:27], v[56:59], v[80:83], v[24:27]
    ds_read_b128 v[108:111], v4 offset:29696
    v_mfma_f32_16x16x32_bf16 v[28:31], v[60:63], v[80:83], v[28:31]
    s_waitcnt vmcnt(4)
    ds_read_b64_tr_b16 v[48:49], v113 offset:0
    v_mfma_f32_16x16x32_bf16 v[32:35], v[84:87], v[56:59], v[32:35]
    ds_read_b64_tr_b16 v[50:51], v113 offset:256
    v_mfma_f32_16x16x32_bf16 v[36:39], v[84:87], v[60:63], v[36:39]
    ds_read_b64_tr_b16 v[52:53], v114 offset:0
    ds_read_b64_tr_b16 v[54:55], v114 offset:256
    v_mfma_f32_16x16x32_bf16 v[40:43], v[88:91], v[56:59], v[40:43]
    v_mfma_f32_16x16x32_bf16 v[44:47], v[88:91], v[60:63], v[44:47]
    s_cmp_ge_u32 s71, 20
    s_cbranch_scc1 ssf_123
    v_mov_b32 v255, 0
    v_mov_b32 v254, 1
    s_mov_b64 exec, 1
    buffer_atomic_add v254, v255, s[32:35], s56 offen sc1
    s_mov_b64 exec, -1
ssf_123:
    s_waitcnt lgkmcnt(8)
    v_mfma_f32_16x16x32_bf16 v[8:11], v[64:67], v[92:95], v[8:11]
    ds_read_b128 v[72:75], v4 offset:30720
    v_mfma_f32_16x16x32_bf16 v[12:15], v[68:71], v[92:95], v[12:15]
    ds_read_b128 v[76:79], v4 offset:31744
    s_waitcnt lgkmcnt(9)
    v_mfma_f32_16x16x32_bf16 v[16:19], v[64:67], v[96:99], v[16:19]
    ds_read_b128 v[80:83], v4 offset:32768
    s_waitcnt lgkmcnt(3)
    s_add_u32 m0, s65, 0
    s_nop 0
    buffer_load_dwordx4 v112, s[32:35], s53 offen sc1 lds
    v_mfma_f32_16x16x32_bf16 v[20:23], v[68:71], v[96:99], v[20:23]
    ds_read_b128 v[84:87], v4 offset:33792
    buffer_load_dwordx4 v112, s[32:35], s53 offen offset:1024 sc1 lds
    s_add_u32 s53, s53, 2048
    s_cmp_ge_u32 s53, s54
    s_cselect_b32 s53, s52, s53
    v_mfma_f32_16x16x32_bf16 v[24:27], v[64:67], v[100:103], v[24:27]
    ds_read_b128 v[88:91], v4 offset:34816
    v_mfma_f32_16x16x32_bf16 v[28:31], v[68:71], v[100:103], v[28:31]
    s_waitcnt vmcnt(4)
    ds_read_b64_tr_b16 v[56:57], v113 offset:2048
    v_mfma_f32_16x16x32_bf16 v[32:35], v[104:107], v[64:67], v[32:35]
    ds_read_b64_tr_b16 v[58:59], v113 offset:2304
    v_mfma_f32_16x16x32_bf16 v[36:39], v[104:107], v[68:71], v[36:39]
    ds_read_b64_tr_b16 v[60:61], v114 offset:2048
    ds_read_b64_tr_b16 v[62:63], v114 offset:2304
    v_mfma_f32_16x16x32_bf16 v[40:43], v[108:111], v[64:67], v[40:43]
    v_mfma_f32_16x16x32_bf16 v[44:47], v[108:111], v[68:71], v[44:47]
    s_waitcnt lgkmcnt(8)
    v_mfma_f32_16x16x32_bf16 v[8:11], v[48:51], v[72:75], v[8:11]
    ds_read_b128 v[92:95], v4 offset:35840
    v_mfma_f32_16x16x32_bf16 v[12:15], v[52:55], v[72:75], v[12:15]
    ds_read_b128 v[96:99], v4 offset:36864
    s_waitcnt lgkmcnt(9)
    v_mfma_f32_16x16x32_bf16 v[16:19], v[48:51], v[76:79], v[16:19]
    ds_read_b128 v[100:103], v4 offset:37888
    s_waitcnt lgkmcnt(3)
    s_add_u32 m0, s65, 2048
    s_nop 0
    buffer_load_dwordx4 v112, s[32:35], s53 offen sc1 lds
    v_mfma_f32_16x16x32_bf16 v[20:23], v[52:55], v[76:79], v[20:23]
    ds_read_b128 v[104:107], v4 offset:38912
    buffer_load_dwordx4 v112, s[32:35], s53 offen offset:1024 sc1 lds
    s_add_u32 s53, s53, 2048
    s_cmp_ge_u32 s53, s54
    s_cselect_b32 s53, s52, s53
    v_mfma_f32_16x16x32_bf16 v[24:27], v[48:51], v[80:83], v[24:27]
    ds_read_b128 v[108:111], v4 offset:39936
    v_mfma_f32_16x16x32_bf16 v[28:31], v[52:55], v[80:83], v[28:31]
    s_waitcnt vmcnt(4)
    ds_read_b64_tr_b16 v[64:65], v113 offset:4096
    v_mfma_f32_16x16x32_bf16 v[32:35], v[84:87], v[48:51], v[32:35]
    ds_read_b64_tr_b16 v[66:67], v113 offset:4352
    v_mfma_f32_16x16x32_bf16 v[36:39], v[84:87], v[52:55], v[36:39]
    ds_read_b64_tr_b16 v[68:69], v114 offset:4096
    ds_read_b64_tr_b16 v[70:71], v114 offset:4352
    v_mfma_f32_16x16x32_bf16 v[40:43], v[88:91], v[48:51], v[40:43]
    v_mfma_f32_16x16x32_bf16 v[44:47], v[88:91], v[52:55], v[44:47]
    s_waitcnt lgkmcnt(8)
    v_mfma_f32_16x16x32_bf16 v[8:11], v[56:59], v[92:95], v[8:11]
    ds_read_b128 v[72:75], v4 offset:40960
    v_mfma_f32_16x16x32_bf16 v[12:15], v[60:63], v[92:95], v[12:15]
    ds_read_b128 v[76:79], v4 offset:41984
    s_waitcnt lgkmcnt(9)
    v_mfma_f32_16x16x32_bf16 v[16:19], v[56:59], v[96:99], v[16:19]
    ds_read_b128 v[80:83], v4 offset:43008
    s_waitcnt lgkmcnt(3)
    s_add_u32 m0, s65, 4096
    s_nop 0
    buffer_load_dwordx4 v112, s[32:35], s53 offen sc1 lds
    v_mfma_f32_16x16x32_bf16 v[20:23], v[60:63], v[96:99], v[20:23]
    ds_read_b128 v[84:87], v4 offset:44032
    buffer_load_dwordx4 v112, s[32:35], s53 offen offset:1024 sc1 lds
    s_add_u32 s53, s53, 2048
    s_cmp_ge_u32 s53, s54
    s_cselect_b32 s53, s52, s53
    v_mfma_f32_16x16x32_bf16 v[24:27], v[56:59], v[100:103], v[24:27]
    ds_read_b128 v[88:91], v4 offset:45056
    v_mfma_f32_16x16x32_bf16 v[28:31], v[60:63], v[100:103], v[28:31]
    s_waitcnt vmcnt(4)
    ds_read_b64_tr_b16 v[48:49], v113 offset:0
    v_mfma_f32_16x16x32_bf16 v[32:35], v[104:107], v[56:59], v[32:35]
    ds_read_b64_tr_b16 v[50:51], v113 offset:256
    v_mfma_f32_16x16x32_bf16 v[36:39], v[104:107], v[60:63], v[36:39]
    ds_read_b64_tr_b16 v[52:53], v114 offset:0
    ds_read_b64_tr_b16 v[54:55], v114 offset:256
    v_mfma_f32_16x16x32_bf16 v[40:43], v[108:111], v[56:59], v[40:43]
    v_mfma_f32_16x16x32_bf16 v[44:47], v[108:111], v[60:63], v[44:47]
    s_waitcnt lgkmcnt(8)
    v_mfma_f32_16x16x32_bf16 v[8:11], v[64:67], v[72:75], v[8:11]
    ds_read_b128 v[92:95], v4 offset:46080
    v_mfma_f32_16x16x32_bf16 v[12:15], v[68:71], v[72:75], v[12:15]
    ds_read_b128 v[96:99], v4 offset:47104
    s_waitcnt lgkmcnt(9)
    v_mfma_f32_16x16x32_bf16 v[16:19], v[64:67], v[76:79], v[16:19]
    ds_read_b128 v[100:103], v4 offset:48128
    s_waitcnt lgkmcnt(3)
    s_add_u32 m0, s65, 0
    s_nop 0
    buffer_load_dwordx4 v112, s[32:35], s53 offen sc1 lds
    v_mfma_f32_16x16x32_bf16 v[20:23], v[68:71], v[76:79], v[20:23]
    ds_read_b128 v[104:107], v4 offset:49152
    buffer_load_dwordx4 v112, s[32:35], s53 offen offset:1024 sc1 lds
    s_add_u32 s53, s53, 2048
    s_cmp_ge_u32 s53, s54
    s_cselect_b32 s53, s52, s53
    v_mfma_f32_16x16x32_bf16 v[24:27], v[64:67], v[80:83], v[24:27]
    ds_read_b128 v[108:111], v4 offset:50176
    v_mfma_f32_16x16x32_bf16 v[28:31], v[68:71], v[80:83], v[28:31]
    s_waitcnt vmcnt(4)
    ds_read_b64_tr_b16 v[56:57], v113 offset:2048
    v_mfma_f32_16x16x32_bf16 v[32:35], v[84:87], v[64:67], v[32:35]
    ds_read_b64_tr_b16 v[58:59], v113 offset:2304
    v_mfma_f32_16x16x32_bf16 v[36:39], v[84:87], v[68:71], v[36:39]
    ds_read_b64_tr_b16 v[60:61], v114 offset:2048
    ds_read_b64_tr_b16 v[62:63], v114 offset:2304
    v_mfma_f32_16x16x32_bf16 v[40:43], v[88:91], v[64:67], v[40:43]
    v_mfma_f32_16x16x32_bf16 v[44:47], v[88:91], v[68:71], v[44:47]
    s_cmp_lg_u32 s3, 7
    s_cbranch_scc1 pb_124
    s_and_b32 s59, s2, 3
    s_lshl_b32 s59, s59, 12
    s_add_u32 s59, s59, 37732352
    v_lshlrev_b32 v255, 8, v2
    buffer_load_dword v151, v255, s[32:35], s59 offen sc1
pb_124:
    s_waitcnt lgkmcnt(8)
    v_mfma_f32_16x16x32_bf16 v[8:11], v[48:51], v[92:95], v[8:11]
    ds_read_b128 v[72:75], v115 offset:0
    v_mfma_f32_16x16x32_bf16 v[12:15], v[52:55], v[92:95], v[12:15]
    ds_read_b128 v[76:79], v115 offset:1024
    s_waitcnt lgkmcnt(9)
    v_mfma_f32_16x16x32_bf16 v[16:19], v[48:51], v[96:99], v[16:19]
    ds_read_b128 v[80:83], v115 offset:2048
    s_waitcnt lgkmcnt(3)
    s_add_u32 m0, s65, 2048
    s_nop 0
    buffer_load_dwordx4 v112, s[32:35], s53 offen sc1 lds
    v_mfma_f32_16x16x32_bf16 v[20:23], v[52:55], v[96:99], v[20:23]
    ds_read_b128 v[84:87], v115 offset:3072
    buffer_load_dwordx4 v112, s[32:35], s53 offen offset:1024 sc1 lds
    s_add_u32 s53, s53, 2048
    s_cmp_ge_u32 s53, s54
    s_cselect_b32 s53, s52, s53
    v_mfma_f32_16x16x32_bf16 v[24:27], v[48:51], v[100:103], v[24:27]
    ds_read_b128 v[88:91], v115 offset:4096
    v_mfma_f32_16x16x32_bf16 v[28:31], v[52:55], v[100:103], v[28:31]
    s_waitcnt vmcnt(4)
    ds_read_b64_tr_b16 v[64:65], v113 offset:4096
    v_mfma_f32_16x16x32_bf16 v[32:35], v[104:107], v[48:51], v[32:35]
    ds_read_b64_tr_b16 v[66:67], v113 offset:4352
    v_mfma_f32_16x16x32_bf16 v[36:39], v[104:107], v[52:55], v[36:39]
    ds_read_b64_tr_b16 v[68:69], v114 offset:4096
    ds_read_b64_tr_b16 v[70:71], v114 offset:4352
    v_mfma_f32_16x16x32_bf16 v[40:43], v[108:111], v[48:51], v[40:43]
    v_mfma_f32_16x16x32_bf16 v[44:47], v[108:111], v[52:55], v[44:47]
    s_waitcnt lgkmcnt(8)
    v_mfma_f32_16x16x32_bf16 v[8:11], v[56:59], v[72:75], v[8:11]
    ds_read_b128 v[92:95], v115 offset:5120
    v_mfma_f32_16x16x32_bf16 v[12:15], v[60:63], v[72:75], v[12:15]
    ds_read_b128 v[96:99], v115 offset:6144
    s_waitcnt lgkmcnt(9)
    v_mfma_f32_16x16x32_bf16 v[16:19], v[56:59], v[76:79], v[16:19]
    ds_read_b128 v[100:103], v115 offset:7168
    s_waitcnt lgkmcnt(3)
    s_add_u32 m0, s65, 4096
    s_nop 0
    buffer_load_dwordx4 v112, s[32:35], s53 offen sc1 lds
    v_mfma_f32_16x16x32_bf16 v[20:23], v[60:63], v[76:79], v[20:23]
    ds_read_b128 v[104:107], v115 offset:8192
    buffer_load_dwordx4 v112, s[32:35], s53 offen offset:1024 sc1 lds
    s_add_u32 s53, s53, 2048
    s_cmp_ge_u32 s53, s54
    s_cselect_b32 s53, s52, s53
    v_mfma_f32_16x16x32_bf16 v[24:27], v[56:59], v[80:83], v[24:27]
    ds_read_b128 v[108:111], v115 offset:9216
    v_mfma_f32_16x16x32_bf16 v[28:31], v[60:63], v[80:83], v[28:31]
    s_waitcnt vmcnt(4)
    ds_read_b64_tr_b16 v[48:49], v113 offset:0
    v_mfma_f32_16x16x32_bf16 v[32:35], v[84:87], v[56:59], v[32:35]
    ds_read_b64_tr_b16 v[50:51], v113 offset:256
    v_mfma_f32_16x16x32_bf16 v[36:39], v[84:87], v[60:63], v[36:39]
    ds_read_b64_tr_b16 v[52:53], v114 offset:0
    ds_read_b64_tr_b16 v[54:55], v114 offset:256
    v_mfma_f32_16x16x32_bf16 v[40:43], v[88:91], v[56:59], v[40:43]
    v_mfma_f32_16x16x32_bf16 v[44:47], v[88:91], v[60:63], v[44:47]
    s_waitcnt lgkmcnt(8)
    v_mfma_f32_16x16x32_bf16 v[8:11], v[64:67], v[92:95], v[8:11]
    ds_read_b128 v[72:75], v115 offset:10240
    v_mfma_f32_16x16x32_bf16 v[12:15], v[68:71], v[92:95], v[12:15]
    ds_read_b128 v[76:79], v115 offset:11264
    s_waitcnt lgkmcnt(9)
    v_mfma_f32_16x16x32_bf16 v[16:19], v[64:67], v[96:99], v[16:19]
    ds_read_b128 v[80:83], v115 offset:12288
    s_waitcnt lgkmcnt(3)
    s_add_u32 m0, s65, 0
    s_nop 0
    buffer_load_dwordx4 v112, s[32:35], s53 offen sc1 lds
    v_mfma_f32_16x16x32_bf16 v[20:23], v[68:71], v[96:99], v[20:23]
    ds_read_b128 v[84:87], v115 offset:13312
    buffer_load_dwordx4 v112, s[32:35], s53 offen offset:1024 sc1 lds
    s_add_u32 s53, s53, 2048
    s_cmp_ge_u32 s53, s54
    s_cselect_b32 s53, s52, s53
    v_mfma_f32_16x16x32_bf16 v[24:27], v[64:67], v[100:103], v[24:27]
    ds_read_b128 v[88:91], v115 offset:14336
    v_mfma_f32_16x16x32_bf16 v[28:31], v[68:71], v[100:103], v[28:31]
    s_waitcnt vmcnt(4)
    ds_read_b64_tr_b16 v[56:57], v113 offset:2048
    v_mfma_f32_16x16x32_bf16 v[32:35], v[104:107], v[64:67], v[32:35]
    ds_read_b64_tr_b16 v[58:59], v113 offset:2304
    v_mfma_f32_16x16x32_bf16 v[36:39], v[104:107], v[68:71], v[36:39]
    ds_read_b64_tr_b16 v[60:61], v114 offset:2048
    ds_read_b64_tr_b16 v[62:63], v114 offset:2304
    v_mfma_f32_16x16x32_bf16 v[40:43], v[108:111], v[64:67], v[40:43]
    v_mfma_f32_16x16x32_bf16 v[44:47], v[108:111], v[68:71], v[44:47]
    s_waitcnt lgkmcnt(8)
    v_mfma_f32_16x16x32_bf16 v[8:11], v[48:51], v[72:75], v[8:11]
    ds_read_b128 v[92:95], v115 offset:15360
    v_mfma_f32_16x16x32_bf16 v[12:15], v[52:55], v[72:75], v[12:15]
    ds_read_b128 v[96:99], v115 offset:16384
    s_waitcnt lgkmcnt(9)
    v_mfma_f32_16x16x32_bf16 v[16:19], v[48:51], v[76:79], v[16:19]
    ds_read_b128 v[100:103], v115 offset:17408
    s_waitcnt lgkmcnt(3)
    s_add_u32 m0, s65, 2048
    s_nop 0
    buffer_load_dwordx4 v112, s[32:35], s53 offen sc1 lds
    v_mfma_f32_16x16x32_bf16 v[20:23], v[52:55], v[76:79], v[20:23]
    ds_read_b128 v[104:107], v115 offset:18432
    buffer_load_dwordx4 v112, s[32:35], s53 offen offset:1024 sc1 lds
    s_add_u32 s53, s53, 2048
    s_cmp_ge_u32 s53, s54
    s_cselect_b32 s53, s52, s53
    v_mfma_f32_16x16x32_bf16 v[24:27], v[48:51], v[80:83], v[24:27]
    ds_read_b128 v[108:111], v115 offset:19456
    v_mfma_f32_16x16x32_bf16 v[28:31], v[52:55], v[80:83], v[28:31]
    s_waitcnt vmcnt(4)
    ds_read_b64_tr_b16 v[64:65], v113 offset:4096
    v_mfma_f32_16x16x32_bf16 v[32:35], v[84:87], v[48:51], v[32:35]
    ds_read_b64_tr_b16 v[66:67], v113 offset:4352
    v_mfma_f32_16x16x32_bf16 v[36:39], v[84:87], v[52:55], v[36:39]
    ds_read_b64_tr_b16 v[68:69], v114 offset:4096
    ds_read_b64_tr_b16 v[70:71], v114 offset:4352
    v_mfma_f32_16x16x32_bf16 v[40:43], v[88:91], v[48:51], v[40:43]
    v_mfma_f32_16x16x32_bf16 v[44:47], v[88:91], v[52:55], v[44:47]
    s_waitcnt lgkmcnt(8)
    v_mfma_f32_16x16x32_bf16 v[8:11], v[56:59], v[92:95], v[8:11]
    ds_read_b128 v[72:75], v115 offset:20480
    v_mfma_f32_16x16x32_bf16 v[12:15], v[60:63], v[92:95], v[12:15]
    ds_read_b128 v[76:79], v115 offset:21504
    s_waitcnt lgkmcnt(9)
    v_mfma_f32_16x16x32_bf16 v[16:19], v[56:59], v[96:99], v[16:19]
    ds_read_b128 v[80:83], v115 offset:22528
    s_waitcnt lgkmcnt(3)
    s_add_u32 m0, s65, 4096
    s_nop 0
    buffer_load_dwordx4 v112, s[32:35], s53 offen sc1 lds
    v_mfma_f32_16x16x32_bf16 v[20:23], v[60:63], v[96:99], v[20:23]
    ds_read_b128 v[84:87], v115 offset:23552
    buffer_load_dwordx4 v112, s[32:35], s53 offen offset:1024 sc1 lds
    s_add_u32 s53, s53, 2048
    s_cmp_ge_u32 s53, s54
    s_cselect_b32 s53, s52, s53
    v_mfma_f32_16x16x32_bf16 v[24:27], v[56:59], v[100:103], v[24:27]
    ds_read_b128 v[88:91], v115 offset:24576
    v_mfma_f32_16x16x32_bf16 v[28:31], v[60:63], v[100:103], v[28:31]
    s_waitcnt vmcnt(4)
    ds_read_b64_tr_b16 v[48:49], v113 offset:0
    v_mfma_f32_16x16x32_bf16 v[32:35], v[104:107], v[56:59], v[32:35]
    ds_read_b64_tr_b16 v[50:51], v113 offset:256
    v_mfma_f32_16x16x32_bf16 v[36:39], v[104:107], v[60:63], v[36:39]
    ds_read_b64_tr_b16 v[52:53], v114 offset:0
    ds_read_b64_tr_b16 v[54:55], v114 offset:256
    v_mfma_f32_16x16x32_bf16 v[40:43], v[108:111], v[56:59], v[40:43]
    v_mfma_f32_16x16x32_bf16 v[44:47], v[108:111], v[60:63], v[44:47]
    v_mov_b32 v5, 0
    buffer_load_dword v140, v5, s[32:35], s56 offen sc1
    s_cmp_lg_u32 s3, 7
    s_cbranch_scc1 w5c_125
    v_cmp_gt_u32 vcc, 8, v2
    v_mov_b32 v253, 4
    s_nop 0
    v_cndmask_b32 v253, 8, v253, vcc
    v_cmp_gt_u32 vcc, v253, v151
    s_nop 0
    s_cmp_eq_u64 vcc, 0
    s_cbranch_scc1 w5c_125
    s_cmp_lg_u32 s3, 7
    s_cbranch_scc1 wt_126
    s_and_b32 s59, s2, 3
    s_lshl_b32 s59, s59, 12
    s_add_u32 s59, s59, 37732352
    v_lshlrev_b32 v255, 8, v2
    v_cmp_gt_u32 vcc, 8, v2
    v_mov_b32 v253, 4
    s_nop 0
    v_cndmask_b32 v253, 8, v253, vcc
    s_mov_b32 s58, 40000
    s_cmp_lg_u32 s83, 0
    s_cbranch_scc1 polld_128
poll_127:
    buffer_load_dword v254, v255, s[32:35], s59 offen sc1
    s_waitcnt vmcnt(0)
    v_cmp_gt_u32 vcc, v253, v254
    s_nop 0
    s_cmp_eq_u64 vcc, 0
    s_cbranch_scc1 polld_128
    s_sub_u32 s58, s58, 1
    s_cmp_lg_u32 s58, 0
    s_cbranch_scc1 poll_127
    s_mov_b32 s83, 4
    v_mov_b32 v254, 4
    v_mov_b32 v255, 16
    buffer_store_dword v254, v255, s[36:39], 0 offen
polld_128:
wt_126:
w5c_125:
    s_barrier
    s_waitcnt lgkmcnt(8)
    v_mfma_f32_16x16x32_bf16 v[8:11], v[64:67], v[72:75], v[8:11]
    ds_read_b128 v[92:95], v115 offset:25600
    v_mfma_f32_16x16x32_bf16 v[12:15], v[68:71], v[72:75], v[12:15]
    ds_read_b128 v[96:99], v115 offset:26624
    s_waitcnt lgkmcnt(9)
    v_mfma_f32_16x16x32_bf16 v[16:19], v[64:67], v[76:79], v[16:19]
    ds_read_b128 v[100:103], v115 offset:27648
    s_waitcnt lgkmcnt(3)
    s_add_u32 m0, s65, 0
    s_nop 0
    buffer_load_dwordx4 v112, s[32:35], s53 offen sc1 lds
    v_mfma_f32_16x16x32_bf16 v[20:23], v[68:71], v[76:79], v[20:23]
    ds_read_b128 v[104:107], v115 offset:28672
    buffer_load_dwordx4 v112, s[32:35], s53 offen offset:1024 sc1 lds
    s_add_u32 s53, s53, 2048
    s_cmp_ge_u32 s53, s54
    s_cselect_b32 s53, s52, s53
    v_mfma_f32_16x16x32_bf16 v[24:27], v[64:67], v[80:83], v[24:27]
    ds_read_b128 v[108:111], v115 offset:29696
    v_mfma_f32_16x16x32_bf16 v[28:31], v[68:71], v[80:83], v[28:31]
    s_waitcnt vmcnt(4)
    ds_read_b64_tr_b16 v[56:57], v113 offset:2048
    v_mfma_f32_16x16x32_bf16 v[32:35], v[84:87], v[64:67], v[32:35]
    ds_read_b64_tr_b16 v[58:59], v113 offset:2304
    v_mfma_f32_16x16x32_bf16 v[36:39], v[84:87], v[68:71], v[36:39]
    ds_read_b64_tr_b16 v[60:61], v114 offset:2048
    ds_read_b64_tr_b16 v[62:63], v114 offset:2304
    v_mfma_f32_16x16x32_bf16 v[40:43], v[88:91], v[64:67], v[40:43]
    v_mfma_f32_16x16x32_bf16 v[44:47], v[88:91], v[68:71], v[44:47]
    s_waitcnt lgkmcnt(8)
    v_mfma_f32_16x16x32_bf16 v[8:11], v[48:51], v[92:95], v[8:11]
    ds_read_b128 v[72:75], v115 offset:30720
    v_mfma_f32_16x16x32_bf16 v[12:15], v[52:55], v[92:95], v[12:15]
    ds_read_b128 v[76:79], v115 offset:31744
    s_waitcnt lgkmcnt(9)
    v_mfma_f32_16x16x32_bf16 v[16:19], v[48:51], v[96:99], v[16:19]
    ds_read_b128 v[80:83], v115 offset:32768
    s_waitcnt lgkmcnt(3)
    s_add_u32 m0, s65, 2048
    s_nop 0
    buffer_load_dwordx4 v112, s[32:35], s53 offen sc1 lds
    v_mfma_f32_16x16x32_bf16 v[20:23], v[52:55], v[96:99], v[20:23]
    ds_read_b128 v[84:87], v115 offset:33792
    buffer_load_dwordx4 v112, s[32:35], s53 offen offset:1024 sc1 lds
    s_add_u32 s53, s53, 2048
    s_cmp_ge_u32 s53, s54
    s_cselect_b32 s53, s52, s53
    v_mfma_f32_16x16x32_bf16 v[24:27], v[48:51], v[100:103], v[24:27]
    ds_read_b128 v[88:91], v115 offset:34816
    v_mfma_f32_16x16x32_bf16 v[28:31], v[52:55], v[100:103], v[28:31]
    s_waitcnt vmcnt(4)
    ds_read_b64_tr_b16 v[64:65], v113 offset:4096
    v_mfma_f32_16x16x32_bf16 v[32:35], v[104:107], v[48:51], v[32:35]
    ds_read_b64_tr_b16 v[66:67], v113 offset:4352
    v_mfma_f32_16x16x32_bf16 v[36:39], v[104:107], v[52:55], v[36:39]
    ds_read_b64_tr_b16 v[68:69], v114 offset:4096
    ds_read_b64_tr_b16 v[70:71], v114 offset:4352
    v_mfma_f32_16x16x32_bf16 v[40:43], v[108:111], v[48:51], v[40:43]
    v_mfma_f32_16x16x32_bf16 v[44:47], v[108:111], v[52:55], v[44:47]
    s_waitcnt lgkmcnt(8)
    v_mfma_f32_16x16x32_bf16 v[8:11], v[56:59], v[72:75], v[8:11]
    ds_read_b128 v[92:95], v115 offset:35840
    v_mfma_f32_16x16x32_bf16 v[12:15], v[60:63], v[72:75], v[12:15]
    ds_read_b128 v[96:99], v115 offset:36864
    s_waitcnt lgkmcnt(9)
    v_mfma_f32_16x16x32_bf16 v[16:19], v[56:59], v[76:79], v[16:19]
    ds_read_b128 v[100:103], v115 offset:37888
    v_mfma_f32_16x16x32_bf16 v[20:23], v[60:63], v[76:79], v[20:23]
    ds_read_b128 v[104:107], v115 offset:38912
    s_waitcnt lgkmcnt(10)
    v_mfma_f32_16x16x32_bf16 v[24:27], v[56:59], v[80:83], v[24:27]
    ds_read_b128 v[108:111], v115 offset:39936
    v_mfma_f32_16x16x32_bf16 v[28:31], v[60:63], v[80:83], v[28:31]
    s_waitcnt vmcnt(2)
    ds_read_b64_tr_b16 v[48:49], v113 offset:0
    s_waitcnt lgkmcnt(11)
    v_mfma_f32_16x16x32_bf16 v[32:35], v[84:87], v[56:59], v[32:35]
    ds_read_b64_tr_b16 v[50:51], v113 offset:256
    v_mfma_f32_16x16x32_bf16 v[36:39], v[84:87], v[60:63], v[36:39]
    ds_read_b64_tr_b16 v[52:53], v114 offset:0
    ds_read_b64_tr_b16 v[54:55], v114 offset:256
    s_waitcnt lgkmcnt(13)
    v_mfma_f32_16x16x32_bf16 v[40:43], v[88:91], v[56:59], v[40:43]
    v_mfma_f32_16x16x32_bf16 v[44:47], v[88:91], v[60:63], v[44:47]
    v_cmp_gt_u32 vcc, 20, v140
    s_nop 0
    s_cmp_eq_u64 vcc, 0
    s_cbranch_scc1 ssp_129
    v_mov_b32 v255, 0
    s_mov_b32 s58, 40000
    s_cmp_lg_u32 s83, 0
    s_cbranch_scc1 polld_131
poll_130:
    buffer_load_dword v254, v255, s[32:35], s56 offen sc1
    s_waitcnt vmcnt(0)
    v_cmp_gt_u32 vcc, 20, v254
    s_nop 0
    s_cmp_eq_u64 vcc, 0
    s_cbranch_scc1 polld_131
    s_sub_u32 s58, s58, 1
    s_cmp_lg_u32 s58, 0
    s_cbranch_scc1 poll_130
    s_mov_b32 s83, 21
    v_mov_b32 v254, 21
    v_mov_b32 v255, 16
    buffer_store_dword v254, v255, s[36:39], 0 offen
polld_131:
ssp_129:
    v_lshlrev_b32 v5, 4, v3
    v_lshlrev_b32 v6, 2, v2
    buffer_load_dwordx4 v[140:143], v5, s[32:35], s55 offen sc1
    buffer_load_dwordx4 v[144:147], v5, s[32:35], s55 offen offset:64 sc1
    buffer_load_dword v148, v6, s[32:35], s55 offen sc1
    buffer_load_dword v149, v6, s[32:35], s55 offen offset:64 sc1
    s_waitcnt lgkmcnt(8)
    v_mfma_f32_16x16x32_bf16 v[8:11], v[64:67], v[92:95], v[8:11]
    ds_read_b128 v[72:75], v115 offset:40960
    v_mfma_f32_16x16x32_bf16 v[12:15], v[68:71], v[92:95], v[12:15]
    ds_read_b128 v[76:79], v115 offset:41984
    s_waitcnt lgkmcnt(9)
    v_mfma_f32_16x16x32_bf16 v[16:19], v[64:67], v[96:99], v[16:19]
    ds_read_b128 v[80:83], v115 offset:43008
    v_mfma_f32_16x16x32_bf16 v[20:23], v[68:71], v[96:99], v[20:23]
    ds_read_b128 v[84:87], v115 offset:44032
    s_waitcnt lgkmcnt(10)
    v_mfma_f32_16x16x32_bf16 v[24:27], v[64:67], v[100:103], v[24:27]
    ds_read_b128 v[88:91], v115 offset:45056
    v_mfma_f32_16x16x32_bf16 v[28:31], v[68:71], v[100:103], v[28:31]
    s_waitcnt vmcnt(4)
    ds_read_b64_tr_b16 v[56:57], v113 offset:2048
    s_waitcnt lgkmcnt(11)
    v_mfma_f32_16x16x32_bf16 v[32:35], v[104:107], v[64:67], v[32:35]
    ds_read_b64_tr_b16 v[58:59], v113 offset:2304
    v_mfma_f32_16x16x32_bf16 v[36:39], v[104:107], v[68:71], v[36:39]
    ds_read_b64_tr_b16 v[60:61], v114 offset:2048
    ds_read_b64_tr_b16 v[62:63], v114 offset:2304
    s_waitcnt lgkmcnt(13)
    v_mfma_f32_16x16x32_bf16 v[40:43], v[108:111], v[64:67], v[40:43]
    v_mfma_f32_16x16x32_bf16 v[44:47], v[108:111], v[68:71], v[44:47]
    s_waitcnt lgkmcnt(8)
    v_mfma_f32_16x16x32_bf16 v[8:11], v[48:51], v[72:75], v[8:11]
    ds_read_b128 v[92:95], v115 offset:46080
    v_mfma_f32_16x16x32_bf16 v[12:15], v[52:55], v[72:75], v[12:15]
    ds_read_b128 v[96:99], v115 offset:47104
    s_waitcnt lgkmcnt(9)
    v_mfma_f32_16x16x32_bf16 v[16:19], v[48:51], v[76:79], v[16:19]
    ds_read_b128 v[100:103], v115 offset:48128
    v_mfma_f32_16x16x32_bf16 v[20:23], v[52:55], v[76:79], v[20:23]
    ds_read_b128 v[104:107], v115 offset:49152
    s_waitcnt lgkmcnt(10)
    v_mfma_f32_16x16x32_bf16 v[24:27], v[48:51], v[80:83], v[24:27]
    ds_read_b128 v[108:111], v115 offset:50176
    v_mfma_f32_16x16x32_bf16 v[28:31], v[52:55], v[80:83], v[28:31]
    s_waitcnt lgkmcnt(10)
    v_mfma_f32_16x16x32_bf16 v[32:35], v[84:87], v[48:51], v[32:35]
    v_mfma_f32_16x16x32_bf16 v[36:39], v[84:87], v[52:55], v[36:39]
    s_waitcnt lgkmcnt(9)
    v_mfma_f32_16x16x32_bf16 v[40:43], v[88:91], v[48:51], v[40:43]
    v_mfma_f32_16x16x32_bf16 v[44:47], v[88:91], v[52:55], v[44:47]
    s_mov_b32 s40, 0x36a3d70a
    v_mov_b32 v7, 0x3727c5ac
    s_waitcnt vmcnt(0)
    v_fma_f32 v140, v140, s40, v7
    v_fma_f32 v141, v141, s40, v7
    v_fma_f32 v142, v142, s40, v7
    v_fma_f32 v143, v143, s40, v7
    v_fma_f32 v144, v144, s40, v7
    v_fma_f32 v145, v145, s40, v7
    v_fma_f32 v146, v146, s40, v7
    v_fma_f32 v147, v147, s40, v7
    v_fma_f32 v148, v148, s40, v7
    v_fma_f32 v149, v149, s40, v7
    v_rsq_f32 v140, v140
    v_rsq_f32 v141, v141
    v_rsq_f32 v142, v142
    v_rsq_f32 v143, v143
    v_rsq_f32 v144, v144
    v_rsq_f32 v145, v145
    v_rsq_f32 v146, v146
    v_rsq_f32 v147, v147
    v_rsq_f32 v148, v148
    v_rsq_f32 v149, v149
    s_waitcnt lgkmcnt(4)
    v_mfma_f32_16x16x32_bf16 v[8:11], v[56:59], v[92:95], v[8:11]
    v_mfma_f32_16x16x32_bf16 v[12:15], v[60:63], v[92:95], v[12:15]
    s_waitcnt lgkmcnt(3)
    v_mfma_f32_16x16x32_bf16 v[16:19], v[56:59], v[96:99], v[16:19]
    v_mfma_f32_16x16x32_bf16 v[20:23], v[60:63], v[96:99], v[20:23]
    s_waitcnt lgkmcnt(2)
    v_mfma_f32_16x16x32_bf16 v[24:27], v[56:59], v[100:103], v[24:27]
    v_mfma_f32_16x16x32_bf16 v[28:31], v[60:63], v[100:103], v[28:31]
    s_waitcnt lgkmcnt(1)
    v_mfma_f32_16x16x32_bf16 v[32:35], v[104:107], v[56:59], v[32:35]
    v_mfma_f32_16x16x32_bf16 v[36:39], v[104:107], v[60:63], v[36:39]
    s_waitcnt lgkmcnt(0)
    v_mfma_f32_16x16x32_bf16 v[40:43], v[108:111], v[56:59], v[40:43]
    v_mfma_f32_16x16x32_bf16 v[44:47], v[108:111], v[60:63], v[44:47]
    v_mov_b32 v58, 0x358637bd
    s_mov_b32 s41, 0x3fb8aa3b
    v_mul_f32 v16, v16, v140
    v_mul_f32 v17, v17, v141
    v_mul_f32 v18, v18, v142
    v_mul_f32 v19, v19, v143
    v_mul_f32 v20, v20, v144
    v_mul_f32 v21, v21, v145
    v_mul_f32 v22, v22, v146
    v_mul_f32 v23, v23, v147
    v_cvt_pk_bf16_f32 v84, v16, v17
    v_cvt_pk_bf16_f32 v85, v18, v19
    v_cvt_pk_bf16_f32 v86, v20, v21
    v_cvt_pk_bf16_f32 v87, v22, v23
    v_fma_f32 v64, v140, v122, v123
    v_fma_f32 v65, v141, v122, v123
    v_fma_f32 v66, v142, v122, v123
    v_fma_f32 v67, v143, v122, v123
    v_fma_f32 v68, v144, v122, v123
    v_fma_f32 v69, v145, v122, v123
    v_fma_f32 v70, v146, v122, v123
    v_fma_f32 v71, v147, v122, v123
    v_fma_f32 v8, v8, v140, v58
    v_fma_f32 v9, v9, v141, v58
    v_fma_f32 v10, v10, v142, v58
    v_fma_f32 v11, v11, v143, v58
    v_fma_f32 v12, v12, v144, v58
    v_fma_f32 v13, v13, v145, v58
    v_fma_f32 v14, v14, v146, v58
    v_fma_f32 v15, v15, v147, v58
    v_mul_f32 v72, s41, v8
    v_mul_f32 v73, s41, v9
    v_mul_f32 v74, s41, v10
    v_mul_f32 v75, s41, v11
    v_mul_f32 v76, s41, v12
    v_mul_f32 v77, s41, v13
    v_mul_f32 v78, s41, v14
    v_mul_f32 v79, s41, v15
    v_exp_f32_e64 v72, v72 clamp
    v_exp_f32_e64 v73, v73 clamp
    v_exp_f32_e64 v74, v74 clamp
    v_exp_f32_e64 v75, v75 clamp
    v_exp_f32_e64 v76, v76 clamp
    v_exp_f32_e64 v77, v77 clamp
    v_exp_f32_e64 v78, v78 clamp
    v_exp_f32_e64 v79, v79 clamp
    v_max_f32 v8, v8, v58
    v_max_f32 v9, v9, v58
    v_max_f32 v10, v10, v58
    v_max_f32 v11, v11, v58
    v_max_f32 v12, v12, v58
    v_max_f32 v13, v13, v58
    v_max_f32 v14, v14, v58
    v_max_f32 v15, v15, v58
    v_add_f32 v8, v8, v72
    v_add_f32 v9, v9, v73
    v_add_f32 v10, v10, v74
    v_add_f32 v11, v11, v75
    v_add_f32 v12, v12, v76
    v_add_f32 v13, v13, v77
    v_add_f32 v14, v14, v78
    v_add_f32 v15, v15, v79
    v_cvt_pk_bf16_f32 v80, v8, v9
    v_cvt_pk_bf16_f32 v81, v10, v11
    v_cvt_pk_bf16_f32 v82, v12, v13
    v_cvt_pk_bf16_f32 v83, v14, v15
    v_fma_f32 v24, v24, v64, v119
    v_fma_f32 v25, v25, v65, v119
    v_fma_f32 v26, v26, v66, v119
    v_fma_f32 v27, v27, v67, v119
    v_fma_f32 v28, v28, v68, v119
    v_fma_f32 v29, v29, v69, v119
    v_fma_f32 v30, v30, v70, v119
    v_fma_f32 v31, v31, v71, v119
    v_mul_f32 v72, s41, v24
    v_mul_f32 v73, s41, v25
    v_mul_f32 v74, s41, v26
    v_mul_f32 v75, s41, v27
    v_mul_f32 v76, s41, v28
    v_mul_f32 v77, s41, v29
    v_mul_f32 v78, s41, v30
    v_mul_f32 v79, s41, v31
    v_exp_f32_e64 v72, v72 clamp
    v_exp_f32_e64 v73, v73 clamp
    v_exp_f32_e64 v74, v74 clamp
    v_exp_f32_e64 v75, v75 clamp
    v_exp_f32_e64 v76, v76 clamp
    v_exp_f32_e64 v77, v77 clamp
    v_exp_f32_e64 v78, v78 clamp
    v_exp_f32_e64 v79, v79 clamp
    v_max_f32 v24, v24, v120
    v_max_f32 v25, v25, v120
    v_max_f32 v26, v26, v120
    v_max_f32 v27, v27, v120
    v_max_f32 v28, v28, v120
    v_max_f32 v29, v29, v120
    v_max_f32 v30, v30, v120
    v_max_f32 v31, v31, v120
    v_fma_f32 v24, v72, v121, v24
    v_fma_f32 v25, v73, v121, v25
    v_fma_f32 v26, v74, v121, v26
    v_fma_f32 v27, v75, v121, v27
    v_fma_f32 v28, v76, v121, v28
    v_fma_f32 v29, v77, v121, v29
    v_fma_f32 v30, v78, v121, v30
    v_fma_f32 v31, v79, v121, v31
    v_cvt_pk_bf16_f32 v88, v24, v25
    v_cvt_pk_bf16_f32 v89, v26, v27
    v_cvt_pk_bf16_f32 v90, v28, v29
    v_cvt_pk_bf16_f32 v91, v30, v31
    v_mov_b32 v5, 0x3f803f80
    v_cmp_gt_u32 vcc, 4, v2
    s_nop 1
    v_cndmask_b32 v92, v88, v5, vcc
    v_cndmask_b32 v93, v89, v5, vcc
    v_cndmask_b32 v94, v90, v5, vcc
    v_cndmask_b32 v95, v91, v5, vcc
    v_mfma_f32_16x16x32_bf16 v[8:11], v[80:83], v[84:87], 0
    v_mfma_f32_16x16x32_bf16 v[12:15], v[88:91], v[84:87], 0
    v_mfma_f32_16x16x32_bf16 v[16:19], v[80:83], v[92:95], 0
    v_mfma_f32_16x16x32_bf16 v[20:23], v[88:91], v[92:95], 0
    v_mfma_f32_16x16x32_bf16 v[24:27], v[88:91], v[124:127], 0
    v_mfma_f32_16x16x32_bf16 v[28:31], v[88:91], v[128:131], 0
    v_add_u32 v6, s65, v4
    s_nop 1
    ds_write_b128 v6, v[8:11] offset:0
    ds_write_b128 v6, v[12:15] offset:1024
    ds_write_b128 v6, v[16:19] offset:2048
    ds_write_b128 v6, v[20:23] offset:3072
    s_cmp_ge_u32 s3, 4
    s_cbranch_scc1 lead_132
    s_mul_i32 s40, s6, 102400
    s_add_u32 s40, s40, 25067520
    s_lshl_b32 s41, s3, 14
    s_add_u32 s40, s40, s41
    s_add_u32 s45, s40, 0
    s_add_u32 m0, s41, 0
    s_nop 0
    buffer_load_dwordx4 v4, s[32:35], s45 offen offset:0 sc1 lds
    buffer_load_dwordx4 v4, s[32:35], s45 offen offset:1024 sc1 lds
    buffer_load_dwordx4 v4, s[32:35], s45 offen offset:2048 sc1 lds
    buffer_load_dwordx4 v4, s[32:35], s45 offen offset:3072 sc1 lds
    s_add_u32 s45, s40, 4096
    s_add_u32 m0, s41, 4096
    s_nop 0
    buffer_load_dwordx4 v4, s[32:35], s45 offen offset:0 sc1 lds
    buffer_load_dwordx4 v4, s[32:35], s45 offen offset:1024 sc1 lds
    buffer_load_dwordx4 v4, s[32:35], s45 offen offset:2048 sc1 lds
    buffer_load_dwordx4 v4, s[32:35], s45 offen offset:3072 sc1 lds
    s_add_u32 s45, s40, 8192
    s_add_u32 m0, s41, 8192
    s_nop 0
    buffer_load_dwordx4 v4, s[32:35], s45 offen offset:0 sc1 lds
    buffer_load_dwordx4 v4, s[32:35], s45 offen offset:1024 sc1 lds
    buffer_load_dwordx4 v4, s[32:35], s45 offen offset:2048 sc1 lds
    buffer_load_dwordx4 v4, s[32:35], s45 offen offset:3072 sc1 lds
    s_add_u32 s45, s40, 12288
    s_add_u32 m0, s41, 12288
    s_nop 0
    buffer_load_dwordx4 v4, s[32:35], s45 offen offset:0 sc1 lds
    buffer_load_dwordx4 v4, s[32:35], s45 offen offset:1024 sc1 lds
    buffer_load_dwordx4 v4, s[32:35], s45 offen offset:2048 sc1 lds
    buffer_load_dwordx4 v4, s[32:35], s45 offen offset:3072 sc1 lds
    s_mov_b32 s41, 0x3fb8aa3b
lead_132:
    s_waitcnt lgkmcnt(0)
    s_barrier
    s_mul_i32 s57, s71, 14336
    s_add_u32 s57, s57, 37158912
    s_cmp_eq_u32 s3, 7
    s_cbranch_scc1 kvs_135
    ds_read_b32 v8, v118 offset:0
    ds_read_b32 v9, v118 offset:6144
    ds_read_b32 v10, v118 offset:12288
    ds_read_b32 v11, v118 offset:18432
    ds_read_b32 v12, v118 offset:24576
    ds_read_b32 v13, v118 offset:30720
    ds_read_b32 v14, v118 offset:36864
    ds_read_b32 v15, v118 offset:43008
    v_lshlrev_b32 v6, 2, v0
    s_mul_i32 s40, s80, 1792
    s_add_u32 s40, s40, s57
    s_waitcnt lgkmcnt(0)
    v_add_f32 v8, v8, v9
    v_add_f32 v10, v10, v11
    v_add_f32 v12, v12, v13
    v_add_f32 v14, v14, v15
    v_add_f32 v8, v8, v10
    v_add_f32 v12, v12, v14
    v_add_f32 v8, v8, v12
    v_max_u32 v8, 1, v8
    buffer_store_dword v8, v6, s[32:35], s40 offen sc1
kvs_135:
    s_mul_i32 s42, s64, 40960
    s_mul_i32 s43, s71, 1280
    s_add_u32 s42, s42, s43
    s_add_u32 s42, s42, 15728640
    s_mov_b32 s43, 0x3b4ccccd
    v_mul_f32 v40, s43, v40
    v_mul_f32 v41, s43, v41
    v_mul_f32 v42, s43, v42
    v_mul_f32 v43, s43, v43
    v_mul_f32 v44, s43, v44
    v_mul_f32 v45, s43, v45
    v_mul_f32 v46, s43, v46
    v_mul_f32 v47, s43, v47
    v_cvt_pk_bf16_f32 v60, v40, v41
    v_cvt_pk_bf16_f32 v61, v42, v43
    v_cvt_pk_bf16_f32 v62, v44, v45
    v_cvt_pk_bf16_f32 v63, v46, v47
    v_max_u32 v60, 1, v60
    v_max_u32 v61, 1, v61
    v_max_u32 v62, 1, v62
    v_max_u32 v63, 1, v63
    buffer_store_dwordx2 v[60:61], v138, s[32:35], s42 offen sc1
    buffer_store_dwordx2 v[62:63], v138, s[32:35], s42 offen offset:128 sc1
    v_fma_f32 v32, v32, v148, v58
    v_fma_f32 v33, v33, v148, v58
    v_fma_f32 v34, v34, v148, v58
    v_fma_f32 v35, v35, v148, v58
    v_fma_f32 v36, v36, v149, v58
    v_fma_f32 v37, v37, v149, v58
    v_fma_f32 v38, v38, v149, v58
    v_fma_f32 v39, v39, v149, v58
    v_mul_f32 v72, s41, v32
    v_mul_f32 v73, s41, v33
    v_mul_f32 v74, s41, v34
    v_mul_f32 v75, s41, v35
    v_mul_f32 v76, s41, v36
    v_mul_f32 v77, s41, v37
    v_mul_f32 v78, s41, v38
    v_mul_f32 v79, s41, v39
    v_exp_f32_e64 v72, v72 clamp
    v_exp_f32_e64 v73, v73 clamp
    v_exp_f32_e64 v74, v74 clamp
    v_exp_f32_e64 v75, v75 clamp
    v_exp_f32_e64 v76, v76 clamp
    v_exp_f32_e64 v77, v77 clamp
    v_exp_f32_e64 v78, v78 clamp
    v_exp_f32_e64 v79, v79 clamp
    v_max_f32 v32, v32, v58
    v_max_f32 v33, v33, v58
    v_max_f32 v34, v34, v58
    v_max_f32 v35, v35, v58
    v_max_f32 v36, v36, v58
    v_max_f32 v37, v37, v58
    v_max_f32 v38, v38, v58
    v_max_f32 v39, v39, v58
    v_add_f32 v32, v32, v72
    v_add_f32 v33, v33, v73
    v_add_f32 v34, v34, v74
    v_add_f32 v35, v35, v75
    v_add_f32 v36, v36, v76
    v_add_f32 v37, v37, v77
    v_add_f32 v38, v38, v78
    v_add_f32 v39, v39, v79
    v_cvt_pk_bf16_f32 v96, v32, v33
    v_cvt_pk_bf16_f32 v97, v34, v35
    v_cvt_pk_bf16_f32 v98, v24, v25
    v_cvt_pk_bf16_f32 v99, v26, v27
    v_cvt_pk_bf16_f32 v100, v36, v37
    v_cvt_pk_bf16_f32 v101, v38, v39
    v_cvt_pk_bf16_f32 v102, v28, v29
    v_cvt_pk_bf16_f32 v103, v30, v31
    s_mul_i32 s44, s64, 40960
    s_add_u32 s44, s44, 13107200
    s_cmp_eq_u32 s3, 7
    s_cbranch_scc1 kv7_133
    s_mov_b32 s58, 40000
kvp_136:
    buffer_load_dwordx4 v[8:11], v132, s[32:35], s57 offen sc1
    buffer_load_dwordx4 v[12:15], v132, s[32:35], s57 offen offset:128 sc1
    s_waitcnt vmcnt(0)
    v_min3_u32 v16, v8, v9, v10
    v_min3_u32 v17, v11, v12, v13
    v_min3_u32 v16, v16, v14, v15
    v_min_u32 v16, v16, v17
    v_cmp_eq_u32 vcc, 0, v16
    s_nop 0
    s_cmp_eq_u64 vcc, 0
    s_cbranch_scc1 kvd_137
    s_cmp_lg_u32 s83, 0
    s_cbranch_scc1 kvd_137
    s_sub_u32 s58, s58, 1
    s_cmp_lg_u32 s58, 0
    s_cbranch_scc1 kvp_136
    s_mov_b32 s83, 31
    v_mov_b32 v254, 31
    v_mov_b32 v255, 16
    buffer_store_dword v254, v255, s[36:39], 0 offen
    s_branch kvd_137
kvd_137:
    v_permlane32_swap_b32 v8, v12
    v_permlane32_swap_b32 v9, v13
    v_permlane32_swap_b32 v10, v14
    v_permlane32_swap_b32 v11, v15
    v_add_f32 v8, v8, v12
    v_add_f32 v9, v9, v13
    v_add_f32 v10, v10, v14
    v_add_f32 v11, v11, v15
    s_nop 0
    v_permlane16_swap_b32 v8, v10
    v_permlane16_swap_b32 v9, v11
    v_add_f32 v8, v8, v10
    v_add_f32 v9, v9, v11
    s_nop 0
    v_add_f32_dpp v8, v8, v8 row_ror:8 row_mask:0xf bank_mask:0xf
    v_add_f32_dpp v9, v9, v9 row_ror:8 row_mask:0xf bank_mask:0xf
    v_cvt_pk_bf16_f32 v8, v8, v9
    ds_write_b32 v133, v8
    s_waitcnt lgkmcnt(0)
    s_branch kvj_134
kv7_133:
    s_mul_i32 s40, s6, 102400
    s_add_u32 s40, s40, 25067520
    s_add_u32 s41, s40, 65536
    s_mov_b32 m0, 65536
    s_nop 0
    buffer_load_dwordx4 v4, s[32:35], s41 offen offset:0 sc1 lds
    buffer_load_dwordx4 v4, s[32:35], s41 offen offset:1024 sc1 lds
    buffer_load_dwordx4 v4, s[32:35], s41 offen offset:2048 sc1 lds
    buffer_load_dwordx4 v4, s[32:35], s41 offen offset:3072 sc1 lds
    s_add_u32 s41, s40, 69632
    s_mov_b32 m0, 69632
    s_nop 0
    buffer_load_dwordx4 v4, s[32:35], s41 offen offset:0 sc1 lds
    buffer_load_dwordx4 v4, s[32:35], s41 offen offset:1024 sc1 lds
    buffer_load_dwordx4 v4, s[32:35], s41 offen offset:2048 sc1 lds
    buffer_load_dwordx4 v4, s[32:35], s41 offen offset:3072 sc1 lds
    s_add_u32 s41, s40, 73728
    s_mov_b32 m0, 73728
    s_nop 0
    buffer_load_dwordx4 v4, s[32:35], s41 offen offset:0 sc1 lds
    buffer_load_dwordx4 v4, s[32:35], s41 offen offset:1024 sc1 lds
    buffer_load_dwordx4 v4, s[32:35], s41 offen offset:2048 sc1 lds
    buffer_load_dwordx4 v4, s[32:35], s41 offen offset:3072 sc1 lds
    s_add_u32 s41, s40, 77824
    s_mov_b32 m0, 77824
    s_nop 0
    buffer_load_dwordx4 v4, s[32:35], s41 offen offset:0 sc1 lds
    buffer_load_dwordx4 v4, s[32:35], s41 offen offset:1024 sc1 lds
    buffer_load_dwordx4 v4, s[32:35], s41 offen offset:2048 sc1 lds
    buffer_load_dwordx4 v4, s[32:35], s41 offen offset:3072 sc1 lds
    s_add_u32 s41, s40, 81920
    s_mov_b32 m0, 81920
    s_nop 0
    buffer_load_dwordx4 v4, s[32:35], s41 offen offset:0 sc1 lds
    buffer_load_dwordx4 v4, s[32:35], s41 offen offset:1024 sc1 lds
    buffer_load_dwordx4 v4, s[32:35], s41 offen offset:2048 sc1 lds
    buffer_load_dwordx4 v4, s[32:35], s41 offen offset:3072 sc1 lds
    s_add_u32 s41, s40, 86016
    s_mov_b32 m0, 86016
    s_nop 0
    buffer_load_dwordx4 v4, s[32:35], s41 offen offset:0 sc1 lds
    buffer_load_dwordx4 v4, s[32:35], s41 offen offset:1024 sc1 lds
    buffer_load_dwordx4 v4, s[32:35], s41 offen offset:2048 sc1 lds
    buffer_load_dwordx4 v4, s[32:35], s41 offen offset:3072 sc1 lds
    s_add_u32 s41, s40, 90112
    s_mov_b32 m0, 90112
    s_nop 0
    buffer_load_dwordx4 v4, s[32:35], s41 offen offset:0 sc1 lds
    buffer_load_dwordx4 v4, s[32:35], s41 offen offset:1024 sc1 lds
    buffer_load_dwordx4 v4, s[32:35], s41 offen offset:2048 sc1 lds
    buffer_load_dwordx4 v4, s[32:35], s41 offen offset:3072 sc1 lds
    s_add_u32 s41, s40, 94208
    s_mov_b32 m0, 94208
    s_nop 0
    buffer_load_dwordx4 v4, s[32:35], s41 offen offset:0 sc1 lds
    buffer_load_dwordx4 v4, s[32:35], s41 offen offset:1024 sc1 lds
    buffer_load_dwordx4 v4, s[32:35], s41 offen offset:2048 sc1 lds
    buffer_load_dwordx4 v4, s[32:35], s41 offen offset:3072 sc1 lds
    s_add_u32 s41, s40, 98304
    s_mov_b32 m0, 98304
    s_nop 0
    buffer_load_dwordx4 v4, s[32:35], s41 offen offset:0 sc1 lds
    buffer_load_dwordx4 v4, s[32:35], s41 offen offset:1024 sc1 lds
    buffer_load_dwordx4 v4, s[32:35], s41 offen offset:2048 sc1 lds
    buffer_load_dwordx4 v4, s[32:35], s41 offen offset:3072 sc1 lds
kvj_134:
    s_barrier
    ds_read_b128 v[28:31], v135
    ds_read_b128 v[24:27], v134
    s_waitcnt lgkmcnt(0)
    v_mfma_f32_16x16x32_bf16 v[36:39], v[28:31], v[96:99], 0
    v_mfma_f32_16x16x32_bf16 v[44:47], v[28:31], v[100:103], 0
    v_mfma_f32_16x16x32_bf16 v[32:35], v[24:27], v[96:99], 0
    v_mfma_f32_16x16x32_bf16 v[40:43], v[24:27], v[100:103], 0
    s_nop 4
    v_mov_b32 v8, v36
    v_mov_b32 v9, v36
    v_mov_b32 v10, v44
    v_mov_b32 v11, v44
    v_permlane16_swap_b32 v8, v9
    s_nop 0
    v_permlane16_swap_b32 v10, v11
    v_add_f32 v9, v9, v58
    v_add_f32 v11, v11, v58
    v_rcp_f32 v9, v9
    v_rcp_f32 v11, v11
    v_mul_f32 v32, v32, v9
    v_mul_f32 v33, v33, v9
    v_mul_f32 v34, v34, v9
    v_mul_f32 v35, v35, v9
    v_mul_f32 v36, v36, v9
    v_mul_f32 v37, v37, v9
    v_mul_f32 v38, v38, v9
    v_mul_f32 v39, v39, v9
    v_cvt_pk_bf16_f32 v12, v32, v33
    v_cvt_pk_bf16_f32 v13, v34, v35
    v_cvt_pk_bf16_f32 v14, v36, v37
    v_cvt_pk_bf16_f32 v15, v38, v39
    v_max_u32 v12, 1, v12
    v_max_u32 v13, 1, v13
    v_max_u32 v14, 1, v14
    v_max_u32 v15, 1, v15
    buffer_store_dwordx2 v[12:13], v136, s[32:35], s44 offen offset:0 sc1
    v_mul_f32 v40, v40, v11
    v_mul_f32 v41, v41, v11
    v_mul_f32 v42, v42, v11
    v_mul_f32 v43, v43, v11
    v_mul_f32 v44, v44, v11
    v_mul_f32 v45, v45, v11
    v_mul_f32 v46, v46, v11
    v_mul_f32 v47, v47, v11
    v_cvt_pk_bf16_f32 v16, v40, v41
    v_cvt_pk_bf16_f32 v17, v42, v43
    v_cvt_pk_bf16_f32 v18, v44, v45
    v_cvt_pk_bf16_f32 v19, v46, v47
    v_max_u32 v16, 1, v16
    v_max_u32 v17, 1, v17
    v_max_u32 v18, 1, v18
    v_max_u32 v19, 1, v19
    buffer_store_dwordx2 v[16:17], v136, s[32:35], s44 offen offset:128 sc1
    s_mov_b64 exec, 0xffff
    buffer_store_dwordx2 v[14:15], v137, s[32:35], s44 offen sc1
    buffer_store_dwordx2 v[18:19], v137, s[32:35], s44 offen offset:128 sc1
    s_mov_b64 exec, -1
    v_max_u32 v98, 1, v98
    v_max_u32 v99, 1, v99
    v_max_u32 v102, 1, v102
    v_max_u32 v103, 1, v103
    s_mov_b32 exec_lo, 0
    s_mov_b32 exec_hi, 0xffff0000
    buffer_store_dwordx2 v[98:99], v138, s[32:35], s42 offen offset:256 sc1
    buffer_store_dwordx2 v[102:103], v138, s[32:35], s42 offen offset:384 sc1
    s_mov_b64 exec, -1
    s_mul_i32 s40, s61, 51200
    v_add_u32 v21, s40, v4
    v_lshrrev_b32 v11, 2, v2
    v_and_b32 v10, 3, v2
    v_lshl_add_u32 v10, v11, 3, v10
    v_add_u32 v10, s62, v10
    v_mul_u32_u24 v22, 1280, v3
    v_lshl_add_u32 v22, v10, 3, v22
    s_lshl_b32 s74, s7, 1
    s_add_u32 s74, s74, s63
    s_mul_i32 s74, s74, 40960
    s_mul_i32 s41, s6, 5120
    s_add_u32 s74, s74, s41
    s_add_u32 s74, s74, 15728640
    s_lshl_b32 s42, s5, 1
    s_add_u32 s42, s42, s63
    s_lshl_b32 s42, s42, 3
    s_add_u32 s42, s42, s62
    s_lshl_b32 s42, s42, 5
    s_lshl_b32 s43, s4, 2
    s_add_u32 s42, s42, s43
    v_and_b32 v10, 3, v2
    v_lshlrev_b32 v10, 5, v10
    v_lshrrev_b32 v11, 2, v2
    v_add3_u32 v10, v10, v11, s42
    s_movk_i32 s41, 1280
    v_mul_lo_u32 v10, v10, s41
    v_mul_u32_u24 v12, 40, v3
    v_add_u32 v23, v10, v12
    s_mul_i32 s75, s6, 160
    s_mul_i32 s40, s60, 5120
    s_add_u32 s40, s40, 102400
    v_add_u32 v9, s40, v4
    s_lshl_b32 s48, s7, 2
    s_add_u32 s48, s48, s60
    s_mul_i32 s48, s48, 20480
    s_mul_i32 s41, s61, 10240
    s_add_u32 s48, s48, s41
    s_add_u32 s48, s48, 13107200
    s_add_u32 s49, s48, 4096
    s_add_u32 s50, s48, 8192
    s_mov_b32 s58, 40000
    s_waitcnt vmcnt(0)
    s_barrier
    s_cmp_lg_u32 s61, 0
    s_cbranch_scc1 p6l_138
    buffer_load_dwordx2 v[10:11], v22, s[32:35], s74 offen offset:0 sc1
    buffer_load_dwordx2 v[12:13], v22, s[32:35], s74 offen offset:256 sc1
    buffer_load_dwordx2 v[14:15], v22, s[32:35], s74 offen offset:512 sc1
    buffer_load_dwordx2 v[16:17], v22, s[32:35], s74 offen offset:768 sc1
    buffer_load_dwordx2 v[18:19], v22, s[32:35], s74 offen offset:1024 sc1
p6l_138:
    buffer_load_dwordx4 v[84:87], v4, s[32:35], s48 offen offset:0 sc1
    buffer_load_dwordx4 v[88:91], v4, s[32:35], s48 offen offset:1024 sc1
    buffer_load_dwordx4 v[92:95], v4, s[32:35], s48 offen offset:2048 sc1
    buffer_load_dwordx4 v[96:99], v4, s[32:35], s48 offen offset:3072 sc1
    ds_read_b128 v[44:47], v21 offset:0
    ds_read_b128 v[48:51], v21 offset:1024
    ds_read_b128 v[52:55], v21 offset:2048
    ds_read_b128 v[56:59], v21 offset:3072
    ds_read_b128 v[60:63], v21 offset:4096
    ds_read_b128 v[64:67], v21 offset:5120
    ds_read_b128 v[68:71], v21 offset:6144
    ds_read_b128 v[72:75], v21 offset:7168
    ds_read_b128 v[76:79], v21 offset:8192
    ds_read_b128 v[80:83], v21 offset:9216
    buffer_load_dwordx4 v[100:103], v4, s[32:35], s49 offen offset:0 sc1
    s_waitcnt vmcnt(4)
    v_min3_u32 v5, v84, v85, v86
    v_min_u32 v5, v5, v87
    v_cmp_eq_u32 vcc, 0, v5
    s_nop 0
    s_cmp_lg_u64 vcc, 0
    s_cbranch_scc1 aor_139
aob_140:
    s_waitcnt lgkmcnt(5)
    v_mfma_f32_16x16x32_bf16 v[24:27], v[44:47], v[84:87], 0
    v_mfma_f32_16x16x32_bf16 v[28:31], v[48:51], v[84:87], 0
    v_mfma_f32_16x16x32_bf16 v[32:35], v[52:55], v[84:87], 0
    v_mfma_f32_16x16x32_bf16 v[36:39], v[56:59], v[84:87], 0
    v_mfma_f32_16x16x32_bf16 v[40:43], v[60:63], v[84:87], 0
    ds_read_b128 v[44:47], v21 offset:10240
    ds_read_b128 v[48:51], v21 offset:11264
    ds_read_b128 v[52:55], v21 offset:12288
    ds_read_b128 v[56:59], v21 offset:13312
    ds_read_b128 v[60:63], v21 offset:14336
    buffer_load_dwordx4 v[104:107], v4, s[32:35], s49 offen offset:1024 sc1
    s_waitcnt vmcnt(4)
    v_min3_u32 v5, v88, v89, v90
    v_min_u32 v5, v5, v91
    v_cmp_eq_u32 vcc, 0, v5
    s_nop 0
    s_cmp_lg_u64 vcc, 0
    s_cbranch_scc1 aor_141
aob_142:
    s_waitcnt lgkmcnt(5)
    v_mfma_f32_16x16x32_bf16 v[24:27], v[64:67], v[88:91], v[24:27]
    v_mfma_f32_16x16x32_bf16 v[28:31], v[68:71], v[88:91], v[28:31]
    v_mfma_f32_16x16x32_bf16 v[32:35], v[72:75], v[88:91], v[32:35]
    v_mfma_f32_16x16x32_bf16 v[36:39], v[76:79], v[88:91], v[36:39]
    v_mfma_f32_16x16x32_bf16 v[40:43], v[80:83], v[88:91], v[40:43]
    ds_read_b128 v[64:67], v21 offset:15360
    ds_read_b128 v[68:71], v21 offset:16384
    ds_read_b128 v[72:75], v21 offset:17408
    ds_read_b128 v[76:79], v21 offset:18432
    ds_read_b128 v[80:83], v21 offset:19456
    buffer_load_dwordx4 v[108:111], v4, s[32:35], s49 offen offset:2048 sc1
    s_waitcnt vmcnt(4)
    v_min3_u32 v5, v92, v93, v94
    v_min_u32 v5, v5, v95
    v_cmp_eq_u32 vcc, 0, v5
    s_nop 0
    s_cmp_lg_u64 vcc, 0
    s_cbranch_scc1 aor_143
aob_144:
    s_waitcnt lgkmcnt(5)
    v_mfma_f32_16x16x32_bf16 v[24:27], v[44:47], v[92:95], v[24:27]
    v_mfma_f32_16x16x32_bf16 v[28:31], v[48:51], v[92:95], v[28:31]
    v_mfma_f32_16x16x32_bf16 v[32:35], v[52:55], v[92:95], v[32:35]
    v_mfma_f32_16x16x32_bf16 v[36:39], v[56:59], v[92:95], v[36:39]
    v_mfma_f32_16x16x32_bf16 v[40:43], v[60:63], v[92:95], v[40:43]
    ds_read_b128 v[44:47], v21 offset:20480
    ds_read_b128 v[48:51], v21 offset:21504
    ds_read_b128 v[52:55], v21 offset:22528
    ds_read_b128 v[56:59], v21 offset:23552
    ds_read_b128 v[60:63], v21 offset:24576
    buffer_load_dwordx4 v[112:115], v4, s[32:35], s49 offen offset:3072 sc1
    s_waitcnt vmcnt(4)
    v_min3_u32 v5, v96, v97, v98
    v_min_u32 v5, v5, v99
    v_cmp_eq_u32 vcc, 0, v5
    s_nop 0
    s_cmp_lg_u64 vcc, 0
    s_cbranch_scc1 aor_145
aob_146:
    s_waitcnt lgkmcnt(5)
    v_mfma_f32_16x16x32_bf16 v[24:27], v[64:67], v[96:99], v[24:27]
    v_mfma_f32_16x16x32_bf16 v[28:31], v[68:71], v[96:99], v[28:31]
    v_mfma_f32_16x16x32_bf16 v[32:35], v[72:75], v[96:99], v[32:35]
    v_mfma_f32_16x16x32_bf16 v[36:39], v[76:79], v[96:99], v[36:39]
    v_mfma_f32_16x16x32_bf16 v[40:43], v[80:83], v[96:99], v[40:43]
    ds_read_b128 v[64:67], v21 offset:25600
    ds_read_b128 v[68:71], v21 offset:26624
    ds_read_b128 v[72:75], v21 offset:27648
    ds_read_b128 v[76:79], v21 offset:28672
    ds_read_b128 v[80:83], v21 offset:29696
    buffer_load_dwordx4 v[116:119], v4, s[32:35], s50 offen offset:0 sc1
    s_waitcnt vmcnt(4)
    v_min3_u32 v5, v100, v101, v102
    v_min_u32 v5, v5, v103
    v_cmp_eq_u32 vcc, 0, v5
    s_nop 0
    s_cmp_lg_u64 vcc, 0
    s_cbranch_scc1 aor_147
aob_148:
    s_waitcnt lgkmcnt(5)
    v_mfma_f32_16x16x32_bf16 v[24:27], v[44:47], v[100:103], v[24:27]
    v_mfma_f32_16x16x32_bf16 v[28:31], v[48:51], v[100:103], v[28:31]
    v_mfma_f32_16x16x32_bf16 v[32:35], v[52:55], v[100:103], v[32:35]
    v_mfma_f32_16x16x32_bf16 v[36:39], v[56:59], v[100:103], v[36:39]
    v_mfma_f32_16x16x32_bf16 v[40:43], v[60:63], v[100:103], v[40:43]
    ds_read_b128 v[44:47], v21 offset:30720
    ds_read_b128 v[48:51], v21 offset:31744
    ds_read_b128 v[52:55], v21 offset:32768
    ds_read_b128 v[56:59], v21 offset:33792
    ds_read_b128 v[60:63], v21 offset:34816
    buffer_load_dwordx4 v[120:123], v4, s[32:35], s50 offen offset:1024 sc1
    s_waitcnt vmcnt(4)
    v_min3_u32 v5, v104, v105, v106
    v_min_u32 v5, v5, v107
    v_cmp_eq_u32 vcc, 0, v5
    s_nop 0
    s_cmp_lg_u64 vcc, 0
    s_cbranch_scc1 aor_149
aob_150:
    s_waitcnt lgkmcnt(5)
    v_mfma_f32_16x16x32_bf16 v[24:27], v[64:67], v[104:107], v[24:27]
    v_mfma_f32_16x16x32_bf16 v[28:31], v[68:71], v[104:107], v[28:31]
    v_mfma_f32_16x16x32_bf16 v[32:35], v[72:75], v[104:107], v[32:35]
    v_mfma_f32_16x16x32_bf16 v[36:39], v[76:79], v[104:107], v[36:39]
    v_mfma_f32_16x16x32_bf16 v[40:43], v[80:83], v[104:107], v[40:43]
    ds_read_b128 v[64:67], v21 offset:35840
    ds_read_b128 v[68:71], v21 offset:36864
    ds_read_b128 v[72:75], v21 offset:37888
    ds_read_b128 v[76:79], v21 offset:38912
    ds_read_b128 v[80:83], v21 offset:39936
    s_waitcnt vmcnt(3)
    v_min3_u32 v5, v108, v109, v110
    v_min_u32 v5, v5, v111
    v_cmp_eq_u32 vcc, 0, v5
    s_nop 0
    s_cmp_lg_u64 vcc, 0
    s_cbranch_scc1 aor_151
aob_152:
    s_waitcnt lgkmcnt(5)
    v_mfma_f32_16x16x32_bf16 v[24:27], v[44:47], v[108:111], v[24:27]
    v_mfma_f32_16x16x32_bf16 v[28:31], v[48:51], v[108:111], v[28:31]
    v_mfma_f32_16x16x32_bf16 v[32:35], v[52:55], v[108:111], v[32:35]
    v_mfma_f32_16x16x32_bf16 v[36:39], v[56:59], v[108:111], v[36:39]
    v_mfma_f32_16x16x32_bf16 v[40:43], v[60:63], v[108:111], v[40:43]
    ds_read_b128 v[44:47], v21 offset:40960
    ds_read_b128 v[48:51], v21 offset:41984
    ds_read_b128 v[52:55], v21 offset:43008
    ds_read_b128 v[56:59], v21 offset:44032
    ds_read_b128 v[60:63], v21 offset:45056
    s_waitcnt vmcnt(2)
    v_min3_u32 v5, v112, v113, v114
    v_min_u32 v5, v5, v115
    v_cmp_eq_u32 vcc, 0, v5
    s_nop 0
    s_cmp_lg_u64 vcc, 0
    s_cbranch_scc1 aor_153
aob_154:
    s_waitcnt lgkmcnt(5)
    v_mfma_f32_16x16x32_bf16 v[24:27], v[64:67], v[112:115], v[24:27]
    v_mfma_f32_16x16x32_bf16 v[28:31], v[68:71], v[112:115], v[28:31]
    v_mfma_f32_16x16x32_bf16 v[32:35], v[72:75], v[112:115], v[32:35]
    v_mfma_f32_16x16x32_bf16 v[36:39], v[76:79], v[112:115], v[36:39]
    v_mfma_f32_16x16x32_bf16 v[40:43], v[80:83], v[112:115], v[40:43]
    ds_read_b128 v[64:67], v21 offset:46080
    ds_read_b128 v[68:71], v21 offset:47104
    ds_read_b128 v[72:75], v21 offset:48128
    ds_read_b128 v[76:79], v21 offset:49152
    ds_read_b128 v[80:83], v21 offset:50176
    s_waitcnt vmcnt(1)
    v_min3_u32 v5, v116, v117, v118
    v_min_u32 v5, v5, v119
    v_cmp_eq_u32 vcc, 0, v5
    s_nop 0
    s_cmp_lg_u64 vcc, 0
    s_cbranch_scc1 aor_155
aob_156:
    s_waitcnt lgkmcnt(5)
    v_mfma_f32_16x16x32_bf16 v[24:27], v[44:47], v[116:119], v[24:27]
    v_mfma_f32_16x16x32_bf16 v[28:31], v[48:51], v[116:119], v[28:31]
    v_mfma_f32_16x16x32_bf16 v[32:35], v[52:55], v[116:119], v[32:35]
    v_mfma_f32_16x16x32_bf16 v[36:39], v[56:59], v[116:119], v[36:39]
    v_mfma_f32_16x16x32_bf16 v[40:43], v[60:63], v[116:119], v[40:43]
    s_waitcnt vmcnt(0)
    v_min3_u32 v5, v120, v121, v122
    v_min_u32 v5, v5, v123
    v_cmp_eq_u32 vcc, 0, v5
    s_nop 0
    s_cmp_lg_u64 vcc, 0
    s_cbranch_scc1 aor_157
aob_158:
    s_waitcnt lgkmcnt(0)
    v_mfma_f32_16x16x32_bf16 v[24:27], v[64:67], v[120:123], v[24:27]
    v_mfma_f32_16x16x32_bf16 v[28:31], v[68:71], v[120:123], v[28:31]
    v_mfma_f32_16x16x32_bf16 v[32:35], v[72:75], v[120:123], v[32:35]
    v_mfma_f32_16x16x32_bf16 v[36:39], v[76:79], v[120:123], v[36:39]
    v_mfma_f32_16x16x32_bf16 v[40:43], v[80:83], v[120:123], v[40:43]
    s_cmp_eq_u32 s61, 0
    s_cbranch_scc1 p6a_159
    s_nop 1
    ds_write_b128 v9, v[24:27] offset:0
    ds_write_b128 v9, v[28:31] offset:1024
    ds_write_b128 v9, v[32:35] offset:2048
    ds_write_b128 v9, v[36:39] offset:3072
    ds_write_b128 v9, v[40:43] offset:4096
    s_waitcnt lgkmcnt(0)
    s_barrier
    s_branch p6b_160
p6r_161:
    buffer_load_dwordx2 v[10:11], v22, s[32:35], s74 offen offset:0 sc1
    buffer_load_dwordx2 v[12:13], v22, s[32:35], s74 offen offset:256 sc1
    buffer_load_dwordx2 v[14:15], v22, s[32:35], s74 offen offset:512 sc1
    buffer_load_dwordx2 v[16:17], v22, s[32:35], s74 offen offset:768 sc1
    buffer_load_dwordx2 v[18:19], v22, s[32:35], s74 offen offset:1024 sc1
    s_waitcnt vmcnt(0)
    s_cmp_lg_u32 s83, 0
    s_cbranch_scc1 p6k_162
    s_sub_u32 s58, s58, 1
    s_cmp_lg_u32 s58, 0
    s_cbranch_scc1 p6a_159
    s_mov_b32 s83, 50
    v_mov_b32 v254, 50
    v_mov_b32 v255, 16
    buffer_store_dword v254, v255, s[36:39], 0 offen
    s_branch p6k_162
p6a_159:
    v_min3_u32 v6, v10, v11, v12
    v_min3_u32 v7, v13, v14, v15
    v_min3_u32 v6, v6, v16, v17
    v_min3_u32 v7, v7, v18, v19
    v_min_u32 v6, v6, v7
    v_cmp_eq_u32 vcc, 0, v6
    s_nop 0
    s_cmp_lg_u64 vcc, 0
    s_cbranch_scc1 p6r_161
p6k_162:
    v_lshlrev_b32 v6, 16, v10
    v_and_b32 v7, 0xffff0000, v10
    v_add_f32 v24, v24, v6
    v_add_f32 v25, v25, v7
    v_lshlrev_b32 v6, 16, v11
    v_and_b32 v7, 0xffff0000, v11
    v_add_f32 v26, v26, v6
    v_add_f32 v27, v27, v7
    v_lshlrev_b32 v6, 16, v12
    v_and_b32 v7, 0xffff0000, v12
    v_add_f32 v28, v28, v6
    v_add_f32 v29, v29, v7
    v_lshlrev_b32 v6, 16, v13
    v_and_b32 v7, 0xffff0000, v13
    v_add_f32 v30, v30, v6
    v_add_f32 v31, v31, v7
    v_lshlrev_b32 v6, 16, v14
    v_and_b32 v7, 0xffff0000, v14
    v_add_f32 v32, v32, v6
    v_add_f32 v33, v33, v7
    v_lshlrev_b32 v6, 16, v15
    v_and_b32 v7, 0xffff0000, v15
    v_add_f32 v34, v34, v6
    v_add_f32 v35, v35, v7
    v_lshlrev_b32 v6, 16, v16
    v_and_b32 v7, 0xffff0000, v16
    v_add_f32 v36, v36, v6
    v_add_f32 v37, v37, v7
    v_lshlrev_b32 v6, 16, v17
    v_and_b32 v7, 0xffff0000, v17
    v_add_f32 v38, v38, v6
    v_add_f32 v39, v39, v7
    v_lshlrev_b32 v6, 16, v18
    v_and_b32 v7, 0xffff0000, v18
    v_add_f32 v40, v40, v6
    v_add_f32 v41, v41, v7
    v_lshlrev_b32 v6, 16, v19
    v_and_b32 v7, 0xffff0000, v19
    v_add_f32 v42, v42, v6
    v_add_f32 v43, v43, v7
    s_barrier
    ds_read_b128 v[44:47], v9 offset:0
    ds_read_b128 v[48:51], v9 offset:1024
    ds_read_b128 v[52:55], v9 offset:2048
    ds_read_b128 v[56:59], v9 offset:3072
    ds_read_b128 v[60:63], v9 offset:4096
    s_waitcnt lgkmcnt(0)
    v_add_f32 v24, v24, v44
    v_add_f32 v25, v25, v45
    v_cvt_pk_bf16_f32 v64, v24, v25
    v_add_f32 v26, v26, v46
    v_add_f32 v27, v27, v47
    v_cvt_pk_bf16_f32 v65, v26, v27
    v_add_f32 v28, v28, v48
    v_add_f32 v29, v29, v49
    v_cvt_pk_bf16_f32 v66, v28, v29
    v_add_f32 v30, v30, v50
    v_add_f32 v31, v31, v51
    v_cvt_pk_bf16_f32 v67, v30, v31
    v_add_f32 v32, v32, v52
    v_add_f32 v33, v33, v53
    v_cvt_pk_bf16_f32 v68, v32, v33
    v_add_f32 v34, v34, v54
    v_add_f32 v35, v35, v55
    v_cvt_pk_bf16_f32 v69, v34, v35
    v_add_f32 v36, v36, v56
    v_add_f32 v37, v37, v57
    v_cvt_pk_bf16_f32 v70, v36, v37
    v_add_f32 v38, v38, v58
    v_add_f32 v39, v39, v59
    v_cvt_pk_bf16_f32 v71, v38, v39
    v_add_f32 v40, v40, v60
    v_add_f32 v41, v41, v61
    v_cvt_pk_bf16_f32 v72, v40, v41
    v_add_f32 v42, v42, v62
    v_add_f32 v43, v43, v63
    v_cvt_pk_bf16_f32 v73, v42, v43
    buffer_store_dwordx4 v[64:67], v23, s[28:31], s75 offen
    buffer_store_dwordx4 v[68:71], v23, s[28:31], s75 offen offset:16
    buffer_store_dwordx2 v[72:73], v23, s[28:31], s75 offen offset:32
p6b_160:
kexit:
    s_endpgm
fvr_33:
    buffer_load_dwordx4 v[16:19], v137, s[32:35], s42 offen sc1
    buffer_load_dwordx4 v[20:23], v137, s[32:35], s43 offen sc1
    buffer_load_dwordx4 v[24:27], v137, s[32:35], s44 offen sc1
    buffer_load_dwordx4 v[28:31], v137, s[32:35], s45 offen sc1
    s_waitcnt vmcnt(0)
    v_min3_u32 v9, v16, v17, v18
    v_min3_u32 v9, v9, v19, v20
    v_min3_u32 v9, v9, v21, v22
    v_min3_u32 v9, v9, v23, v24
    v_min3_u32 v9, v9, v25, v26
    v_min3_u32 v9, v9, v27, v28
    v_min3_u32 v9, v9, v29, v30
    v_min_u32 v9, v9, v31
    v_cmp_eq_u32 vcc, 0, v9
    s_nop 0
    s_cmp_lg_u64 vcc, 0
    s_cbranch_scc0 fvo_163
    s_cmp_lg_u32 s83, 0
    s_cbranch_scc1 fvb_34
    s_sub_u32 s58, s58, 1
    s_cmp_lg_u32 s58, 0
    s_cbranch_scc1 fvr_33
    s_mov_b32 s83, 60
    v_mov_b32 v254, 60
    v_mov_b32 v255, 16
    buffer_store_dword v254, v255, s[36:39], 0 offen
    s_branch fvb_34
fvo_163:
    buffer_load_dwordx4 v[48:51], v136, s[32:35], s46 offen sc1
    buffer_load_dwordx4 v[52:55], v136, s[32:35], s46 offen offset:128 sc1
    s_branch fvb_34
fdr_35:
    buffer_load_dwordx4 v[48:51], v136, s[32:35], s46 offen sc1
    buffer_load_dwordx4 v[52:55], v136, s[32:35], s46 offen offset:128 sc1
    s_waitcnt vmcnt(0)
    v_min3_u32 v9, v48, v49, v50
    v_min3_u32 v9, v9, v51, v52
    v_min3_u32 v9, v9, v53, v54
    v_min_u32 v9, v9, v55
    v_cmp_eq_u32 vcc, 0, v9
    s_nop 0
    s_cmp_lg_u64 vcc, 0
    s_cbranch_scc0 fdb_36
    s_cmp_lg_u32 s83, 0
    s_cbranch_scc1 fdb_36
    s_sub_u32 s58, s58, 1
    s_cmp_lg_u32 s58, 0
    s_cbranch_scc1 fdr_35
    s_mov_b32 s83, 61
    v_mov_b32 v254, 61
    v_mov_b32 v255, 16
    buffer_store_dword v254, v255, s[36:39], 0 offen
    s_branch fdb_36
aor_79:
    buffer_load_dwordx4 v[84:87], v4, s[32:35], s48 offen offset:0 sc1
    s_waitcnt vmcnt(0)
    v_min3_u32 v5, v84, v85, v86
    v_min_u32 v5, v5, v87
    v_cmp_eq_u32 vcc, 0, v5
    s_nop 0
    s_cmp_lg_u64 vcc, 0
    s_cbranch_scc0 aok_164
    s_cmp_lg_u32 s83, 0
    s_cbranch_scc1 aob_80
    s_sub_u32 s58, s58, 1
    s_cmp_lg_u32 s58, 0
    s_cbranch_scc1 aor_79
    s_mov_b32 s83, 40
    v_mov_b32 v254, 40
    v_mov_b32 v255, 16
    buffer_store_dword v254, v255, s[36:39], 0 offen
    s_branch aob_80
aok_164:
    buffer_load_dwordx4 v[88:91], v4, s[32:35], s48 offen offset:1024 sc1
    buffer_load_dwordx4 v[92:95], v4, s[32:35], s48 offen offset:2048 sc1
    buffer_load_dwordx4 v[96:99], v4, s[32:35], s48 offen offset:3072 sc1
    buffer_load_dwordx4 v[100:103], v4, s[32:35], s49 offen offset:0 sc1
    s_branch aob_80
aor_81:
    buffer_load_dwordx4 v[88:91], v4, s[32:35], s48 offen offset:1024 sc1
    s_waitcnt vmcnt(0)
    v_min3_u32 v5, v88, v89, v90
    v_min_u32 v5, v5, v91
    v_cmp_eq_u32 vcc, 0, v5
    s_nop 0
    s_cmp_lg_u64 vcc, 0
    s_cbranch_scc0 aok_165
    s_cmp_lg_u32 s83, 0
    s_cbranch_scc1 aob_82
    s_sub_u32 s58, s58, 1
    s_cmp_lg_u32 s58, 0
    s_cbranch_scc1 aor_81
    s_mov_b32 s83, 40
    v_mov_b32 v254, 40
    v_mov_b32 v255, 16
    buffer_store_dword v254, v255, s[36:39], 0 offen
    s_branch aob_82
aok_165:
    buffer_load_dwordx4 v[92:95], v4, s[32:35], s48 offen offset:2048 sc1
    buffer_load_dwordx4 v[96:99], v4, s[32:35], s48 offen offset:3072 sc1
    buffer_load_dwordx4 v[100:103], v4, s[32:35], s49 offen offset:0 sc1
    buffer_load_dwordx4 v[104:107], v4, s[32:35], s49 offen offset:1024 sc1
    s_branch aob_82
aor_83:
    buffer_load_dwordx4 v[92:95], v4, s[32:35], s48 offen offset:2048 sc1
    s_waitcnt vmcnt(0)
    v_min3_u32 v5, v92, v93, v94
    v_min_u32 v5, v5, v95
    v_cmp_eq_u32 vcc, 0, v5
    s_nop 0
    s_cmp_lg_u64 vcc, 0
    s_cbranch_scc0 aok_166
    s_cmp_lg_u32 s83, 0
    s_cbranch_scc1 aob_84
    s_sub_u32 s58, s58, 1
    s_cmp_lg_u32 s58, 0
    s_cbranch_scc1 aor_83
    s_mov_b32 s83, 40
    v_mov_b32 v254, 40
    v_mov_b32 v255, 16
    buffer_store_dword v254, v255, s[36:39], 0 offen
    s_branch aob_84
aok_166:
    buffer_load_dwordx4 v[96:99], v4, s[32:35], s48 offen offset:3072 sc1
    buffer_load_dwordx4 v[100:103], v4, s[32:35], s49 offen offset:0 sc1
    buffer_load_dwordx4 v[104:107], v4, s[32:35], s49 offen offset:1024 sc1
    buffer_load_dwordx4 v[108:111], v4, s[32:35], s49 offen offset:2048 sc1
    s_branch aob_84
aor_85:
    buffer_load_dwordx4 v[96:99], v4, s[32:35], s48 offen offset:3072 sc1
    s_waitcnt vmcnt(0)
    v_min3_u32 v5, v96, v97, v98
    v_min_u32 v5, v5, v99
    v_cmp_eq_u32 vcc, 0, v5
    s_nop 0
    s_cmp_lg_u64 vcc, 0
    s_cbranch_scc0 aok_167
    s_cmp_lg_u32 s83, 0
    s_cbranch_scc1 aob_86
    s_sub_u32 s58, s58, 1
    s_cmp_lg_u32 s58, 0
    s_cbranch_scc1 aor_85
    s_mov_b32 s83, 40
    v_mov_b32 v254, 40
    v_mov_b32 v255, 16
    buffer_store_dword v254, v255, s[36:39], 0 offen
    s_branch aob_86
aok_167:
    buffer_load_dwordx4 v[100:103], v4, s[32:35], s49 offen offset:0 sc1
    buffer_load_dwordx4 v[104:107], v4, s[32:35], s49 offen offset:1024 sc1
    buffer_load_dwordx4 v[108:111], v4, s[32:35], s49 offen offset:2048 sc1
    buffer_load_dwordx4 v[112:115], v4, s[32:35], s49 offen offset:3072 sc1
    s_branch aob_86
aor_87:
    buffer_load_dwordx4 v[100:103], v4, s[32:35], s49 offen offset:0 sc1
    s_waitcnt vmcnt(0)
    v_min3_u32 v5, v100, v101, v102
    v_min_u32 v5, v5, v103
    v_cmp_eq_u32 vcc, 0, v5
    s_nop 0
    s_cmp_lg_u64 vcc, 0
    s_cbranch_scc0 aok_168
    s_cmp_lg_u32 s83, 0
    s_cbranch_scc1 aob_88
    s_sub_u32 s58, s58, 1
    s_cmp_lg_u32 s58, 0
    s_cbranch_scc1 aor_87
    s_mov_b32 s83, 40
    v_mov_b32 v254, 40
    v_mov_b32 v255, 16
    buffer_store_dword v254, v255, s[36:39], 0 offen
    s_branch aob_88
aok_168:
    buffer_load_dwordx4 v[104:107], v4, s[32:35], s49 offen offset:1024 sc1
    buffer_load_dwordx4 v[108:111], v4, s[32:35], s49 offen offset:2048 sc1
    buffer_load_dwordx4 v[112:115], v4, s[32:35], s49 offen offset:3072 sc1
    buffer_load_dwordx4 v[116:119], v4, s[32:35], s50 offen offset:0 sc1
    s_branch aob_88
aor_89:
    buffer_load_dwordx4 v[104:107], v4, s[32:35], s49 offen offset:1024 sc1
    s_waitcnt vmcnt(0)
    v_min3_u32 v5, v104, v105, v106
    v_min_u32 v5, v5, v107
    v_cmp_eq_u32 vcc, 0, v5
    s_nop 0
    s_cmp_lg_u64 vcc, 0
    s_cbranch_scc0 aok_169
    s_cmp_lg_u32 s83, 0
    s_cbranch_scc1 aob_90
    s_sub_u32 s58, s58, 1
    s_cmp_lg_u32 s58, 0
    s_cbranch_scc1 aor_89
    s_mov_b32 s83, 40
    v_mov_b32 v254, 40
    v_mov_b32 v255, 16
    buffer_store_dword v254, v255, s[36:39], 0 offen
    s_branch aob_90
aok_169:
    buffer_load_dwordx4 v[108:111], v4, s[32:35], s49 offen offset:2048 sc1
    buffer_load_dwordx4 v[112:115], v4, s[32:35], s49 offen offset:3072 sc1
    buffer_load_dwordx4 v[116:119], v4, s[32:35], s50 offen offset:0 sc1
    buffer_load_dwordx4 v[120:123], v4, s[32:35], s50 offen offset:1024 sc1
    s_branch aob_90
aor_91:
    buffer_load_dwordx4 v[108:111], v4, s[32:35], s49 offen offset:2048 sc1
    s_waitcnt vmcnt(0)
    v_min3_u32 v5, v108, v109, v110
    v_min_u32 v5, v5, v111
    v_cmp_eq_u32 vcc, 0, v5
    s_nop 0
    s_cmp_lg_u64 vcc, 0
    s_cbranch_scc0 aok_170
    s_cmp_lg_u32 s83, 0
    s_cbranch_scc1 aob_92
    s_sub_u32 s58, s58, 1
    s_cmp_lg_u32 s58, 0
    s_cbranch_scc1 aor_91
    s_mov_b32 s83, 40
    v_mov_b32 v254, 40
    v_mov_b32 v255, 16
    buffer_store_dword v254, v255, s[36:39], 0 offen
    s_branch aob_92
aok_170:
    buffer_load_dwordx4 v[112:115], v4, s[32:35], s49 offen offset:3072 sc1
    buffer_load_dwordx4 v[116:119], v4, s[32:35], s50 offen offset:0 sc1
    buffer_load_dwordx4 v[120:123], v4, s[32:35], s50 offen offset:1024 sc1
    s_branch aob_92
aor_93:
    buffer_load_dwordx4 v[112:115], v4, s[32:35], s49 offen offset:3072 sc1
    s_waitcnt vmcnt(0)
    v_min3_u32 v5, v112, v113, v114
    v_min_u32 v5, v5, v115
    v_cmp_eq_u32 vcc, 0, v5
    s_nop 0
    s_cmp_lg_u64 vcc, 0
    s_cbranch_scc0 aok_171
    s_cmp_lg_u32 s83, 0
    s_cbranch_scc1 aob_94
    s_sub_u32 s58, s58, 1
    s_cmp_lg_u32 s58, 0
    s_cbranch_scc1 aor_93
    s_mov_b32 s83, 40
    v_mov_b32 v254, 40
    v_mov_b32 v255, 16
    buffer_store_dword v254, v255, s[36:39], 0 offen
    s_branch aob_94
aok_171:
    buffer_load_dwordx4 v[116:119], v4, s[32:35], s50 offen offset:0 sc1
    buffer_load_dwordx4 v[120:123], v4, s[32:35], s50 offen offset:1024 sc1
    s_branch aob_94
aor_95:
    buffer_load_dwordx4 v[116:119], v4, s[32:35], s50 offen offset:0 sc1
    s_waitcnt vmcnt(0)
    v_min3_u32 v5, v116, v117, v118
    v_min_u32 v5, v5, v119
    v_cmp_eq_u32 vcc, 0, v5
    s_nop 0
    s_cmp_lg_u64 vcc, 0
    s_cbranch_scc0 aok_172
    s_cmp_lg_u32 s83, 0
    s_cbranch_scc1 aob_96
    s_sub_u32 s58, s58, 1
    s_cmp_lg_u32 s58, 0
    s_cbranch_scc1 aor_95
    s_mov_b32 s83, 40
    v_mov_b32 v254, 40
    v_mov_b32 v255, 16
    buffer_store_dword v254, v255, s[36:39], 0 offen
    s_branch aob_96
aok_172:
    buffer_load_dwordx4 v[120:123], v4, s[32:35], s50 offen offset:1024 sc1
    s_branch aob_96
aor_97:
    buffer_load_dwordx4 v[120:123], v4, s[32:35], s50 offen offset:1024 sc1
    s_waitcnt vmcnt(0)
    v_min3_u32 v5, v120, v121, v122
    v_min_u32 v5, v5, v123
    v_cmp_eq_u32 vcc, 0, v5
    s_nop 0
    s_cmp_lg_u64 vcc, 0
    s_cbranch_scc0 aok_173
    s_cmp_lg_u32 s83, 0
    s_cbranch_scc1 aob_98
    s_sub_u32 s58, s58, 1
    s_cmp_lg_u32 s58, 0
    s_cbranch_scc1 aor_97
    s_mov_b32 s83, 40
    v_mov_b32 v254, 40
    v_mov_b32 v255, 16
    buffer_store_dword v254, v255, s[36:39], 0 offen
    s_branch aob_98
aok_173:
    s_branch aob_98
fvr_103:
    buffer_load_dwordx4 v[16:19], v137, s[32:35], s42 offen sc1
    buffer_load_dwordx4 v[20:23], v137, s[32:35], s43 offen sc1
    buffer_load_dwordx4 v[24:27], v137, s[32:35], s44 offen sc1
    buffer_load_dwordx4 v[28:31], v137, s[32:35], s45 offen sc1
    s_waitcnt vmcnt(0)
    v_min3_u32 v9, v16, v17, v18
    v_min3_u32 v9, v9, v19, v20
    v_min3_u32 v9, v9, v21, v22
    v_min3_u32 v9, v9, v23, v24
    v_min3_u32 v9, v9, v25, v26
    v_min3_u32 v9, v9, v27, v28
    v_min3_u32 v9, v9, v29, v30
    v_min_u32 v9, v9, v31
    v_cmp_eq_u32 vcc, 0, v9
    s_nop 0
    s_cmp_lg_u64 vcc, 0
    s_cbranch_scc0 fvo_174
    s_cmp_lg_u32 s83, 0
    s_cbranch_scc1 fvb_104
    s_sub_u32 s58, s58, 1
    s_cmp_lg_u32 s58, 0
    s_cbranch_scc1 fvr_103
    s_mov_b32 s83, 60
    v_mov_b32 v254, 60
    v_mov_b32 v255, 16
    buffer_store_dword v254, v255, s[36:39], 0 offen
    s_branch fvb_104
fvo_174:
    buffer_load_dwordx4 v[48:51], v136, s[32:35], s46 offen sc1
    buffer_load_dwordx4 v[52:55], v136, s[32:35], s46 offen offset:128 sc1
    s_branch fvb_104
fdr_105:
    buffer_load_dwordx4 v[48:51], v136, s[32:35], s46 offen sc1
    buffer_load_dwordx4 v[52:55], v136, s[32:35], s46 offen offset:128 sc1
    s_waitcnt vmcnt(0)
    v_min3_u32 v9, v48, v49, v50
    v_min3_u32 v9, v9, v51, v52
    v_min3_u32 v9, v9, v53, v54
    v_min_u32 v9, v9, v55
    v_cmp_eq_u32 vcc, 0, v9
    s_nop 0
    s_cmp_lg_u64 vcc, 0
    s_cbranch_scc0 fdb_106
    s_cmp_lg_u32 s83, 0
    s_cbranch_scc1 fdb_106
    s_sub_u32 s58, s58, 1
    s_cmp_lg_u32 s58, 0
    s_cbranch_scc1 fdr_105
    s_mov_b32 s83, 61
    v_mov_b32 v254, 61
    v_mov_b32 v255, 16
    buffer_store_dword v254, v255, s[36:39], 0 offen
    s_branch fdb_106
aor_139:
    buffer_load_dwordx4 v[84:87], v4, s[32:35], s48 offen offset:0 sc1
    s_waitcnt vmcnt(0)
    v_min3_u32 v5, v84, v85, v86
    v_min_u32 v5, v5, v87
    v_cmp_eq_u32 vcc, 0, v5
    s_nop 0
    s_cmp_lg_u64 vcc, 0
    s_cbranch_scc0 aok_175
    s_cmp_lg_u32 s83, 0
    s_cbranch_scc1 aob_140
    s_sub_u32 s58, s58, 1
    s_cmp_lg_u32 s58, 0
    s_cbranch_scc1 aor_139
    s_mov_b32 s83, 41
    v_mov_b32 v254, 41
    v_mov_b32 v255, 16
    buffer_store_dword v254, v255, s[36:39], 0 offen
    s_branch aob_140
aok_175:
    buffer_load_dwordx4 v[88:91], v4, s[32:35], s48 offen offset:1024 sc1
    buffer_load_dwordx4 v[92:95], v4, s[32:35], s48 offen offset:2048 sc1
    buffer_load_dwordx4 v[96:99], v4, s[32:35], s48 offen offset:3072 sc1
    buffer_load_dwordx4 v[100:103], v4, s[32:35], s49 offen offset:0 sc1
    s_branch aob_140
aor_141:
    buffer_load_dwordx4 v[88:91], v4, s[32:35], s48 offen offset:1024 sc1
    s_waitcnt vmcnt(0)
    v_min3_u32 v5, v88, v89, v90
    v_min_u32 v5, v5, v91
    v_cmp_eq_u32 vcc, 0, v5
    s_nop 0
    s_cmp_lg_u64 vcc, 0
    s_cbranch_scc0 aok_176
    s_cmp_lg_u32 s83, 0
    s_cbranch_scc1 aob_142
    s_sub_u32 s58, s58, 1
    s_cmp_lg_u32 s58, 0
    s_cbranch_scc1 aor_141
    s_mov_b32 s83, 41
    v_mov_b32 v254, 41
    v_mov_b32 v255, 16
    buffer_store_dword v254, v255, s[36:39], 0 offen
    s_branch aob_142
aok_176:
    buffer_load_dwordx4 v[92:95], v4, s[32:35], s48 offen offset:2048 sc1
    buffer_load_dwordx4 v[96:99], v4, s[32:35], s48 offen offset:3072 sc1
    buffer_load_dwordx4 v[100:103], v4, s[32:35], s49 offen offset:0 sc1
    buffer_load_dwordx4 v[104:107], v4, s[32:35], s49 offen offset:1024 sc1
    s_branch aob_142
aor_143:
    buffer_load_dwordx4 v[92:95], v4, s[32:35], s48 offen offset:2048 sc1
    s_waitcnt vmcnt(0)
    v_min3_u32 v5, v92, v93, v94
    v_min_u32 v5, v5, v95
    v_cmp_eq_u32 vcc, 0, v5
    s_nop 0
    s_cmp_lg_u64 vcc, 0
    s_cbranch_scc0 aok_177
    s_cmp_lg_u32 s83, 0
    s_cbranch_scc1 aob_144
    s_sub_u32 s58, s58, 1
    s_cmp_lg_u32 s58, 0
    s_cbranch_scc1 aor_143
    s_mov_b32 s83, 41
    v_mov_b32 v254, 41
    v_mov_b32 v255, 16
    buffer_store_dword v254, v255, s[36:39], 0 offen
    s_branch aob_144
aok_177:
    buffer_load_dwordx4 v[96:99], v4, s[32:35], s48 offen offset:3072 sc1
    buffer_load_dwordx4 v[100:103], v4, s[32:35], s49 offen offset:0 sc1
    buffer_load_dwordx4 v[104:107], v4, s[32:35], s49 offen offset:1024 sc1
    buffer_load_dwordx4 v[108:111], v4, s[32:35], s49 offen offset:2048 sc1
    s_branch aob_144
aor_145:
    buffer_load_dwordx4 v[96:99], v4, s[32:35], s48 offen offset:3072 sc1
    s_waitcnt vmcnt(0)
    v_min3_u32 v5, v96, v97, v98
    v_min_u32 v5, v5, v99
    v_cmp_eq_u32 vcc, 0, v5
    s_nop 0
    s_cmp_lg_u64 vcc, 0
    s_cbranch_scc0 aok_178
    s_cmp_lg_u32 s83, 0
    s_cbranch_scc1 aob_146
    s_sub_u32 s58, s58, 1
    s_cmp_lg_u32 s58, 0
    s_cbranch_scc1 aor_145
    s_mov_b32 s83, 41
    v_mov_b32 v254, 41
    v_mov_b32 v255, 16
    buffer_store_dword v254, v255, s[36:39], 0 offen
    s_branch aob_146
aok_178:
    buffer_load_dwordx4 v[100:103], v4, s[32:35], s49 offen offset:0 sc1
    buffer_load_dwordx4 v[104:107], v4, s[32:35], s49 offen offset:1024 sc1
    buffer_load_dwordx4 v[108:111], v4, s[32:35], s49 offen offset:2048 sc1
    buffer_load_dwordx4 v[112:115], v4, s[32:35], s49 offen offset:3072 sc1
    s_branch aob_146
aor_147:
    buffer_load_dwordx4 v[100:103], v4, s[32:35], s49 offen offset:0 sc1
    s_waitcnt vmcnt(0)
    v_min3_u32 v5, v100, v101, v102
    v_min_u32 v5, v5, v103
    v_cmp_eq_u32 vcc, 0, v5
    s_nop 0
    s_cmp_lg_u64 vcc, 0
    s_cbranch_scc0 aok_179
    s_cmp_lg_u32 s83, 0
    s_cbranch_scc1 aob_148
    s_sub_u32 s58, s58, 1
    s_cmp_lg_u32 s58, 0
    s_cbranch_scc1 aor_147
    s_mov_b32 s83, 41
    v_mov_b32 v254, 41
    v_mov_b32 v255, 16
    buffer_store_dword v254, v255, s[36:39], 0 offen
    s_branch aob_148
aok_179:
    buffer_load_dwordx4 v[104:107], v4, s[32:35], s49 offen offset:1024 sc1
    buffer_load_dwordx4 v[108:111], v4, s[32:35], s49 offen offset:2048 sc1
    buffer_load_dwordx4 v[112:115], v4, s[32:35], s49 offen offset:3072 sc1
    buffer_load_dwordx4 v[116:119], v4, s[32:35], s50 offen offset:0 sc1
    s_branch aob_148
aor_149:
    buffer_load_dwordx4 v[104:107], v4, s[32:35], s49 offen offset:1024 sc1
    s_waitcnt vmcnt(0)
    v_min3_u32 v5, v104, v105, v106
    v_min_u32 v5, v5, v107
    v_cmp_eq_u32 vcc, 0, v5
    s_nop 0
    s_cmp_lg_u64 vcc, 0
    s_cbranch_scc0 aok_180
    s_cmp_lg_u32 s83, 0
    s_cbranch_scc1 aob_150
    s_sub_u32 s58, s58, 1
    s_cmp_lg_u32 s58, 0
    s_cbranch_scc1 aor_149
    s_mov_b32 s83, 41
    v_mov_b32 v254, 41
    v_mov_b32 v255, 16
    buffer_store_dword v254, v255, s[36:39], 0 offen
    s_branch aob_150
aok_180:
    buffer_load_dwordx4 v[108:111], v4, s[32:35], s49 offen offset:2048 sc1
    buffer_load_dwordx4 v[112:115], v4, s[32:35], s49 offen offset:3072 sc1
    buffer_load_dwordx4 v[116:119], v4, s[32:35], s50 offen offset:0 sc1
    buffer_load_dwordx4 v[120:123], v4, s[32:35], s50 offen offset:1024 sc1
    s_branch aob_150
aor_151:
    buffer_load_dwordx4 v[108:111], v4, s[32:35], s49 offen offset:2048 sc1
    s_waitcnt vmcnt(0)
    v_min3_u32 v5, v108, v109, v110
    v_min_u32 v5, v5, v111
    v_cmp_eq_u32 vcc, 0, v5
    s_nop 0
    s_cmp_lg_u64 vcc, 0
    s_cbranch_scc0 aok_181
    s_cmp_lg_u32 s83, 0
    s_cbranch_scc1 aob_152
    s_sub_u32 s58, s58, 1
    s_cmp_lg_u32 s58, 0
    s_cbranch_scc1 aor_151
    s_mov_b32 s83, 41
    v_mov_b32 v254, 41
    v_mov_b32 v255, 16
    buffer_store_dword v254, v255, s[36:39], 0 offen
    s_branch aob_152
aok_181:
    buffer_load_dwordx4 v[112:115], v4, s[32:35], s49 offen offset:3072 sc1
    buffer_load_dwordx4 v[116:119], v4, s[32:35], s50 offen offset:0 sc1
    buffer_load_dwordx4 v[120:123], v4, s[32:35], s50 offen offset:1024 sc1
    s_branch aob_152
aor_153:
    buffer_load_dwordx4 v[112:115], v4, s[32:35], s49 offen offset:3072 sc1
    s_waitcnt vmcnt(0)
    v_min3_u32 v5, v112, v113, v114
    v_min_u32 v5, v5, v115
    v_cmp_eq_u32 vcc, 0, v5
    s_nop 0
    s_cmp_lg_u64 vcc, 0
    s_cbranch_scc0 aok_182
    s_cmp_lg_u32 s83, 0
    s_cbranch_scc1 aob_154
    s_sub_u32 s58, s58, 1
    s_cmp_lg_u32 s58, 0
    s_cbranch_scc1 aor_153
    s_mov_b32 s83, 41
    v_mov_b32 v254, 41
    v_mov_b32 v255, 16
    buffer_store_dword v254, v255, s[36:39], 0 offen
    s_branch aob_154
aok_182:
    buffer_load_dwordx4 v[116:119], v4, s[32:35], s50 offen offset:0 sc1
    buffer_load_dwordx4 v[120:123], v4, s[32:35], s50 offen offset:1024 sc1
    s_branch aob_154
aor_155:
    buffer_load_dwordx4 v[116:119], v4, s[32:35], s50 offen offset:0 sc1
    s_waitcnt vmcnt(0)
    v_min3_u32 v5, v116, v117, v118
    v_min_u32 v5, v5, v119
    v_cmp_eq_u32 vcc, 0, v5
    s_nop 0
    s_cmp_lg_u64 vcc, 0
    s_cbranch_scc0 aok_183
    s_cmp_lg_u32 s83, 0
    s_cbranch_scc1 aob_156
    s_sub_u32 s58, s58, 1
    s_cmp_lg_u32 s58, 0
    s_cbranch_scc1 aor_155
    s_mov_b32 s83, 41
    v_mov_b32 v254, 41
    v_mov_b32 v255, 16
    buffer_store_dword v254, v255, s[36:39], 0 offen
    s_branch aob_156
aok_183:
    buffer_load_dwordx4 v[120:123], v4, s[32:35], s50 offen offset:1024 sc1
    s_branch aob_156
aor_157:
    buffer_load_dwordx4 v[120:123], v4, s[32:35], s50 offen offset:1024 sc1
    s_waitcnt vmcnt(0)
    v_min3_u32 v5, v120, v121, v122
    v_min_u32 v5, v5, v123
    v_cmp_eq_u32 vcc, 0, v5
    s_nop 0
    s_cmp_lg_u64 vcc, 0
    s_cbranch_scc0 aok_184
    s_cmp_lg_u32 s83, 0
    s_cbranch_scc1 aob_158
    s_sub_u32 s58, s58, 1
    s_cmp_lg_u32 s58, 0
    s_cbranch_scc1 aor_157
    s_mov_b32 s83, 41
    v_mov_b32 v254, 41
    v_mov_b32 v255, 16
    buffer_store_dword v254, v255, s[36:39], 0 offen
    s_branch aob_158
aok_184:
    s_branch aob_158
kend:
.section .rodata,"a"
.p2align 6
.amdhsa_kernel interleave_layers__spectral_gfnet__linear_attn_block__prompt_kernel
  .amdhsa_next_free_vgpr 256
  .amdhsa_next_free_sgpr 102
  .amdhsa_accum_offset 256
  .amdhsa_group_segment_fixed_size 0
  .amdhsa_kernarg_size 72
  .amdhsa_user_sgpr_count 2
  .amdhsa_user_sgpr_kernarg_segment_ptr 1
  .amdhsa_system_sgpr_workgroup_id_x 1
.end_amdhsa_kernel
```
